```python
import torch

def _softmax(x, axis=-1):
    return torch.softmax(x, dim=axis)
def _gelu(x):
    return torch.nn.functional.gelu(x, approximate="tanh")
def _silu(x):
    return torch.nn.functional.silu(x)
def _sigmoid(x):
    return torch.sigmoid(x)
def _layernorm(x, axis=-1, eps=1e-5):
    m = x.mean(dim=axis, keepdim=True)
    v = x.var(dim=axis, keepdim=True, unbiased=False)
    return (x - m) / torch.sqrt(v + eps)
def _scatter_add(tgt, idx, src, axis=0):
    return tgt.clone().index_add_(axis, idx, src)
def _segment_sum(src, seg, n):
    out = torch.zeros((n,) + src.shape[1:], dtype=src.dtype)
    return out.index_add_(0, seg, src)
def _pad(x, pw):
    flat = tuple(v for pair in reversed(pw) for v in pair)
    return torch.nn.functional.pad(x, flat)

kernel_name = 'parallel_sum__grouped_kv_mqa__dense_activation_gelu__prompt'

def setup_inputs():

    _w = (lambda a: (lambda t: t.to(torch.bfloat16) if t.is_floating_point() else t)(torch.as_tensor(a)))
    def _A_setup():
        B, S, D, H = 1, 2048, 512, 32
        Dh = D // H
        return {
            "x": _w((lambda *s: torch.randn(*s, dtype=torch.bfloat16) * 0.05)(B, S, D)),
            "wq": _w((lambda *s: torch.randn(*s, dtype=torch.bfloat16) * 0.05)(D, H * Dh)),
            "wk": _w((lambda *s: torch.randn(*s, dtype=torch.bfloat16) * 0.05)(D, Dh)),
            "wv": _w((lambda *s: torch.randn(*s, dtype=torch.bfloat16) * 0.05)(D, Dh)),
            "wo": _w((lambda *s: torch.randn(*s, dtype=torch.bfloat16) * 0.05)(H * Dh, D)),
        }
    _A_in = _A_setup()

    def _B_setup():
        B, S, D, F = 1, 2048, 512, 1792
        return {
            "x": _w((lambda *s: torch.randn(*s, dtype=torch.bfloat16) * 0.05)(B, S, D)),
            "w1": _w((lambda *s: torch.randn(*s, dtype=torch.bfloat16) * 0.8)(D, F) * (D ** -0.5)),
            "b1": _w((lambda *s: torch.randn(*s, dtype=torch.bfloat16) * 12.8)(F) * 0.01),
            "w2": _w((lambda *s: torch.randn(*s, dtype=torch.bfloat16) * 0.8)(F, D) * (F ** -0.5)),
            "b2": _w((lambda *s: torch.randn(*s, dtype=torch.bfloat16) * 12.8)(D) * 0.01),
        }
    _B_in = _B_setup()

    return {
        "A_x": _A_in["x"],
        "A_wq": _A_in["wq"],
        "A_wk": _A_in["wk"],
        "A_wv": _A_in["wv"],
        "A_wo": _A_in["wo"],
        "B_x": _B_in["x"],
        "B_w1": _B_in["w1"],
        "B_b1": _B_in["b1"],
        "B_w2": _B_in["w2"],
        "B_b2": _B_in["b2"],
    }

def reference(A_x, A_wq, A_wk, A_wv, A_wo, B_x, B_w1, B_b1, B_w2, B_b2):
    def _A_ref(x, wq, wk, wv, wo):
        B, S, D = x.shape
        H = 32
        Dh = D // H
        q = (lambda x, *d: x.permute(*d))((x @ wq).reshape(B, S, H, Dh), 0, 2, 1, 3)
        k = x @ wk
        v = x @ wv
        scores = torch.einsum("bhqd,bkd->bhqk", q, k) * (Dh ** -0.5)
        p = _softmax(scores, axis=-1)
        o = torch.einsum("bhqk,bkd->bhqd", p, v)
        return (lambda x, *d: x.permute(*d))(o, 0, 2, 1, 3).reshape(B, S, H * Dh) @ wo

    def _B_ref(x, w1, b1, w2, b2):
        h = torch.einsum("bsd,df->bsf", x, w1) + b1
        h = _gelu(h)
        return torch.einsum("bsf,fd->bsd", h, w2) + b2

    x = A_x
    xn = _layernorm(x, axis=-1)
    return x + _A_ref(xn, A_wq, A_wk, A_wv, A_wo) + _B_ref(xn, B_w1, B_b1, B_w2, B_b2)
```

```asm
; @launch grid=(256,1,1) block=(512,1,1) lds=163840
.amdgcn_target "amdgcn-amd-amdhsa--gfx950"
.text
.globl parallel_sum__grouped_kv_mqa__dense_activation_gelu__prompt_kernel
.p2align 8
.type parallel_sum__grouped_kv_mqa__dense_activation_gelu__prompt_kernel,@function
parallel_sum__grouped_kv_mqa__dense_activation_gelu__prompt_kernel:
LSTART:
 s_cmp_ge_u32 s2, 256
 s_cbranch_scc1 LEND
 s_nop 0
 s_load_dwordx16 s[4:19], s[0:1], 0
 s_load_dwordx8 s[20:27], s[0:1], 64
 s_load_dwordx2 s[28:29], s[0:1], 96
 v_lshrrev_b32 v1, 6, v0
 v_and_b32 v255, 63, v0
 v_readfirstlane_b32 s30, v1
 s_and_b32 s67, s2, 7
 s_lshr_b32 s68, s2, 3
 s_and_b32 s31, s67, 3
 s_lshl_b32 s31, s31, 3
 s_and_b32 s69, s68, 7
 s_add_u32 s31, s31, s69
 s_lshr_b32 s3, s67, 2
 s_lshl_b32 s3, s3, 2
 s_lshr_b32 s69, s68, 3
 s_add_u32 s3, s3, s69
 s_lshl_b32 s71, s3, 1
 s_add_u32 s71, s71, s30
 s_and_b32 s71, s71, 7
 v_lshrrev_b32 v2, 3, v255
 v_and_b32 v3, 7, v255
 v_lshlrev_b32_e64 v3, 4, v3
 v_lshl_add_u32 v40, v2, 10, v3
 s_lshl_b32 s69, s31, 16
 s_lshl_b32 s68, s71, 13
 s_add_u32 s69, s69, s68
 s_and_b32 s62, s3, 1
 s_and_b32 s60, s30, 3
 s_lshl_b32 s68, s71, 3
 v_add_u32_e64 v2, s68, v2
 v_mul_u32_u24 v2, 1040, v2
 v_add_u32_e64 v48, v2, v3
 s_mov_b32 s74, 0x3f803f80
 s_mov_b32 s34, 2097152
 s_mov_b32 s35, 0x20000
 s_cmp_lt_u32 s30, 4
 s_waitcnt lgkmcnt(0)
 s_mov_b64 s[32:33], s[4:5]
 s_nop 0
 buffer_load_dwordx4 v[64:67], v40, s[32:35], s69 offen offset:0
 buffer_load_dwordx4 v[68:71], v40, s[32:35], s69 offen offset:128
 buffer_load_dwordx4 v[72:75], v40, s[32:35], s69 offen offset:256
 buffer_load_dwordx4 v[76:79], v40, s[32:35], s69 offen offset:384
 buffer_load_dwordx4 v[80:83], v40, s[32:35], s69 offen offset:512
 s_cbranch_scc0 LG
 s_nop 0
 buffer_load_dwordx4 v[84:87], v40, s[32:35], s69 offen offset:640
 buffer_load_dwordx4 v[88:91], v40, s[32:35], s69 offen offset:768
 buffer_load_dwordx4 v[92:95], v40, s[32:35], s69 offen offset:896
 s_and_b32 s70, s31, 7
 s_mov_b32 s55, 0x20000
 s_mul_i32 s72, s3, 224
 s_lshl_b32 s67, s62, 5
 s_mul_i32 s68, s62, 192
 s_add_u32 s73, s72, 192
 s_sub_u32 s73, s73, s68
 s_add_u32 s72, s72, s67
 s_cmp_lt_u32 s60, 2
 s_cbranch_scc0 Lt2_2
 v_mul_u32_u24 v4, 57, v255
 v_lshrrev_b32 v4, 10, v4
 v_mul_u32_u24 v5, 18, v4
 v_sub_u32 v5, v255, v5
 v_lshl_add_u32 v5, v5, 3, s70
 s_cmp_eq_u32 s60, 0
 s_cbranch_scc0 Lt1_1
 v_mul_u32_u24 v5, 3584, v5
 v_lshl_add_u32 v5, v4, 7, v5
 s_lshl_b32 s79, s72, 1
 s_mov_b32 s54, 1835008
 s_mov_b32 exec_hi, 0x3fffff
 s_mov_b64 s[52:53], s[16:17]
 s_branch Ltgo_4
Lt1_1:
 v_lshlrev_b32_e64 v5, 10, v5
 s_lshl_b32 s79, s3, 7
 s_mov_b32 s54, 524288
 s_mov_b64 exec, 0x3ffff
 s_mov_b64 s[52:53], s[6:7]
 s_branch Ltgo_4
Lt2_2:
 v_lshlrev_b32 v5, 7, v255
 s_cmp_eq_u32 s60, 2
 s_cbranch_scc0 Lt3_3
 s_lshl_b32 s79, s70, 11
 s_mov_b32 s54, 16384
 s_mov_b64 exec, 0xffff
 s_cmp_eq_u32 s62, 0
 s_cselect_b32 s52, s8, s10
 s_cselect_b32 s53, s9, s11
 s_branch Ltgo_4
Lt3_3:
 s_lshr_b32 s79, s2, 3
 s_nop 0
 s_mul_i32 s79, s79, 1664
 s_mov_b32 s54, LEND-LSTART
 s_mov_b64 exec, 0x1fff
 s_getpc_b64 s[52:53]
LPC:
 s_sub_u32 s52, s52, LPC-LSTART
 s_subb_u32 s53, s53, 0
Ltgo_4:
 buffer_load_dword v254, v5, s[52:55], s79 offen
 s_mov_b64 exec, -1
 s_mov_b32 s44, s26
 s_mov_b32 s45, s27
 s_mov_b32 s46, 256
 s_mov_b32 s47, 0x20000
 s_mov_b32 s52, s16
 s_mov_b32 s53, s17
 s_mov_b32 s54, 1835008
 s_mov_b32 s55, 0x20000
 s_mov_b32 s40, s28
 s_mov_b32 s41, s29
 s_mov_b32 s42, 33554432
 s_mov_b32 s43, 0x20000
 s_mov_b32 s48, s20
 s_mov_b32 s49, s21
 s_mov_b32 s50, 1835008
 s_mov_b32 s51, 0x20000
 s_mov_b32 s36, s12
 s_mov_b32 s37, s13
 s_mov_b32 s38, 524288
 s_mov_b32 s39, 0x20000
 s_mov_b32 s56, s18
 s_mov_b32 s57, s19
 s_mov_b32 s58, 3584
 s_mov_b32 s59, 0x20000
 v_mov_b32 v41, 0
 v_mov_b32 v232, 0
 v_mov_b32 v236, 0
 v_mov_b32 v198, 0
 v_mov_b32 v39, 0
 s_waitcnt vmcnt(1)
LLN:
 v_mov_b32 v4, 0
 v_mov_b32 v5, 0
 v_mov_b32 v6, 0
 v_mov_b32_e64 v7, 0
 v_dot2_f32_bf16 v4, v64, s74, v4
 v_dot2_f32_bf16 v6, v64, v64, v6
 v_dot2_f32_bf16 v5, v65, s74, v5
 v_dot2_f32_bf16 v7, v65, v65, v7
 v_dot2_f32_bf16 v4, v66, s74, v4
 v_dot2_f32_bf16 v6, v66, v66, v6
 v_dot2_f32_bf16 v5, v67, s74, v5
 v_dot2_f32_bf16 v7, v67, v67, v7
 v_dot2_f32_bf16 v4, v68, s74, v4
 v_dot2_f32_bf16 v6, v68, v68, v6
 v_dot2_f32_bf16 v5, v69, s74, v5
 v_dot2_f32_bf16 v7, v69, v69, v7
 v_dot2_f32_bf16 v4, v70, s74, v4
 v_dot2_f32_bf16 v6, v70, v70, v6
 v_dot2_f32_bf16 v5, v71, s74, v5
 v_dot2_f32_bf16 v7, v71, v71, v7
 v_dot2_f32_bf16 v4, v72, s74, v4
 v_dot2_f32_bf16 v6, v72, v72, v6
 v_dot2_f32_bf16 v5, v73, s74, v5
 v_dot2_f32_bf16 v7, v73, v73, v7
 v_dot2_f32_bf16 v4, v74, s74, v4
 v_dot2_f32_bf16 v6, v74, v74, v6
 v_dot2_f32_bf16 v5, v75, s74, v5
 v_dot2_f32_bf16 v7, v75, v75, v7
 v_dot2_f32_bf16 v4, v76, s74, v4
 v_dot2_f32_bf16 v6, v76, v76, v6
 v_dot2_f32_bf16 v5, v77, s74, v5
 v_dot2_f32_bf16 v7, v77, v77, v7
 v_dot2_f32_bf16 v4, v78, s74, v4
 v_dot2_f32_bf16 v6, v78, v78, v6
 v_dot2_f32_bf16 v5, v79, s74, v5
 v_dot2_f32_bf16 v7, v79, v79, v7
 v_dot2_f32_bf16 v4, v80, s74, v4
 v_dot2_f32_bf16 v6, v80, v80, v6
 v_dot2_f32_bf16 v5, v81, s74, v5
 v_dot2_f32_bf16 v7, v81, v81, v7
 v_dot2_f32_bf16 v4, v82, s74, v4
 v_dot2_f32_bf16 v6, v82, v82, v6
 v_dot2_f32_bf16 v5, v83, s74, v5
 v_dot2_f32_bf16 v7, v83, v83, v7
 v_dot2_f32_bf16 v4, v84, s74, v4
 v_dot2_f32_bf16 v6, v84, v84, v6
 v_dot2_f32_bf16 v5, v85, s74, v5
 v_dot2_f32_bf16 v7, v85, v85, v7
 v_dot2_f32_bf16 v4, v86, s74, v4
 v_dot2_f32_bf16 v6, v86, v86, v6
 v_dot2_f32_bf16 v5, v87, s74, v5
 v_dot2_f32_bf16 v7, v87, v87, v7
 v_dot2_f32_bf16 v4, v88, s74, v4
 v_dot2_f32_bf16 v6, v88, v88, v6
 v_dot2_f32_bf16 v5, v89, s74, v5
 v_dot2_f32_bf16 v7, v89, v89, v7
 v_dot2_f32_bf16 v4, v90, s74, v4
 v_dot2_f32_bf16 v6, v90, v90, v6
 v_dot2_f32_bf16 v5, v91, s74, v5
 v_dot2_f32_bf16 v7, v91, v91, v7
 v_dot2_f32_bf16 v4, v92, s74, v4
 v_dot2_f32_bf16 v6, v92, v92, v6
 v_dot2_f32_bf16 v5, v93, s74, v5
 v_dot2_f32_bf16 v7, v93, v93, v7
 v_dot2_f32_bf16 v4, v94, s74, v4
 v_dot2_f32_bf16 v6, v94, v94, v6
 v_dot2_f32_bf16 v5, v95, s74, v5
 v_dot2_f32_bf16 v7, v95, v95, v7
 s_nop 2
 v_add_f32 v4, v4, v5
 v_add_f32 v6, v6, v7
 s_nop 0
 v_add_f32_dpp v4, v4, v4 quad_perm:[1,0,3,2] row_mask:0xf bank_mask:0xf
 v_add_f32_dpp v6, v6, v6 quad_perm:[1,0,3,2] row_mask:0xf bank_mask:0xf
 s_nop 0
 v_add_f32_dpp v4, v4, v4 quad_perm:[2,3,0,1] row_mask:0xf bank_mask:0xf
 v_add_f32_dpp v6, v6, v6 quad_perm:[2,3,0,1] row_mask:0xf bank_mask:0xf
 s_nop 0
 v_add_f32_dpp v4, v4, v4 row_half_mirror row_mask:0xf bank_mask:0xf
 v_add_f32_dpp v6, v6, v6 row_half_mirror row_mask:0xf bank_mask:0xf
 v_mul_f32 v4, 0x3b000000, v4
 v_mul_f32 v6, 0x3b000000, v6
 v_fma_f32 v6, -v4, v4, v6
 v_max_f32_e64 v6, 0, v6
 v_add_f32 v6, 0x3727c5ac, v6
 v_rsq_f32 v8, v6
 s_nop 0
 v_mul_f32 v10, v4, v8
 v_mov_b32 v9, v8
 v_sub_f32 v10, 0, v10
 v_mov_b32 v11, v10
 v_lshlrev_b32_e64 v12, 16, v64
 v_and_b32 v13, 0xffff0000, v64
 v_lshlrev_b32_e64 v14, 16, v65
 v_and_b32 v15, 0xffff0000, v65
 v_lshlrev_b32_e64 v16, 16, v66
 v_and_b32 v17, 0xffff0000, v66
 v_lshlrev_b32_e64 v18, 16, v67
 v_and_b32 v19, 0xffff0000, v67
 v_pk_fma_f32 v[12:13], v[12:13], v[8:9], v[10:11]
 v_pk_fma_f32 v[14:15], v[14:15], v[8:9], v[10:11]
 v_pk_fma_f32 v[16:17], v[16:17], v[8:9], v[10:11]
 v_pk_fma_f32 v[18:19], v[18:19], v[8:9], v[10:11]
 v_cvt_pk_bf16_f32 v64, v12, v13
 v_cvt_pk_bf16_f32 v65, v14, v15
 v_cvt_pk_bf16_f32 v66, v16, v17
 v_cvt_pk_bf16_f32 v67, v18, v19
 ds_write_b128 v48, v[64:67] offset:0
 v_lshlrev_b32_e64 v20, 16, v68
 v_and_b32 v21, 0xffff0000, v68
 v_lshlrev_b32_e64 v22, 16, v69
 v_and_b32 v23, 0xffff0000, v69
 v_lshlrev_b32_e64 v24, 16, v70
 v_and_b32 v25, 0xffff0000, v70
 v_lshlrev_b32_e64 v26, 16, v71
 v_and_b32 v27, 0xffff0000, v71
 v_pk_fma_f32 v[20:21], v[20:21], v[8:9], v[10:11]
 v_pk_fma_f32 v[22:23], v[22:23], v[8:9], v[10:11]
 v_pk_fma_f32 v[24:25], v[24:25], v[8:9], v[10:11]
 v_pk_fma_f32 v[26:27], v[26:27], v[8:9], v[10:11]
 v_cvt_pk_bf16_f32 v68, v20, v21
 v_cvt_pk_bf16_f32 v69, v22, v23
 v_cvt_pk_bf16_f32 v70, v24, v25
 v_cvt_pk_bf16_f32 v71, v26, v27
 ds_write_b128 v48, v[68:71] offset:128
 v_lshlrev_b32_e64 v12, 16, v72
 v_and_b32 v13, 0xffff0000, v72
 v_lshlrev_b32_e64 v14, 16, v73
 v_and_b32 v15, 0xffff0000, v73
 v_lshlrev_b32_e64 v16, 16, v74
 v_and_b32 v17, 0xffff0000, v74
 v_lshlrev_b32_e64 v18, 16, v75
 v_and_b32 v19, 0xffff0000, v75
 v_pk_fma_f32 v[12:13], v[12:13], v[8:9], v[10:11]
 v_pk_fma_f32 v[14:15], v[14:15], v[8:9], v[10:11]
 v_pk_fma_f32 v[16:17], v[16:17], v[8:9], v[10:11]
 v_pk_fma_f32 v[18:19], v[18:19], v[8:9], v[10:11]
 v_cvt_pk_bf16_f32 v72, v12, v13
 v_cvt_pk_bf16_f32 v73, v14, v15
 v_cvt_pk_bf16_f32 v74, v16, v17
 v_cvt_pk_bf16_f32 v75, v18, v19
 ds_write_b128 v48, v[72:75] offset:256
 v_lshlrev_b32_e64 v20, 16, v76
 v_and_b32 v21, 0xffff0000, v76
 v_lshlrev_b32_e64 v22, 16, v77
 v_and_b32 v23, 0xffff0000, v77
 v_lshlrev_b32_e64 v24, 16, v78
 v_and_b32 v25, 0xffff0000, v78
 v_lshlrev_b32_e64 v26, 16, v79
 v_and_b32 v27, 0xffff0000, v79
 v_pk_fma_f32 v[20:21], v[20:21], v[8:9], v[10:11]
 v_pk_fma_f32 v[22:23], v[22:23], v[8:9], v[10:11]
 v_pk_fma_f32 v[24:25], v[24:25], v[8:9], v[10:11]
 v_pk_fma_f32 v[26:27], v[26:27], v[8:9], v[10:11]
 v_cvt_pk_bf16_f32 v76, v20, v21
 v_cvt_pk_bf16_f32 v77, v22, v23
 v_cvt_pk_bf16_f32 v78, v24, v25
 v_cvt_pk_bf16_f32 v79, v26, v27
 ds_write_b128 v48, v[76:79] offset:384
 v_lshlrev_b32_e64 v12, 16, v80
 v_and_b32 v13, 0xffff0000, v80
 v_lshlrev_b32_e64 v14, 16, v81
 v_and_b32 v15, 0xffff0000, v81
 v_lshlrev_b32_e64 v16, 16, v82
 v_and_b32 v17, 0xffff0000, v82
 v_lshlrev_b32_e64 v18, 16, v83
 v_and_b32 v19, 0xffff0000, v83
 v_pk_fma_f32 v[12:13], v[12:13], v[8:9], v[10:11]
 v_pk_fma_f32 v[14:15], v[14:15], v[8:9], v[10:11]
 v_pk_fma_f32 v[16:17], v[16:17], v[8:9], v[10:11]
 v_pk_fma_f32 v[18:19], v[18:19], v[8:9], v[10:11]
 v_cvt_pk_bf16_f32 v80, v12, v13
 v_cvt_pk_bf16_f32 v81, v14, v15
 v_cvt_pk_bf16_f32 v82, v16, v17
 v_cvt_pk_bf16_f32 v83, v18, v19
 ds_write_b128 v48, v[80:83] offset:512
 v_lshlrev_b32_e64 v20, 16, v84
 v_and_b32 v21, 0xffff0000, v84
 v_lshlrev_b32_e64 v22, 16, v85
 v_and_b32 v23, 0xffff0000, v85
 v_lshlrev_b32_e64 v24, 16, v86
 v_and_b32 v25, 0xffff0000, v86
 v_lshlrev_b32_e64 v26, 16, v87
 v_and_b32 v27, 0xffff0000, v87
 v_pk_fma_f32 v[20:21], v[20:21], v[8:9], v[10:11]
 v_pk_fma_f32 v[22:23], v[22:23], v[8:9], v[10:11]
 v_pk_fma_f32 v[24:25], v[24:25], v[8:9], v[10:11]
 v_pk_fma_f32 v[26:27], v[26:27], v[8:9], v[10:11]
 v_cvt_pk_bf16_f32 v84, v20, v21
 v_cvt_pk_bf16_f32 v85, v22, v23
 v_cvt_pk_bf16_f32 v86, v24, v25
 v_cvt_pk_bf16_f32 v87, v26, v27
 ds_write_b128 v48, v[84:87] offset:640
 v_lshlrev_b32_e64 v12, 16, v88
 v_and_b32 v13, 0xffff0000, v88
 v_lshlrev_b32_e64 v14, 16, v89
 v_and_b32 v15, 0xffff0000, v89
 v_lshlrev_b32_e64 v16, 16, v90
 v_and_b32 v17, 0xffff0000, v90
 v_lshlrev_b32_e64 v18, 16, v91
 v_and_b32 v19, 0xffff0000, v91
 v_pk_fma_f32 v[12:13], v[12:13], v[8:9], v[10:11]
 v_pk_fma_f32 v[14:15], v[14:15], v[8:9], v[10:11]
 v_pk_fma_f32 v[16:17], v[16:17], v[8:9], v[10:11]
 v_pk_fma_f32 v[18:19], v[18:19], v[8:9], v[10:11]
 v_cvt_pk_bf16_f32 v88, v12, v13
 v_cvt_pk_bf16_f32 v89, v14, v15
 v_cvt_pk_bf16_f32 v90, v16, v17
 v_cvt_pk_bf16_f32 v91, v18, v19
 ds_write_b128 v48, v[88:91] offset:768
 v_lshlrev_b32_e64 v20, 16, v92
 v_and_b32 v21, 0xffff0000, v92
 v_lshlrev_b32_e64 v22, 16, v93
 v_and_b32 v23, 0xffff0000, v93
 v_lshlrev_b32_e64 v24, 16, v94
 v_and_b32 v25, 0xffff0000, v94
 v_lshlrev_b32_e64 v26, 16, v95
 v_and_b32 v27, 0xffff0000, v95
 v_pk_fma_f32 v[20:21], v[20:21], v[8:9], v[10:11]
 v_pk_fma_f32 v[22:23], v[22:23], v[8:9], v[10:11]
 v_pk_fma_f32 v[24:25], v[24:25], v[8:9], v[10:11]
 v_pk_fma_f32 v[26:27], v[26:27], v[8:9], v[10:11]
 v_cvt_pk_bf16_f32 v92, v20, v21
 v_cvt_pk_bf16_f32 v93, v22, v23
 v_cvt_pk_bf16_f32 v94, v24, v25
 v_cvt_pk_bf16_f32 v95, v26, v27
 ds_write_b128 v48, v[92:95] offset:896
 s_cmp_lt_u32 s30, 4
 s_cbranch_scc0 LG2
 s_waitcnt lgkmcnt(0)
 s_barrier
 v_lshlrev_b32 v241, 4, v255
 v_lshrrev_b32 v2, 2, v255
 v_mul_u32_u24 v198, 3584, v2
 v_and_b32_e64 v2, 3, v255
 v_lshl_add_u32 v198, v2, 4, v198
 v_mov_b32 v253, 140288
 v_mov_b32_e64 v249, 0
 s_mov_b32 s79, 589824
 s_cmp_eq_u32 s30, 3
 s_cbranch_scc0 Lp1_5
 s_setprio 2
 v_and_b32 v28, 15, v255
 v_lshrrev_b32 v29, 4, v255
 s_lshr_b32 s69, s3, 1
 s_lshl_b32 s67, s69, 4
 v_add_u32 v5, s67, v28
 v_mul_u32_u24 v2, 1040, v5
 v_lshl_add_u32 v2, v29, 4, v2
 v_and_b32 v21, 1, v29
 v_lshrrev_b32 v22, 1, v29
 v_lshlrev_b32_e64 v30, 3, v28
 v_lshl_add_u32 v30, v21, 7, v30
 v_lshl_add_u32 v30, v22, 9, v30
 v_add_u32 v30, 140544, v30
 buffer_load_dwordx2 v[36:37], v249, s[44:47], 0 offen sc1
 ds_read_b128 v[64:67], v2 offset:0
 ds_read_b64_tr_b16 v[68:69], v30 offset:0
 ds_read_b64_tr_b16 v[70:71], v30 offset:256
 ds_read_b128 v[72:75], v2 offset:64
 ds_read_b64_tr_b16 v[76:77], v30 offset:1024
 ds_read_b64_tr_b16 v[78:79], v30 offset:1280
 ds_read_b128 v[80:83], v2 offset:128
 ds_read_b64_tr_b16 v[84:85], v30 offset:2048
 ds_read_b64_tr_b16 v[86:87], v30 offset:2304
 ds_read_b128 v[88:91], v2 offset:192
 ds_read_b64_tr_b16 v[92:93], v30 offset:3072
 ds_read_b64_tr_b16 v[94:95], v30 offset:3328
 ds_read_b128 v[96:99], v2 offset:256
 ds_read_b64_tr_b16 v[100:101], v30 offset:4096
 ds_read_b64_tr_b16 v[102:103], v30 offset:4352
 s_cmp_eq_u32 s62, 0
 s_cbranch_scc0 Lvt_6
 s_waitcnt lgkmcnt(12)
 s_nop 0
 ds_read_b128 v[104:107], v2 offset:320
 ds_read_b64_tr_b16 v[108:109], v30 offset:5120
 ds_read_b64_tr_b16 v[110:111], v30 offset:5376
 v_mfma_f32_16x16x32_bf16 v[224:227], v[68:71], v[64:67], 0
 s_waitcnt lgkmcnt(12)
 s_nop 0
 ds_read_b128 v[64:67], v2 offset:384
 ds_read_b64_tr_b16 v[68:69], v30 offset:6144
 ds_read_b64_tr_b16 v[70:71], v30 offset:6400
 v_mfma_f32_16x16x32_bf16 v[224:227], v[76:79], v[72:75], v[224:227]
 s_waitcnt lgkmcnt(12)
 s_nop 0
 ds_read_b128 v[72:75], v2 offset:448
 ds_read_b64_tr_b16 v[76:77], v30 offset:7168
 ds_read_b64_tr_b16 v[78:79], v30 offset:7424
 v_mfma_f32_16x16x32_bf16 v[224:227], v[84:87], v[80:83], v[224:227]
 s_waitcnt lgkmcnt(12)
 s_nop 0
 ds_read_b128 v[80:83], v2 offset:512
 ds_read_b64_tr_b16 v[84:85], v30 offset:8192
 ds_read_b64_tr_b16 v[86:87], v30 offset:8448
 v_mfma_f32_16x16x32_bf16 v[224:227], v[92:95], v[88:91], v[224:227]
 s_waitcnt lgkmcnt(12)
 s_nop 0
 ds_read_b128 v[88:91], v2 offset:576
 ds_read_b64_tr_b16 v[92:93], v30 offset:9216
 ds_read_b64_tr_b16 v[94:95], v30 offset:9472
 v_mfma_f32_16x16x32_bf16 v[224:227], v[100:103], v[96:99], v[224:227]
 s_waitcnt lgkmcnt(12)
 s_nop 0
 ds_read_b128 v[96:99], v2 offset:640
 ds_read_b64_tr_b16 v[100:101], v30 offset:10240
 ds_read_b64_tr_b16 v[102:103], v30 offset:10496
 v_mfma_f32_16x16x32_bf16 v[224:227], v[108:111], v[104:107], v[224:227]
 s_waitcnt lgkmcnt(12)
 s_nop 0
 ds_read_b128 v[104:107], v2 offset:704
 ds_read_b64_tr_b16 v[108:109], v30 offset:11264
 ds_read_b64_tr_b16 v[110:111], v30 offset:11520
 v_mfma_f32_16x16x32_bf16 v[224:227], v[68:71], v[64:67], v[224:227]
 s_waitcnt lgkmcnt(12)
 s_nop 0
 ds_read_b128 v[64:67], v2 offset:768
 ds_read_b64_tr_b16 v[68:69], v30 offset:12288
 ds_read_b64_tr_b16 v[70:71], v30 offset:12544
 v_mfma_f32_16x16x32_bf16 v[224:227], v[76:79], v[72:75], v[224:227]
 s_waitcnt lgkmcnt(12)
 s_nop 0
 ds_read_b128 v[72:75], v2 offset:832
 ds_read_b64_tr_b16 v[76:77], v30 offset:13312
 ds_read_b64_tr_b16 v[78:79], v30 offset:13568
 v_mfma_f32_16x16x32_bf16 v[224:227], v[84:87], v[80:83], v[224:227]
 s_waitcnt lgkmcnt(12)
 s_nop 0
 ds_read_b128 v[80:83], v2 offset:896
 ds_read_b64_tr_b16 v[84:85], v30 offset:14336
 ds_read_b64_tr_b16 v[86:87], v30 offset:14592
 v_mfma_f32_16x16x32_bf16 v[224:227], v[92:95], v[88:91], v[224:227]
 s_waitcnt lgkmcnt(12)
 s_nop 0
 ds_read_b128 v[88:91], v2 offset:960
 ds_read_b64_tr_b16 v[92:93], v30 offset:15360
 ds_read_b64_tr_b16 v[94:95], v30 offset:15616
 v_mfma_f32_16x16x32_bf16 v[224:227], v[100:103], v[96:99], v[224:227]
 s_waitcnt lgkmcnt(12)
 v_mfma_f32_16x16x32_bf16 v[224:227], v[108:111], v[104:107], v[224:227]
 s_waitcnt lgkmcnt(9)
 v_mfma_f32_16x16x32_bf16 v[224:227], v[68:71], v[64:67], v[224:227]
 s_waitcnt lgkmcnt(6)
 v_mfma_f32_16x16x32_bf16 v[224:227], v[76:79], v[72:75], v[224:227]
 s_waitcnt lgkmcnt(3)
 v_mfma_f32_16x16x32_bf16 v[224:227], v[84:87], v[80:83], v[224:227]
 s_waitcnt lgkmcnt(0)
 v_mfma_f32_16x16x32_bf16 v[224:227], v[92:95], v[88:91], v[224:227]
 s_nop 3
 s_lshl_b32 s67, s31, 1
 s_lshr_b32 s68, s69, 1
 s_add_u32 s67, s67, s68
 s_mul_i32 s67, s67, 2176
 s_and_b32 s68, s69, 1
 s_lshl_b32 s68, s68, 8
 s_add_u32 s67, s67, s68
 v_lshlrev_b32_e64 v20, 4, v28
 v_cvt_pk_bf16_f32 v16, v224, v225
 v_cvt_pk_bf16_f32 v17, v226, v227
 v_lshl_add_u32 v23, v21, 9, v20
 v_lshl_add_u32 v23, v22, 3, v23
 buffer_store_dwordx2 v[16:17], v23, s[40:43], s67 offen sc1
 v_mul_f32_e64 v26, v224, v224
 v_fma_f32 v26, v225, v225, v26
 v_fma_f32 v26, v226, v226, v26
 v_fma_f32 v26, v227, v227, v26
 v_mov_b32 v25, v26
 s_nop 1
 v_permlane32_swap_b32 v25, v26
 s_nop 1
 v_add_f32_e64 v26, v25, v26
 s_branch Lkvd_7
Lvt_6:
 s_waitcnt lgkmcnt(12)
 ds_read_b128 v[104:107], v2 offset:320
 ds_read_b64_tr_b16 v[108:109], v30 offset:5120
 ds_read_b64_tr_b16 v[110:111], v30 offset:5376
 v_mfma_f32_16x16x32_bf16 v[224:227], v[64:67], v[68:71], 0
 s_waitcnt lgkmcnt(12)
 s_nop 0
 ds_read_b128 v[64:67], v2 offset:384
 ds_read_b64_tr_b16 v[68:69], v30 offset:6144
 ds_read_b64_tr_b16 v[70:71], v30 offset:6400
 v_mfma_f32_16x16x32_bf16 v[224:227], v[72:75], v[76:79], v[224:227]
 s_waitcnt lgkmcnt(12)
 s_nop 0
 ds_read_b128 v[72:75], v2 offset:448
 ds_read_b64_tr_b16 v[76:77], v30 offset:7168
 ds_read_b64_tr_b16 v[78:79], v30 offset:7424
 v_mfma_f32_16x16x32_bf16 v[224:227], v[80:83], v[84:87], v[224:227]
 s_waitcnt lgkmcnt(12)
 s_nop 0
 ds_read_b128 v[80:83], v2 offset:512
 ds_read_b64_tr_b16 v[84:85], v30 offset:8192
 ds_read_b64_tr_b16 v[86:87], v30 offset:8448
 v_mfma_f32_16x16x32_bf16 v[224:227], v[88:91], v[92:95], v[224:227]
 s_waitcnt lgkmcnt(12)
 s_nop 0
 ds_read_b128 v[88:91], v2 offset:576
 ds_read_b64_tr_b16 v[92:93], v30 offset:9216
 ds_read_b64_tr_b16 v[94:95], v30 offset:9472
 v_mfma_f32_16x16x32_bf16 v[224:227], v[96:99], v[100:103], v[224:227]
 s_waitcnt lgkmcnt(12)
 s_nop 0
 ds_read_b128 v[96:99], v2 offset:640
 ds_read_b64_tr_b16 v[100:101], v30 offset:10240
 ds_read_b64_tr_b16 v[102:103], v30 offset:10496
 v_mfma_f32_16x16x32_bf16 v[224:227], v[104:107], v[108:111], v[224:227]
 s_waitcnt lgkmcnt(12)
 s_nop 0
 ds_read_b128 v[104:107], v2 offset:704
 ds_read_b64_tr_b16 v[108:109], v30 offset:11264
 ds_read_b64_tr_b16 v[110:111], v30 offset:11520
 v_mfma_f32_16x16x32_bf16 v[224:227], v[64:67], v[68:71], v[224:227]
 s_waitcnt lgkmcnt(12)
 s_nop 0
 ds_read_b128 v[64:67], v2 offset:768
 ds_read_b64_tr_b16 v[68:69], v30 offset:12288
 ds_read_b64_tr_b16 v[70:71], v30 offset:12544
 v_mfma_f32_16x16x32_bf16 v[224:227], v[72:75], v[76:79], v[224:227]
 s_waitcnt lgkmcnt(12)
 s_nop 0
 ds_read_b128 v[72:75], v2 offset:832
 ds_read_b64_tr_b16 v[76:77], v30 offset:13312
 ds_read_b64_tr_b16 v[78:79], v30 offset:13568
 v_mfma_f32_16x16x32_bf16 v[224:227], v[80:83], v[84:87], v[224:227]
 s_waitcnt lgkmcnt(12)
 s_nop 0
 ds_read_b128 v[80:83], v2 offset:896
 ds_read_b64_tr_b16 v[84:85], v30 offset:14336
 ds_read_b64_tr_b16 v[86:87], v30 offset:14592
 v_mfma_f32_16x16x32_bf16 v[224:227], v[88:91], v[92:95], v[224:227]
 s_waitcnt lgkmcnt(12)
 s_nop 0
 ds_read_b128 v[88:91], v2 offset:960
 ds_read_b64_tr_b16 v[92:93], v30 offset:15360
 ds_read_b64_tr_b16 v[94:95], v30 offset:15616
 v_mfma_f32_16x16x32_bf16 v[224:227], v[96:99], v[100:103], v[224:227]
 s_waitcnt lgkmcnt(12)
 v_mfma_f32_16x16x32_bf16 v[224:227], v[104:107], v[108:111], v[224:227]
 s_waitcnt lgkmcnt(9)
 v_mfma_f32_16x16x32_bf16 v[224:227], v[64:67], v[68:71], v[224:227]
 s_waitcnt lgkmcnt(6)
 v_mfma_f32_16x16x32_bf16 v[224:227], v[72:75], v[76:79], v[224:227]
 s_waitcnt lgkmcnt(3)
 v_mfma_f32_16x16x32_bf16 v[224:227], v[80:83], v[84:87], v[224:227]
 s_waitcnt lgkmcnt(0)
 v_mfma_f32_16x16x32_bf16 v[224:227], v[88:91], v[92:95], v[224:227]
 s_nop 3
 s_lshl_b32 s67, s31, 1
 s_lshr_b32 s68, s69, 1
 s_add_u32 s67, s67, s68
 s_mul_i32 s67, s67, 2176
 s_and_b32 s68, s69, 1
 s_lshl_b32 s68, s68, 4
 s_add_u32 s70, s67, s68
 s_and_b32 s68, s69, 1
 s_lshl_b32 s68, s68, 9
 s_add_u32 s67, s67, s68
 v_lshlrev_b32 v20, 4, v28
 v_cvt_pk_bf16_f32 v16, v224, v225
 v_cvt_pk_bf16_f32 v17, v226, v227
 v_lshl_add_u32 v23, v22, 8, v20
 v_lshl_add_u32 v23, v21, 3, v23
 buffer_store_dwordx2 v[16:17], v23, s[40:43], s67 offen offset:1024 sc1
 v_mov_b32 v24, 0x3f803f80
 v_lshlrev_b32 v25, 2, v255
 s_mov_b64 exec, 15
 buffer_store_dword v24, v25, s[40:43], s70 offen offset:2048 sc1
 s_mov_b64 exec, -1
 s_nop 0
 v_max3_f32 v27, abs(v224), abs(v225), abs(v226)
 v_max_f32 v27, abs(v227), v27
 v_mov_b32 v25, 0x7e000000
 v_cmp_lt_f32 vcc, 0x49800000, v27
 s_nop 1
 v_cndmask_b32 v26, 0, v25, vcc
 v_mov_b32 v25, v26
 s_nop 1
 v_permlane32_swap_b32 v25, v26
 s_nop 1
 v_max_u32 v26, v25, v26
Lkvd_7:
 v_mov_b32 v25, v26
 s_nop 1
 v_permlane16_swap_b32 v25, v26
 s_nop 1
 v_add_f32 v26, v25, v26
 s_nop 1
 v_max_u32_dpp v26, v26, v26 row_shr:1 row_mask:0xf bank_mask:0xf
 s_nop 1
 v_max_u32_dpp v26, v26, v26 row_shr:2 row_mask:0xf bank_mask:0xf
 s_nop 1
 v_max_u32_dpp v26, v26, v26 row_shr:4 row_mask:0xf bank_mask:0xf
 s_nop 1
 v_max_u32_dpp v26, v26, v26 row_shr:8 row_mask:0xf bank_mask:0xf
 s_setprio 0
 v_mov_b32 v20, 1
 s_mov_b64 exec, 1
 ds_add_u32 v253, v20 offset:24
 s_mov_b64 exec, -1
 s_lshl_b32 s67, s31, 3
 s_add_u32 s67, s67, s3
 s_lshl_b32 s67, s67, 4
 s_add_u32 s67, s67, 589824
 v_mov_b32 v27, 0
 s_waitcnt vmcnt(0)
 v_cmp_eq_u32 vcc, 0, v36
 s_cbranch_vccz Lhavetag_8
 v_mov_b32 v38, 0
 s_mov_b32 s70, 0
Ltag_9:
 buffer_load_dwordx2 v[36:37], v38, s[44:47], 0 offen sc1
 s_add_u32 s70, s70, 1
 s_waitcnt vmcnt(0)
 v_readfirstlane_b32 s0, v36
 v_readfirstlane_b32 s1, v37
 s_cmp_gt_u32 s70, 200000
 s_cbranch_scc1 Ltagd_10
 s_cmp_lg_u32 s0, 0
 s_cbranch_scc1 Ltagd_10
 s_sleep 2
 s_branch Ltag_9
Ltagd_10:
Lhavetag_8:
 v_mov_b32 v24, v36
 v_mov_b32 v25, v37
 s_mov_b64 exec, 0x8000
 buffer_store_dwordx4 v[24:27], v27, s[40:43], s67 offen sc1
 s_mov_b64 exec, -1
Lp1_5:
 s_mul_i32 s71, s30, 34816
 v_mov_b32 v240, 0xdddddddd
 v_lshrrev_b32 v128, 1, v255
 v_lshlrev_b32 v128, 13, v128
 v_and_b32 v2, 1, v255
 v_lshl_add_u32 v128, v2, 7, v128
 v_lshlrev_b32 v129, 13, v255
 v_and_b32 v244, 15, v255
 v_lshrrev_b32_e64 v245, 5, v255
 v_lshl_add_u32 v244, v245, 4, v244
 v_lshlrev_b32_e64 v244, 4, v244
 v_mov_b32 v245, 0x7f000000
 v_and_b32 v246, 16, v255
 v_cmp_eq_u32 vcc, 0, v246
 v_and_b32 v246, 27, v255
 s_nop 0
 v_cndmask_b32 v244, v245, v244, vcc
 v_cmp_eq_u32 vcc, 16, v246
 v_mov_b32 v245, 1024
 v_mov_b32 v246, 528
 v_cndmask_b32 v242, v244, v245, vcc
 v_cndmask_b32 v243, v244, v246, vcc
 v_mov_b64 v[200:201], 0
 v_mov_b64 v[202:203], 0
 v_mov_b64 v[204:205], 0
 v_mov_b64 v[206:207], 0
 v_mov_b64 v[224:225], 0
 v_mov_b64 v[226:227], 0
 v_mov_b64 v[228:229], 0
 v_mov_b64 v[230:231], 0
 v_mov_b64 v[232:233], 0
 v_mov_b64 v[234:235], 0
 v_mov_b64 v[236:237], 0
 v_mov_b64 v[238:239], 0
 v_mov_b64 v[0:1], 0
 v_mov_b64 v[2:3], 0
 v_mov_b64 v[4:5], 0
 v_mov_b64 v[6:7], 0
 v_mov_b64 v[8:9], 0
 v_mov_b64 v[16:17], 0
 v_mov_b64 v[18:19], 0
 v_mov_b64 v[20:21], 0
 v_mov_b64 v[22:23], 0
 v_mov_b64 v[24:25], 0
 v_mov_b64 v[32:33], 0
 v_mov_b64 v[34:35], 0
 v_mov_b64 v[36:37], 0
 v_mov_b64 v[38:39], 0
 v_mov_b64 v[40:41], 0
 v_mov_b64 v[48:49], 0
 v_mov_b64 v[50:51], 0
 v_mov_b64 v[52:53], 0
 v_mov_b64 v[54:55], 0
 v_mov_b64 v[56:57], 0
 v_mov_b64 v[64:65], 0
 v_mov_b64 v[66:67], 0
 v_mov_b64 v[68:69], 0
 v_mov_b64 v[70:71], 0
 v_mov_b64 v[72:73], 0
 v_mov_b64 v[80:81], 0
 v_mov_b64 v[82:83], 0
 v_mov_b64 v[84:85], 0
 v_mov_b64 v[86:87], 0
 v_mov_b64 v[88:89], 0
 v_mov_b64 v[96:97], 0
 v_mov_b64 v[98:99], 0
 v_mov_b64 v[100:101], 0
 v_mov_b64 v[102:103], 0
 v_mov_b64 v[104:105], 0
 v_mov_b64 v[112:113], 0
 v_mov_b64 v[114:115], 0
 v_mov_b64 v[116:117], 0
 v_mov_b64_e64 v[118:119], 0
 v_mov_b64 v[120:121], 0
 s_add_u32 s67, s30, 1
 s_and_b32 s67, s67, 3
 s_lshl_b32 s68, s67, 11
 s_add_u32 s68, s68, 66560
 v_add_u32 v12, s68, v241
 s_add_u32 s67, s30, 2
 s_and_b32 s67, s67, 3
 s_lshl_b32 s68, s67, 11
 s_add_u32 s68, s68, 66560
 v_add_u32 v13, s68, v241
 s_add_u32 s67, s30, 3
 s_and_b32 s67, s67, 3
 s_lshl_b32 s68, s67, 11
 s_add_u32 s68, s68, 66560
 v_add_u32 v14, s68, v241
 s_add_u32 s67, s30, 4
 s_and_b32 s67, s67, 3
 s_lshl_b32 s68, s67, 11
 s_add_u32 s68, s68, 66560
 v_add_u32 v15, s68, v241
 s_mov_b32 s70, 0
Llp_11:
 ds_read_b32 v252, v253 offset:32
 s_add_u32 s70, s70, 1
 s_waitcnt lgkmcnt(0)
 v_cmp_gt_u32 vcc, 4, v252
 s_cmp_gt_u32 s70, 1600000
 s_cbranch_scc1 Llpd_12
 s_cbranch_vccz Llpd_12
 s_sleep 2
 s_branch Llp_11
Llpd_12:
 s_mov_b32 s63, 0
Lagain_13:
 s_cmp_eq_u32 s63, 0
 s_cbranch_scc0 Lnr3_15x
 s_mov_b32 s63, 1
 s_mov_b32 s76, 0
 s_cmp_eq_u32 s30, 3
 s_cbranch_scc0 Lnr3_15x
 s_lshl_b32 s66, s73, 1
 s_mov_b32 m0, 144640
 s_nop 0
 buffer_load_dwordx4 v198, s[52:55], s66 offen lds
 s_add_u32 s66, s66, 57344
 s_mov_b32 m0, 145664
 s_nop 0
 s_nop 0
 buffer_load_dwordx4 v198, s[52:55], s66 offen lds
 s_add_u32 s66, s66, 57344
 s_mov_b32 m0, 146688
 s_nop 0
 s_nop 0
 buffer_load_dwordx4 v198, s[52:55], s66 offen lds
 s_add_u32 s66, s66, 57344
 s_mov_b32 m0, 147712
 s_nop 0
 s_nop 0
 buffer_load_dwordx4 v198, s[52:55], s66 offen lds
 s_add_u32 s66, s66, 57344
 s_mov_b32 m0, 148736
 s_nop 0
 s_nop 0
 buffer_load_dwordx4 v198, s[52:55], s66 offen lds
 s_add_u32 s66, s66, 57344
 s_mov_b32 m0, 149760
 s_nop 0
 s_nop 0
 buffer_load_dwordx4 v198, s[52:55], s66 offen lds
 s_add_u32 s66, s66, 57344
 s_mov_b32 m0, 150784
 s_nop 0
 s_nop 0
 buffer_load_dwordx4 v198, s[52:55], s66 offen lds
 s_add_u32 s66, s66, 57344
 s_mov_b32 m0, 151808
 s_nop 0
 s_nop 0
 buffer_load_dwordx4 v198, s[52:55], s66 offen lds
 s_add_u32 s66, s66, 57344
Lnr3_15x:
 buffer_load_dwordx2 v[250:251], v249, s[44:47], 0 offen sc1
 buffer_load_dwordx4 v[208:211], v241, s[40:43], s79 offen offset:0 sc1
 buffer_load_dwordx4 v[212:215], v241, s[40:43], s79 offen offset:1024 sc1
 buffer_load_dwordx4 v[216:219], v241, s[40:43], s79 offen offset:2048 sc1
 buffer_load_dwordx4 v[220:223], v241, s[40:43], s79 offen offset:3072 sc1
 s_add_u32 s76, s76, 1
 s_waitcnt vmcnt(0)
 v_cmp_eq_u32 s[68:69], 0, v250
 v_cmp_ne_u64 vcc, v[208:209], v[250:251]
 s_or_b64 s[68:69], s[68:69], vcc
 v_cmp_ne_u64 vcc, v[212:213], v[250:251]
 s_or_b64 s[68:69], s[68:69], vcc
 v_cmp_ne_u64 vcc, v[216:217], v[250:251]
 s_or_b64 s[68:69], s[68:69], vcc
 v_cmp_ne_u64 vcc, v[220:221], v[250:251]
 s_or_b64 s[68:69], s[68:69], vcc
 s_mov_b64 vcc, s[68:69]
 s_cmp_gt_u32 s76, 200000
 s_cbranch_scc1 Lgo_14
 s_cbranch_vccz Lgo_14
 s_sleep 4
 s_branch Lagain_13
Lgo_14:
 s_lshr_b32 s67, s2, 3
 s_lshl_b32 s67, s67, 2
 s_add_u32 s67, s67, s30
 s_mul_i32 s67, s67, 1152
 v_lshlrev_b32_e64 v244, 7, v255
 buffer_load_dwordx4 v[160:163], v241, s[40:43], s71 offen sc1
 buffer_load_dwordx4 v[164:167], v242, s[40:43], s71 offen offset:1024 sc1
 buffer_load_dwordx4 v[168:171], v243, s[40:43], s71 offen offset:1536 sc1
 s_add_u32 s71, s71, 2176
 s_mov_b64 exec, 0x1ff
 buffer_load_dword v254, v244, s[40:43], s67 offen sc1
 s_mov_b64 exec, -1
 s_nop 0
 buffer_load_dwordx4 v[172:175], v241, s[40:43], s71 offen sc1
 buffer_load_dwordx4 v[176:179], v242, s[40:43], s71 offen offset:1024 sc1
 buffer_load_dwordx4 v[180:183], v243, s[40:43], s71 offen offset:1536 sc1
 s_add_u32 s71, s71, 2176
 buffer_load_dwordx4 v[184:187], v241, s[40:43], s71 offen sc1
 buffer_load_dwordx4 v[188:191], v242, s[40:43], s71 offen offset:1024 sc1
 buffer_load_dwordx4 v[192:195], v243, s[40:43], s71 offen offset:1536 sc1
 s_add_u32 s71, s71, 2176
 v_mov_b32 v252, 1
 s_mov_b64 exec, 1
 ds_add_u32 v253, v252 offset:36
 s_mov_b64 exec, -1
 s_cmp_eq_u32 s30, 3
 s_cbranch_scc0 Ln3_16
 ds_write_b32 v253, v252 offset:40
 s_and_b32 s67, s31, 7
 s_mul_i32 s68, s3, 224
 s_add_u32 s68, s68, s67
 s_lshl_b32 s68, s68, 10
 s_mov_b32 s70, 0
Llp_17:
 ds_read_b32 v252, v253 offset:36
 s_add_u32 s70, s70, 1
 s_waitcnt lgkmcnt(0)
 v_cmp_gt_u32 vcc, 4, v252
 s_cmp_gt_u32 s70, 1600000
 s_cbranch_scc1 Llpd_18
 s_cbranch_vccz Llpd_18
 s_sleep 1
 s_branch Llp_17
Llpd_18:
 s_mov_b32 exec_hi, 0xffffff
 buffer_load_dword v254, v128, s[48:51], s68 offen offset:0
 buffer_load_dword v254, v128, s[48:51], s68 offen offset:256
 buffer_load_dword v254, v128, s[48:51], s68 offen offset:512
 buffer_load_dword v254, v128, s[48:51], s68 offen offset:768
 s_lshl_b32 s67, s67, 10
 s_lshl_b32 s68, s3, 7
 s_add_u32 s67, s67, s68
 s_mov_b64 exec, -1
 buffer_load_dword v254, v129, s[36:39], s67 offen
 s_waitcnt vmcnt(5)
Ln3_16:
 v_max3_u32 v250, v210, v214, v218
 v_max_u32 v250, v250, v222
 s_nop 1
 v_max_u32_dpp v250, v250, v250 row_shr:1 row_mask:0xf bank_mask:0xf
 s_nop 1
 v_max_u32_dpp v250, v250, v250 row_shr:2 row_mask:0xf bank_mask:0xf
 s_nop 1
 v_max_u32_dpp v250, v250, v250 row_shr:4 row_mask:0xf bank_mask:0xf
 s_nop 1
 v_max_u32_dpp v250, v250, v250 row_shr:8 row_mask:0xf bank_mask:0xf
 s_nop 1
 v_max_u32_dpp v250, v250, v250 row_bcast:15 row_mask:0xf bank_mask:0xf
 s_nop 1
 v_max_u32_dpp v250, v250, v250 row_bcast:31 row_mask:0xf bank_mask:0xf
 s_nop 0
 v_readlane_b32 s77, v250, 63
 v_lshlrev_b32 v251, 2, v255
 s_add_u32 s67, s30, 1
 s_and_b32 s67, s67, 3
 s_mul_i32 s67, s67, 13824
 s_add_u32 s67, s67, 66560
 v_add_u32 v244, s67, v241
 v_add_u32 v245, s67, v251
 s_add_u32 s67, s30, 2
 s_and_b32 s67, s67, 3
 s_mul_i32 s67, s67, 13824
 s_add_u32 s67, s67, 71168
 v_add_u32 v246, s67, v241
 v_add_u32 v247, s67, v251
 s_add_u32 s67, s30, 3
 s_and_b32 s67, s67, 3
 s_mul_i32 s67, s67, 13824
 s_add_u32 s67, s67, 75776
 v_add_u32_e64 v248, s67, v241
 v_add_u32 v249, s67, v251
 s_mov_b32 s70, 0
Llp_19:
 ds_read_b32 v252, v253 offset:28
 s_add_u32 s70, s70, 1
 s_waitcnt lgkmcnt(0)
 v_cmp_gt_u32 vcc, 1, v252
 s_cmp_gt_u32 s70, 1600000
 s_cbranch_scc1 Llpd_20
 s_cbranch_vccz Llpd_20
 s_sleep 1
 s_branch Llp_19
Llpd_20:
 s_nop 0
 ds_read_b128 v[128:131], v12 offset:0
 ds_read_b128 v[132:135], v12 offset:1024
 ds_read_b128 v[136:139], v13 offset:0
 ds_read_b128 v[140:143], v13 offset:1024
 ds_read_b128 v[144:147], v14 offset:0
 ds_read_b128 v[148:151], v14 offset:1024
 ds_read_b128 v[152:155], v15 offset:0
 ds_read_b128 v[156:159], v15 offset:1024
 ds_read_b32 v250, v253 offset:0
 s_lshl_b32 s67, s30, 2
 v_add_u32 v11, s67, v253
 s_cmp_eq_u32 s30, 3
 s_cbranch_scc1 Lnw0_21
 s_waitcnt vmcnt(0)
Lnw0_21:
 s_mov_b32 s70, 0
Llp_22:
 ds_read_b32 v252, v11 offset:48
 s_add_u32 s70, s70, 1
 s_waitcnt lgkmcnt(0)
 v_cmp_gt_u32 vcc, 1, v252
 s_cmp_gt_u32 s70, 1600000
 s_cbranch_scc1 Llpd_23
 s_cbranch_vccz Llpd_23
 s_sleep 1
 s_branch Llp_22
Llpd_23:
 s_setprio 1
 s_mov_b32 s70, 4
 v_mfma_f32_32x32x16_bf16 v[208:223], v[160:163], v[128:131], 0
 v_mul_f32 v250, s77, v250
 v_cmp_nge_f32 vcc, 0x45f20000, v250
 s_cbranch_vccnz LSLOW
 s_nop 5
.p2align 6
LATT:
 v_smfmac_f32_32x32x32_bf16 v[112:127], v[200:203], v[224:231], v240
 v_exp_f32 v208, v208
 v_exp_f32 v209, v209
 v_exp_f32_e64 v210, v210
 v_smfmac_f32_32x32x32_bf16 v[112:127], v[204:207], v[232:239], v240
 v_exp_f32 v211, v211
 v_exp_f32 v212, v212
 v_exp_f32 v213, v213
 v_exp_f32 v214, v214
 v_exp_f32 v215, v215
 v_exp_f32 v216, v216
 v_exp_f32_e64 v217, v217
 v_mfma_f32_32x32x16_bf16 v[224:239], v[160:163], v[132:135], 0
 v_exp_f32 v218, v218
 v_exp_f32 v219, v219
 v_exp_f32 v220, v220
 v_exp_f32 v221, v221
 v_exp_f32 v222, v222
 v_exp_f32 v223, v223
 v_smfmac_f32_32x32x32_bf16 v[0:15], v[164:167], v[208:215], v240
 v_exp_f32 v224, v224
 v_exp_f32 v225, v225
 v_exp_f32_e64 v226, v226
 v_smfmac_f32_32x32x32_bf16 v[0:15], v[168:171], v[216:223], v240
 v_exp_f32 v227, v227
 v_exp_f32 v228, v228
 v_exp_f32 v229, v229
 v_exp_f32 v230, v230
 v_exp_f32 v231, v231
 v_exp_f32 v232, v232
 v_exp_f32_e64 v233, v233
 v_mfma_f32_32x32x16_bf16 v[208:223], v[160:163], v[136:139], 0
 v_exp_f32 v234, v234
 v_exp_f32 v235, v235
 v_exp_f32 v236, v236
 v_exp_f32 v237, v237
 v_exp_f32 v238, v238
 v_exp_f32 v239, v239
 v_smfmac_f32_32x32x32_bf16 v[16:31], v[164:167], v[224:231], v240
 v_exp_f32 v208, v208
 v_exp_f32 v209, v209
 v_exp_f32_e64 v210, v210
 v_smfmac_f32_32x32x32_bf16 v[16:31], v[168:171], v[232:239], v240
 v_exp_f32 v211, v211
 v_exp_f32 v212, v212
 v_exp_f32 v213, v213
 v_exp_f32 v214, v214
 v_exp_f32 v215, v215
 v_exp_f32 v216, v216
 v_exp_f32_e64 v217, v217
 v_mfma_f32_32x32x16_bf16 v[224:239], v[160:163], v[140:143], 0
 v_exp_f32 v218, v218
 v_exp_f32 v219, v219
 v_exp_f32 v220, v220
 v_exp_f32 v221, v221
 v_exp_f32 v222, v222
 v_exp_f32 v223, v223
 v_smfmac_f32_32x32x32_bf16 v[32:47], v[164:167], v[208:215], v240
 v_exp_f32 v224, v224
 v_exp_f32 v225, v225
 v_exp_f32_e64 v226, v226
 v_smfmac_f32_32x32x32_bf16 v[32:47], v[168:171], v[216:223], v240
 v_exp_f32 v227, v227
 v_exp_f32 v228, v228
 v_exp_f32 v229, v229
 v_exp_f32 v230, v230
 v_exp_f32 v231, v231
 v_exp_f32 v232, v232
 v_exp_f32_e64 v233, v233
 v_mfma_f32_32x32x16_bf16 v[208:223], v[160:163], v[144:147], 0
 v_exp_f32 v234, v234
 v_exp_f32 v235, v235
 v_exp_f32 v236, v236
 v_exp_f32 v237, v237
 v_exp_f32 v238, v238
 v_exp_f32 v239, v239
 v_smfmac_f32_32x32x32_bf16 v[48:63], v[164:167], v[224:231], v240
 v_exp_f32 v208, v208
 v_exp_f32 v209, v209
 v_exp_f32_e64 v210, v210
 v_smfmac_f32_32x32x32_bf16 v[48:63], v[168:171], v[232:239], v240
 v_exp_f32 v211, v211
 v_exp_f32 v212, v212
 v_exp_f32 v213, v213
 v_exp_f32 v214, v214
 v_exp_f32 v215, v215
 v_exp_f32 v216, v216
 v_exp_f32_e64 v217, v217
 v_mfma_f32_32x32x16_bf16 v[224:239], v[160:163], v[148:151], 0
 v_exp_f32 v218, v218
 v_exp_f32 v219, v219
 v_exp_f32 v220, v220
 v_exp_f32 v221, v221
 v_exp_f32 v222, v222
 v_exp_f32 v223, v223
 v_smfmac_f32_32x32x32_bf16 v[64:79], v[164:167], v[208:215], v240
 v_exp_f32 v224, v224
 v_exp_f32 v225, v225
 v_exp_f32_e64 v226, v226
 v_smfmac_f32_32x32x32_bf16 v[64:79], v[168:171], v[216:223], v240
 v_exp_f32 v227, v227
 v_exp_f32 v228, v228
 v_exp_f32 v229, v229
 v_exp_f32 v230, v230
 v_exp_f32 v231, v231
 v_exp_f32 v232, v232
 v_exp_f32_e64 v233, v233
 v_mfma_f32_32x32x16_bf16 v[208:223], v[160:163], v[152:155], 0
 v_exp_f32 v234, v234
 v_exp_f32 v235, v235
 v_exp_f32 v236, v236
 v_exp_f32 v237, v237
 v_exp_f32 v238, v238
 v_exp_f32 v239, v239
 v_smfmac_f32_32x32x32_bf16 v[80:95], v[164:167], v[224:231], v240
 v_exp_f32 v208, v208
 v_exp_f32 v209, v209
 v_exp_f32_e64 v210, v210
 v_smfmac_f32_32x32x32_bf16 v[80:95], v[168:171], v[232:239], v240
 v_exp_f32 v211, v211
 v_exp_f32 v212, v212
 v_exp_f32 v213, v213
 v_exp_f32 v214, v214
 v_exp_f32 v215, v215
 v_exp_f32 v216, v216
 v_exp_f32_e64 v217, v217
 v_mfma_f32_32x32x16_bf16 v[224:239], v[160:163], v[156:159], 0
 v_exp_f32 v218, v218
 v_exp_f32 v219, v219
 v_exp_f32 v220, v220
 v_exp_f32 v221, v221
 v_exp_f32 v222, v222
 v_exp_f32 v223, v223
 v_smfmac_f32_32x32x32_bf16 v[96:111], v[164:167], v[208:215], v240
 v_exp_f32 v224, v224
 v_exp_f32 v225, v225
 v_exp_f32_e64 v226, v226
 v_smfmac_f32_32x32x32_bf16 v[96:111], v[168:171], v[216:223], v240
 v_exp_f32 v227, v227
 v_exp_f32 v228, v228
 v_exp_f32 v229, v229
 v_exp_f32 v230, v230
 v_exp_f32 v231, v231
 v_exp_f32 v232, v232
 v_exp_f32_e64 v233, v233
 v_mfma_f32_32x32x16_bf16 v[208:223], v[172:175], v[128:131], 0
 v_exp_f32 v234, v234
 v_exp_f32 v235, v235
 v_exp_f32 v236, v236
 v_exp_f32 v237, v237
 v_exp_f32 v238, v238
 v_exp_f32 v239, v239
 v_smfmac_f32_32x32x32_bf16 v[112:127], v[164:167], v[224:231], v240
 v_exp_f32 v208, v208
 v_exp_f32 v209, v209
 v_exp_f32_e64 v210, v210
 v_smfmac_f32_32x32x32_bf16 v[112:127], v[168:171], v[232:239], v240
 v_exp_f32 v211, v211
 v_exp_f32 v212, v212
 v_exp_f32 v213, v213
 v_exp_f32 v214, v214
 v_exp_f32 v215, v215
 v_exp_f32 v216, v216
 v_exp_f32_e64 v217, v217
 v_mfma_f32_32x32x16_bf16 v[224:239], v[172:175], v[132:135], 0
 v_exp_f32 v218, v218
 v_exp_f32 v219, v219
 v_exp_f32 v220, v220
 v_exp_f32 v221, v221
 v_exp_f32 v222, v222
 v_exp_f32 v223, v223
 v_smfmac_f32_32x32x32_bf16 v[0:15], v[176:179], v[208:215], v240
 v_exp_f32 v224, v224
 v_exp_f32 v225, v225
 v_exp_f32_e64 v226, v226
 v_smfmac_f32_32x32x32_bf16 v[0:15], v[180:183], v[216:223], v240
 v_exp_f32 v227, v227
 v_exp_f32 v228, v228
 v_exp_f32 v229, v229
 v_exp_f32 v230, v230
 v_exp_f32 v231, v231
 v_exp_f32 v232, v232
 v_exp_f32_e64 v233, v233
 v_mfma_f32_32x32x16_bf16 v[208:223], v[172:175], v[136:139], 0
 buffer_load_dwordx4 v[196:199], v241, s[40:43], s71 offen sc1
 buffer_load_dwordx4 v[200:203], v242, s[40:43], s71 offen offset:1024 sc1
 buffer_load_dwordx4 v[204:207], v243, s[40:43], s71 offen offset:1536 sc1
 v_exp_f32 v234, v234
 v_exp_f32 v235, v235
 v_exp_f32 v236, v236
 v_exp_f32 v237, v237
 v_exp_f32 v238, v238
 v_exp_f32 v239, v239
 v_smfmac_f32_32x32x32_bf16 v[16:31], v[176:179], v[224:231], v240
 v_exp_f32 v208, v208
 v_exp_f32 v209, v209
 v_exp_f32_e64 v210, v210
 v_smfmac_f32_32x32x32_bf16 v[16:31], v[180:183], v[232:239], v240
 v_exp_f32 v211, v211
 v_exp_f32 v212, v212
 v_exp_f32 v213, v213
 v_exp_f32 v214, v214
 v_exp_f32 v215, v215
 v_exp_f32 v216, v216
 v_exp_f32_e64 v217, v217
 v_mfma_f32_32x32x16_bf16 v[224:239], v[172:175], v[140:143], 0
 v_exp_f32 v218, v218
 v_exp_f32 v219, v219
 v_exp_f32 v220, v220
 v_exp_f32 v221, v221
 v_exp_f32 v222, v222
 v_exp_f32 v223, v223
 v_smfmac_f32_32x32x32_bf16 v[32:47], v[176:179], v[208:215], v240
 v_exp_f32 v224, v224
 v_exp_f32 v225, v225
 v_exp_f32_e64 v226, v226
 v_smfmac_f32_32x32x32_bf16 v[32:47], v[180:183], v[216:223], v240
 v_exp_f32 v227, v227
 v_exp_f32 v228, v228
 v_exp_f32 v229, v229
 v_exp_f32 v230, v230
 v_exp_f32 v231, v231
 v_exp_f32 v232, v232
 v_exp_f32_e64 v233, v233
 v_mfma_f32_32x32x16_bf16 v[208:223], v[172:175], v[144:147], 0
 v_exp_f32 v234, v234
 v_exp_f32 v235, v235
 v_exp_f32 v236, v236
 v_exp_f32 v237, v237
 v_exp_f32 v238, v238
 v_exp_f32 v239, v239
 v_smfmac_f32_32x32x32_bf16 v[48:63], v[176:179], v[224:231], v240
 v_exp_f32 v208, v208
 v_exp_f32 v209, v209
 v_exp_f32_e64 v210, v210
 v_smfmac_f32_32x32x32_bf16 v[48:63], v[180:183], v[232:239], v240
 v_exp_f32 v211, v211
 v_exp_f32 v212, v212
 v_exp_f32 v213, v213
 v_exp_f32 v214, v214
 v_exp_f32 v215, v215
 v_exp_f32 v216, v216
 v_exp_f32_e64 v217, v217
 v_mfma_f32_32x32x16_bf16 v[224:239], v[172:175], v[148:151], 0
 v_exp_f32 v218, v218
 v_exp_f32 v219, v219
 v_exp_f32 v220, v220
 v_exp_f32 v221, v221
 v_exp_f32 v222, v222
 v_exp_f32 v223, v223
 v_smfmac_f32_32x32x32_bf16 v[64:79], v[176:179], v[208:215], v240
 v_exp_f32 v224, v224
 v_exp_f32 v225, v225
 v_exp_f32_e64 v226, v226
 v_smfmac_f32_32x32x32_bf16 v[64:79], v[180:183], v[216:223], v240
 v_exp_f32 v227, v227
 v_exp_f32 v228, v228
 v_exp_f32 v229, v229
 v_exp_f32 v230, v230
 v_exp_f32 v231, v231
 v_exp_f32 v232, v232
 v_exp_f32_e64 v233, v233
 v_mfma_f32_32x32x16_bf16 v[208:223], v[172:175], v[152:155], 0
 buffer_load_dwordx4 v[160:163], v241, s[40:43], s71 offen offset:2176 sc1
 buffer_load_dwordx4 v[164:167], v242, s[40:43], s71 offen offset:3200 sc1
 buffer_load_dwordx4 v[168:171], v243, s[40:43], s71 offen offset:3712 sc1
 s_add_u32 s71, s71, 4352
 v_exp_f32 v234, v234
 v_exp_f32 v235, v235
 v_exp_f32 v236, v236
 v_exp_f32 v237, v237
 v_exp_f32 v238, v238
 v_exp_f32 v239, v239
 v_smfmac_f32_32x32x32_bf16 v[80:95], v[176:179], v[224:231], v240
 v_exp_f32 v208, v208
 v_exp_f32 v209, v209
 v_exp_f32_e64 v210, v210
 v_smfmac_f32_32x32x32_bf16 v[80:95], v[180:183], v[232:239], v240
 v_exp_f32 v211, v211
 v_exp_f32 v212, v212
 v_exp_f32 v213, v213
 v_exp_f32 v214, v214
 v_exp_f32 v215, v215
 v_exp_f32 v216, v216
 v_exp_f32_e64 v217, v217
 v_mfma_f32_32x32x16_bf16 v[224:239], v[172:175], v[156:159], 0
 v_exp_f32 v218, v218
 v_exp_f32 v219, v219
 v_exp_f32 v220, v220
 v_exp_f32 v221, v221
 v_exp_f32 v222, v222
 v_exp_f32 v223, v223
 v_smfmac_f32_32x32x32_bf16 v[96:111], v[176:179], v[208:215], v240
 v_exp_f32 v224, v224
 v_exp_f32 v225, v225
 v_exp_f32_e64 v226, v226
 v_smfmac_f32_32x32x32_bf16 v[96:111], v[180:183], v[216:223], v240
 v_exp_f32 v227, v227
 v_exp_f32 v228, v228
 v_exp_f32 v229, v229
 v_exp_f32 v230, v230
 v_exp_f32 v231, v231
 v_exp_f32 v232, v232
 v_exp_f32_e64 v233, v233
 v_mfma_f32_32x32x16_bf16 v[208:223], v[184:187], v[128:131], 0
 v_exp_f32 v234, v234
 v_exp_f32 v235, v235
 v_exp_f32 v236, v236
 v_exp_f32 v237, v237
 v_exp_f32 v238, v238
 v_exp_f32 v239, v239
 v_smfmac_f32_32x32x32_bf16 v[112:127], v[176:179], v[224:231], v240
 v_exp_f32 v208, v208
 v_exp_f32 v209, v209
 v_exp_f32_e64 v210, v210
 v_smfmac_f32_32x32x32_bf16 v[112:127], v[180:183], v[232:239], v240
 v_exp_f32 v211, v211
 v_exp_f32 v212, v212
 v_exp_f32 v213, v213
 v_exp_f32 v214, v214
 v_exp_f32 v215, v215
 v_exp_f32 v216, v216
 v_exp_f32_e64 v217, v217
 v_mfma_f32_32x32x16_bf16 v[224:239], v[184:187], v[132:135], 0
 v_exp_f32 v218, v218
 v_exp_f32 v219, v219
 v_exp_f32 v220, v220
 v_exp_f32 v221, v221
 v_exp_f32 v222, v222
 v_exp_f32 v223, v223
 v_smfmac_f32_32x32x32_bf16 v[0:15], v[188:191], v[208:215], v240
 v_exp_f32 v224, v224
 v_exp_f32 v225, v225
 v_exp_f32_e64 v226, v226
 v_smfmac_f32_32x32x32_bf16 v[0:15], v[192:195], v[216:223], v240
 v_exp_f32 v227, v227
 v_exp_f32 v228, v228
 v_exp_f32 v229, v229
 v_exp_f32 v230, v230
 v_exp_f32 v231, v231
 v_exp_f32 v232, v232
 v_exp_f32_e64 v233, v233
 v_mfma_f32_32x32x16_bf16 v[208:223], v[184:187], v[136:139], 0
 buffer_load_dwordx4 v[172:175], v241, s[40:43], s71 offen sc1
 buffer_load_dwordx4 v[176:179], v242, s[40:43], s71 offen offset:1024 sc1
 buffer_load_dwordx4 v[180:183], v243, s[40:43], s71 offen offset:1536 sc1
 v_exp_f32 v234, v234
 v_exp_f32 v235, v235
 v_exp_f32 v236, v236
 v_exp_f32 v237, v237
 v_exp_f32 v238, v238
 v_exp_f32 v239, v239
 v_smfmac_f32_32x32x32_bf16 v[16:31], v[188:191], v[224:231], v240
 v_exp_f32 v208, v208
 v_exp_f32 v209, v209
 v_exp_f32_e64 v210, v210
 v_smfmac_f32_32x32x32_bf16 v[16:31], v[192:195], v[232:239], v240
 v_exp_f32 v211, v211
 v_exp_f32 v212, v212
 v_exp_f32 v213, v213
 v_exp_f32 v214, v214
 v_exp_f32 v215, v215
 v_exp_f32 v216, v216
 v_exp_f32_e64 v217, v217
 v_mfma_f32_32x32x16_bf16 v[224:239], v[184:187], v[140:143], 0
 v_exp_f32 v218, v218
 v_exp_f32 v219, v219
 v_exp_f32 v220, v220
 v_exp_f32 v221, v221
 v_exp_f32 v222, v222
 v_exp_f32 v223, v223
 v_smfmac_f32_32x32x32_bf16 v[32:47], v[188:191], v[208:215], v240
 v_exp_f32 v224, v224
 v_exp_f32 v225, v225
 v_exp_f32_e64 v226, v226
 v_smfmac_f32_32x32x32_bf16 v[32:47], v[192:195], v[216:223], v240
 v_exp_f32 v227, v227
 v_exp_f32 v228, v228
 v_exp_f32 v229, v229
 v_exp_f32 v230, v230
 v_exp_f32 v231, v231
 v_exp_f32 v232, v232
 v_exp_f32_e64 v233, v233
 v_mfma_f32_32x32x16_bf16 v[208:223], v[184:187], v[144:147], 0
 v_exp_f32 v234, v234
 v_exp_f32 v235, v235
 v_exp_f32 v236, v236
 v_exp_f32 v237, v237
 v_exp_f32 v238, v238
 v_exp_f32 v239, v239
 v_smfmac_f32_32x32x32_bf16 v[48:63], v[188:191], v[224:231], v240
 v_exp_f32 v208, v208
 v_exp_f32 v209, v209
 v_exp_f32_e64 v210, v210
 v_smfmac_f32_32x32x32_bf16 v[48:63], v[192:195], v[232:239], v240
 v_exp_f32 v211, v211
 v_exp_f32 v212, v212
 v_exp_f32 v213, v213
 v_exp_f32 v214, v214
 v_exp_f32 v215, v215
 v_exp_f32 v216, v216
 v_exp_f32_e64 v217, v217
 v_mfma_f32_32x32x16_bf16 v[224:239], v[184:187], v[148:151], 0
 v_exp_f32 v218, v218
 v_exp_f32 v219, v219
 v_exp_f32 v220, v220
 v_exp_f32 v221, v221
 v_exp_f32 v222, v222
 v_exp_f32 v223, v223
 v_smfmac_f32_32x32x32_bf16 v[64:79], v[188:191], v[208:215], v240
 v_exp_f32 v224, v224
 v_exp_f32 v225, v225
 v_exp_f32_e64 v226, v226
 v_smfmac_f32_32x32x32_bf16 v[64:79], v[192:195], v[216:223], v240
 v_exp_f32 v227, v227
 v_exp_f32 v228, v228
 v_exp_f32 v229, v229
 v_exp_f32 v230, v230
 v_exp_f32 v231, v231
 v_exp_f32 v232, v232
 v_exp_f32_e64 v233, v233
 v_mfma_f32_32x32x16_bf16 v[208:223], v[184:187], v[152:155], 0
 v_exp_f32 v234, v234
 v_exp_f32 v235, v235
 v_exp_f32 v236, v236
 v_exp_f32 v237, v237
 v_exp_f32 v238, v238
 v_exp_f32 v239, v239
 v_smfmac_f32_32x32x32_bf16 v[80:95], v[188:191], v[224:231], v240
 v_exp_f32 v208, v208
 v_exp_f32 v209, v209
 v_exp_f32_e64 v210, v210
 v_smfmac_f32_32x32x32_bf16 v[80:95], v[192:195], v[232:239], v240
 v_exp_f32 v211, v211
 v_exp_f32 v212, v212
 v_exp_f32 v213, v213
 v_exp_f32 v214, v214
 v_exp_f32 v215, v215
 v_exp_f32 v216, v216
 v_exp_f32_e64 v217, v217
 v_mfma_f32_32x32x16_bf16 v[224:239], v[184:187], v[156:159], 0
 s_waitcnt vmcnt(6)
 v_exp_f32 v218, v218
 v_exp_f32 v219, v219
 v_exp_f32 v220, v220
 v_exp_f32 v221, v221
 v_exp_f32 v222, v222
 v_exp_f32_e64 v223, v223
 v_smfmac_f32_32x32x32_bf16 v[96:111], v[188:191], v[208:215], v240
 v_exp_f32 v224, v224
 v_exp_f32 v225, v225
 v_exp_f32_e64 v226, v226
 v_smfmac_f32_32x32x32_bf16 v[96:111], v[192:195], v[216:223], v240
 v_exp_f32 v227, v227
 v_exp_f32 v228, v228
 v_exp_f32 v229, v229
 v_exp_f32 v230, v230
 v_exp_f32 v231, v231
 v_exp_f32 v232, v232
 v_exp_f32_e64 v233, v233
 v_mfma_f32_32x32x16_bf16 v[208:223], v[196:199], v[128:131], 0
 v_exp_f32 v234, v234
 v_exp_f32 v235, v235
 v_exp_f32 v236, v236
 v_exp_f32 v237, v237
 v_exp_f32 v238, v238
 v_exp_f32 v239, v239
 v_smfmac_f32_32x32x32_bf16 v[112:127], v[188:191], v[224:231], v240
 v_exp_f32 v208, v208
 v_exp_f32 v209, v209
 v_exp_f32_e64 v210, v210
 v_smfmac_f32_32x32x32_bf16 v[112:127], v[192:195], v[232:239], v240
 v_exp_f32 v211, v211
 v_exp_f32 v212, v212
 v_exp_f32 v213, v213
 v_exp_f32 v214, v214
 v_exp_f32 v215, v215
 v_exp_f32 v216, v216
 v_exp_f32_e64 v217, v217
 v_mfma_f32_32x32x16_bf16 v[224:239], v[196:199], v[132:135], 0
 v_exp_f32 v218, v218
 v_exp_f32 v219, v219
 v_exp_f32 v220, v220
 v_exp_f32 v221, v221
 v_exp_f32 v222, v222
 v_exp_f32 v223, v223
 v_smfmac_f32_32x32x32_bf16 v[0:15], v[200:203], v[208:215], v240
 v_exp_f32 v224, v224
 v_exp_f32 v225, v225
 v_exp_f32_e64 v226, v226
 v_smfmac_f32_32x32x32_bf16 v[0:15], v[204:207], v[216:223], v240
 v_exp_f32 v227, v227
 v_exp_f32 v228, v228
 v_exp_f32 v229, v229
 v_exp_f32 v230, v230
 v_exp_f32 v231, v231
 v_exp_f32 v232, v232
 v_exp_f32_e64 v233, v233
 v_mfma_f32_32x32x16_bf16 v[208:223], v[196:199], v[136:139], 0
 buffer_load_dwordx4 v[184:187], v241, s[40:43], s71 offen offset:2176 sc1
 buffer_load_dwordx4 v[188:191], v242, s[40:43], s71 offen offset:3200 sc1
 buffer_load_dwordx4 v[192:195], v243, s[40:43], s71 offen offset:3712 sc1
 s_add_u32 s71, s71, 4352
 v_exp_f32 v234, v234
 v_exp_f32 v235, v235
 v_exp_f32 v236, v236
 v_exp_f32 v237, v237
 v_exp_f32 v238, v238
 v_exp_f32 v239, v239
 v_smfmac_f32_32x32x32_bf16 v[16:31], v[200:203], v[224:231], v240
 v_exp_f32 v208, v208
 v_exp_f32 v209, v209
 v_exp_f32_e64 v210, v210
 v_smfmac_f32_32x32x32_bf16 v[16:31], v[204:207], v[232:239], v240
 v_exp_f32 v211, v211
 v_exp_f32 v212, v212
 v_exp_f32 v213, v213
 v_exp_f32 v214, v214
 v_exp_f32 v215, v215
 v_exp_f32 v216, v216
 v_exp_f32_e64 v217, v217
 v_mfma_f32_32x32x16_bf16 v[224:239], v[196:199], v[140:143], 0
 v_exp_f32 v218, v218
 v_exp_f32 v219, v219
 v_exp_f32 v220, v220
 v_exp_f32 v221, v221
 v_exp_f32 v222, v222
 v_exp_f32 v223, v223
 v_smfmac_f32_32x32x32_bf16 v[32:47], v[200:203], v[208:215], v240
 v_exp_f32 v224, v224
 v_exp_f32 v225, v225
 v_exp_f32_e64 v226, v226
 v_smfmac_f32_32x32x32_bf16 v[32:47], v[204:207], v[216:223], v240
 v_exp_f32 v227, v227
 v_exp_f32 v228, v228
 v_exp_f32 v229, v229
 v_exp_f32 v230, v230
 v_exp_f32 v231, v231
 v_exp_f32 v232, v232
 v_exp_f32_e64 v233, v233
 v_mfma_f32_32x32x16_bf16 v[208:223], v[196:199], v[144:147], 0
 v_exp_f32 v234, v234
 v_exp_f32 v235, v235
 v_exp_f32 v236, v236
 v_exp_f32 v237, v237
 v_exp_f32 v238, v238
 v_exp_f32 v239, v239
 v_smfmac_f32_32x32x32_bf16 v[48:63], v[200:203], v[224:231], v240
 v_exp_f32 v208, v208
 v_exp_f32 v209, v209
 v_exp_f32_e64 v210, v210
 v_smfmac_f32_32x32x32_bf16 v[48:63], v[204:207], v[232:239], v240
 v_exp_f32 v211, v211
 v_exp_f32 v212, v212
 v_exp_f32 v213, v213
 v_exp_f32 v214, v214
 v_exp_f32 v215, v215
 v_exp_f32 v216, v216
 v_exp_f32_e64 v217, v217
 v_mfma_f32_32x32x16_bf16 v[224:239], v[196:199], v[148:151], 0
 v_exp_f32 v218, v218
 v_exp_f32 v219, v219
 v_exp_f32 v220, v220
 v_exp_f32 v221, v221
 v_exp_f32 v222, v222
 v_exp_f32 v223, v223
 v_smfmac_f32_32x32x32_bf16 v[64:79], v[200:203], v[208:215], v240
 v_exp_f32 v224, v224
 v_exp_f32 v225, v225
 v_exp_f32_e64 v226, v226
 v_smfmac_f32_32x32x32_bf16 v[64:79], v[204:207], v[216:223], v240
 v_exp_f32 v227, v227
 v_exp_f32 v228, v228
 v_exp_f32 v229, v229
 v_exp_f32 v230, v230
 v_exp_f32 v231, v231
 v_exp_f32 v232, v232
 v_exp_f32_e64 v233, v233
 v_mfma_f32_32x32x16_bf16 v[208:223], v[196:199], v[152:155], 0
 v_exp_f32 v234, v234
 v_exp_f32 v235, v235
 v_exp_f32 v236, v236
 v_exp_f32 v237, v237
 v_exp_f32 v238, v238
 v_exp_f32 v239, v239
 v_smfmac_f32_32x32x32_bf16 v[80:95], v[200:203], v[224:231], v240
 v_exp_f32 v208, v208
 v_exp_f32 v209, v209
 v_exp_f32_e64 v210, v210
 v_smfmac_f32_32x32x32_bf16 v[80:95], v[204:207], v[232:239], v240
 v_exp_f32 v211, v211
 v_exp_f32 v212, v212
 v_exp_f32 v213, v213
 v_exp_f32 v214, v214
 v_exp_f32 v215, v215
 v_exp_f32 v216, v216
 v_exp_f32_e64 v217, v217
 v_mfma_f32_32x32x16_bf16 v[224:239], v[196:199], v[156:159], 0
 s_waitcnt vmcnt(6)
 v_exp_f32 v218, v218
 v_exp_f32 v219, v219
 v_exp_f32 v220, v220
 v_exp_f32 v221, v221
 v_exp_f32 v222, v222
 v_exp_f32_e64 v223, v223
 v_smfmac_f32_32x32x32_bf16 v[96:111], v[200:203], v[208:215], v240
 v_exp_f32 v224, v224
 v_exp_f32 v225, v225
 v_exp_f32_e64 v226, v226
 v_smfmac_f32_32x32x32_bf16 v[96:111], v[204:207], v[216:223], v240
 v_exp_f32 v227, v227
 v_exp_f32 v228, v228
 v_exp_f32 v229, v229
 v_exp_f32 v230, v230
 v_exp_f32 v231, v231
 v_exp_f32 v232, v232
 v_exp_f32_e64 v233, v233
 v_mfma_f32_32x32x16_bf16 v[208:223], v[160:163], v[128:131], 0
 v_exp_f32 v234, v234
 v_exp_f32 v235, v235
 v_exp_f32 v236, v236
 v_exp_f32 v237, v237
 v_exp_f32 v238, v238
 v_exp_f32 v239, v239
 v_smfmac_f32_32x32x32_bf16 v[112:127], v[200:203], v[224:231], v240
 v_exp_f32 v208, v208
 v_exp_f32 v209, v209
 v_exp_f32_e64 v210, v210
 v_smfmac_f32_32x32x32_bf16 v[112:127], v[204:207], v[232:239], v240
 v_exp_f32 v211, v211
 v_exp_f32 v212, v212
 v_exp_f32 v213, v213
 v_exp_f32 v214, v214
 v_exp_f32 v215, v215
 v_exp_f32 v216, v216
 v_exp_f32_e64 v217, v217
 v_mfma_f32_32x32x16_bf16 v[224:239], v[160:163], v[132:135], 0
 v_exp_f32 v218, v218
 v_exp_f32 v219, v219
 v_exp_f32 v220, v220
 v_exp_f32 v221, v221
 v_exp_f32 v222, v222
 v_exp_f32 v223, v223
 v_smfmac_f32_32x32x32_bf16 v[0:15], v[164:167], v[208:215], v240
 v_exp_f32 v224, v224
 v_exp_f32 v225, v225
 v_exp_f32_e64 v226, v226
 v_smfmac_f32_32x32x32_bf16 v[0:15], v[168:171], v[216:223], v240
 v_exp_f32 v227, v227
 v_exp_f32 v228, v228
 v_exp_f32 v229, v229
 v_exp_f32 v230, v230
 v_exp_f32 v231, v231
 v_exp_f32 v232, v232
 v_exp_f32_e64 v233, v233
 v_mfma_f32_32x32x16_bf16 v[208:223], v[160:163], v[136:139], 0
 buffer_load_dwordx4 v[196:199], v241, s[40:43], s71 offen sc1
 buffer_load_dwordx4 v[200:203], v242, s[40:43], s71 offen offset:1024 sc1
 buffer_load_dwordx4 v[204:207], v243, s[40:43], s71 offen offset:1536 sc1
 v_exp_f32 v234, v234
 v_exp_f32 v235, v235
 v_exp_f32 v236, v236
 v_exp_f32 v237, v237
 v_exp_f32 v238, v238
 v_exp_f32 v239, v239
 v_smfmac_f32_32x32x32_bf16 v[16:31], v[164:167], v[224:231], v240
 v_exp_f32 v208, v208
 v_exp_f32 v209, v209
 v_exp_f32_e64 v210, v210
 v_smfmac_f32_32x32x32_bf16 v[16:31], v[168:171], v[232:239], v240
 v_exp_f32 v211, v211
 v_exp_f32 v212, v212
 v_exp_f32 v213, v213
 v_exp_f32 v214, v214
 v_exp_f32 v215, v215
 v_exp_f32 v216, v216
 v_exp_f32_e64 v217, v217
 v_mfma_f32_32x32x16_bf16 v[224:239], v[160:163], v[140:143], 0
 v_exp_f32 v218, v218
 v_exp_f32 v219, v219
 v_exp_f32 v220, v220
 v_exp_f32 v221, v221
 v_exp_f32 v222, v222
 v_exp_f32 v223, v223
 v_smfmac_f32_32x32x32_bf16 v[32:47], v[164:167], v[208:215], v240
 v_exp_f32 v224, v224
 v_exp_f32 v225, v225
 v_exp_f32_e64 v226, v226
 v_smfmac_f32_32x32x32_bf16 v[32:47], v[168:171], v[216:223], v240
 v_exp_f32 v227, v227
 v_exp_f32 v228, v228
 v_exp_f32 v229, v229
 v_exp_f32 v230, v230
 v_exp_f32 v231, v231
 v_exp_f32 v232, v232
 v_exp_f32_e64 v233, v233
 v_mfma_f32_32x32x16_bf16 v[208:223], v[160:163], v[144:147], 0
 v_exp_f32 v234, v234
 v_exp_f32 v235, v235
 v_exp_f32 v236, v236
 v_exp_f32 v237, v237
 v_exp_f32 v238, v238
 v_exp_f32 v239, v239
 v_smfmac_f32_32x32x32_bf16 v[48:63], v[164:167], v[224:231], v240
 v_exp_f32 v208, v208
 v_exp_f32 v209, v209
 v_exp_f32_e64 v210, v210
 v_smfmac_f32_32x32x32_bf16 v[48:63], v[168:171], v[232:239], v240
 v_exp_f32 v211, v211
 v_exp_f32 v212, v212
 v_exp_f32 v213, v213
 v_exp_f32 v214, v214
 v_exp_f32 v215, v215
 v_exp_f32 v216, v216
 v_exp_f32_e64 v217, v217
 v_mfma_f32_32x32x16_bf16 v[224:239], v[160:163], v[148:151], 0
 v_exp_f32 v218, v218
 v_exp_f32 v219, v219
 v_exp_f32 v220, v220
 v_exp_f32 v221, v221
 v_exp_f32 v222, v222
 v_exp_f32 v223, v223
 v_smfmac_f32_32x32x32_bf16 v[64:79], v[164:167], v[208:215], v240
 v_exp_f32 v224, v224
 v_exp_f32 v225, v225
 v_exp_f32_e64 v226, v226
 v_smfmac_f32_32x32x32_bf16 v[64:79], v[168:171], v[216:223], v240
 v_exp_f32 v227, v227
 v_exp_f32 v228, v228
 v_exp_f32 v229, v229
 v_exp_f32 v230, v230
 v_exp_f32 v231, v231
 v_exp_f32 v232, v232
 v_exp_f32_e64 v233, v233
 v_mfma_f32_32x32x16_bf16 v[208:223], v[160:163], v[152:155], 0
 v_exp_f32 v234, v234
 v_exp_f32 v235, v235
 v_exp_f32 v236, v236
 v_exp_f32 v237, v237
 v_exp_f32 v238, v238
 v_exp_f32 v239, v239
 v_smfmac_f32_32x32x32_bf16 v[80:95], v[164:167], v[224:231], v240
 v_exp_f32 v208, v208
 v_exp_f32 v209, v209
 v_exp_f32_e64 v210, v210
 v_smfmac_f32_32x32x32_bf16 v[80:95], v[168:171], v[232:239], v240
 v_exp_f32 v211, v211
 v_exp_f32 v212, v212
 v_exp_f32 v213, v213
 v_exp_f32 v214, v214
 v_exp_f32 v215, v215
 v_exp_f32 v216, v216
 v_exp_f32_e64 v217, v217
 v_mfma_f32_32x32x16_bf16 v[224:239], v[160:163], v[156:159], 0
 s_waitcnt vmcnt(6)
 v_exp_f32 v218, v218
 v_exp_f32 v219, v219
 v_exp_f32 v220, v220
 v_exp_f32 v221, v221
 v_exp_f32 v222, v222
 v_exp_f32_e64 v223, v223
 v_smfmac_f32_32x32x32_bf16 v[96:111], v[164:167], v[208:215], v240
 v_exp_f32 v224, v224
 v_exp_f32 v225, v225
 v_exp_f32_e64 v226, v226
 v_smfmac_f32_32x32x32_bf16 v[96:111], v[168:171], v[216:223], v240
 v_exp_f32 v227, v227
 v_exp_f32 v228, v228
 v_exp_f32 v229, v229
 v_exp_f32 v230, v230
 v_exp_f32 v231, v231
 v_exp_f32 v232, v232
 v_exp_f32_e64 v233, v233
 v_mfma_f32_32x32x16_bf16 v[208:223], v[172:175], v[128:131], 0
 v_exp_f32 v234, v234
 v_exp_f32 v235, v235
 v_exp_f32 v236, v236
 v_exp_f32 v237, v237
 v_exp_f32 v238, v238
 v_exp_f32 v239, v239
 v_smfmac_f32_32x32x32_bf16 v[112:127], v[164:167], v[224:231], v240
 v_exp_f32 v208, v208
 v_exp_f32 v209, v209
 v_exp_f32_e64 v210, v210
 v_smfmac_f32_32x32x32_bf16 v[112:127], v[168:171], v[232:239], v240
 v_exp_f32 v211, v211
 v_exp_f32 v212, v212
 v_exp_f32 v213, v213
 v_exp_f32 v214, v214
 v_exp_f32 v215, v215
 v_exp_f32 v216, v216
 v_exp_f32_e64 v217, v217
 v_mfma_f32_32x32x16_bf16 v[224:239], v[172:175], v[132:135], 0
 v_exp_f32 v218, v218
 v_exp_f32 v219, v219
 v_exp_f32 v220, v220
 v_exp_f32 v221, v221
 v_exp_f32 v222, v222
 v_exp_f32 v223, v223
 v_smfmac_f32_32x32x32_bf16 v[0:15], v[176:179], v[208:215], v240
 v_exp_f32 v224, v224
 v_exp_f32 v225, v225
 v_exp_f32_e64 v226, v226
 v_smfmac_f32_32x32x32_bf16 v[0:15], v[180:183], v[216:223], v240
 v_exp_f32 v227, v227
 v_exp_f32 v228, v228
 v_exp_f32 v229, v229
 v_exp_f32 v230, v230
 v_exp_f32 v231, v231
 v_exp_f32 v232, v232
 v_exp_f32_e64 v233, v233
 v_mfma_f32_32x32x16_bf16 v[208:223], v[172:175], v[136:139], 0
 buffer_load_dwordx4 v[160:163], v241, s[40:43], s71 offen offset:2176 sc1
 buffer_load_dwordx4 v[164:167], v242, s[40:43], s71 offen offset:3200 sc1
 buffer_load_dwordx4 v[168:171], v243, s[40:43], s71 offen offset:3712 sc1
 s_add_u32 s71, s71, 4352
 v_exp_f32 v234, v234
 v_exp_f32 v235, v235
 v_exp_f32 v236, v236
 v_exp_f32 v237, v237
 v_exp_f32 v238, v238
 v_exp_f32 v239, v239
 v_smfmac_f32_32x32x32_bf16 v[16:31], v[176:179], v[224:231], v240
 v_exp_f32 v208, v208
 v_exp_f32 v209, v209
 v_exp_f32_e64 v210, v210
 v_smfmac_f32_32x32x32_bf16 v[16:31], v[180:183], v[232:239], v240
 v_exp_f32 v211, v211
 v_exp_f32 v212, v212
 v_exp_f32 v213, v213
 v_exp_f32 v214, v214
 v_exp_f32 v215, v215
 v_exp_f32 v216, v216
 v_exp_f32_e64 v217, v217
 v_mfma_f32_32x32x16_bf16 v[224:239], v[172:175], v[140:143], 0
 v_exp_f32 v218, v218
 v_exp_f32 v219, v219
 v_exp_f32 v220, v220
 v_exp_f32 v221, v221
 v_exp_f32 v222, v222
 v_exp_f32 v223, v223
 v_smfmac_f32_32x32x32_bf16 v[32:47], v[176:179], v[208:215], v240
 v_exp_f32 v224, v224
 v_exp_f32 v225, v225
 v_exp_f32_e64 v226, v226
 v_smfmac_f32_32x32x32_bf16 v[32:47], v[180:183], v[216:223], v240
 v_exp_f32 v227, v227
 v_exp_f32 v228, v228
 v_exp_f32 v229, v229
 v_exp_f32 v230, v230
 v_exp_f32 v231, v231
 v_exp_f32 v232, v232
 v_exp_f32_e64 v233, v233
 v_mfma_f32_32x32x16_bf16 v[208:223], v[172:175], v[144:147], 0
 v_exp_f32 v234, v234
 v_exp_f32 v235, v235
 v_exp_f32 v236, v236
 v_exp_f32 v237, v237
 v_exp_f32 v238, v238
 v_exp_f32 v239, v239
 v_smfmac_f32_32x32x32_bf16 v[48:63], v[176:179], v[224:231], v240
 v_exp_f32 v208, v208
 v_exp_f32 v209, v209
 v_exp_f32_e64 v210, v210
 v_smfmac_f32_32x32x32_bf16 v[48:63], v[180:183], v[232:239], v240
 v_exp_f32 v211, v211
 v_exp_f32 v212, v212
 v_exp_f32 v213, v213
 v_exp_f32 v214, v214
 v_exp_f32 v215, v215
 v_exp_f32 v216, v216
 v_exp_f32_e64 v217, v217
 v_mfma_f32_32x32x16_bf16 v[224:239], v[172:175], v[148:151], 0
 v_exp_f32 v218, v218
 v_exp_f32 v219, v219
 v_exp_f32 v220, v220
 v_exp_f32 v221, v221
 v_exp_f32 v222, v222
 v_exp_f32 v223, v223
 v_smfmac_f32_32x32x32_bf16 v[64:79], v[176:179], v[208:215], v240
 v_exp_f32 v224, v224
 v_exp_f32 v225, v225
 v_exp_f32_e64 v226, v226
 v_smfmac_f32_32x32x32_bf16 v[64:79], v[180:183], v[216:223], v240
 v_exp_f32 v227, v227
 v_exp_f32 v228, v228
 v_exp_f32 v229, v229
 v_exp_f32 v230, v230
 v_exp_f32 v231, v231
 v_exp_f32 v232, v232
 v_exp_f32_e64 v233, v233
 v_mfma_f32_32x32x16_bf16 v[208:223], v[172:175], v[152:155], 0
 v_exp_f32 v234, v234
 v_exp_f32 v235, v235
 v_exp_f32 v236, v236
 v_exp_f32 v237, v237
 v_exp_f32 v238, v238
 v_exp_f32 v239, v239
 v_smfmac_f32_32x32x32_bf16 v[80:95], v[176:179], v[224:231], v240
 v_exp_f32 v208, v208
 v_exp_f32 v209, v209
 v_exp_f32_e64 v210, v210
 v_smfmac_f32_32x32x32_bf16 v[80:95], v[180:183], v[232:239], v240
 v_exp_f32 v211, v211
 v_exp_f32 v212, v212
 v_exp_f32 v213, v213
 v_exp_f32 v214, v214
 v_exp_f32 v215, v215
 v_exp_f32 v216, v216
 v_exp_f32_e64 v217, v217
 v_mfma_f32_32x32x16_bf16 v[224:239], v[172:175], v[156:159], 0
 s_waitcnt vmcnt(6)
 v_exp_f32 v218, v218
 v_exp_f32 v219, v219
 v_exp_f32 v220, v220
 v_exp_f32 v221, v221
 v_exp_f32 v222, v222
 v_exp_f32_e64 v223, v223
 v_smfmac_f32_32x32x32_bf16 v[96:111], v[176:179], v[208:215], v240
 v_exp_f32 v224, v224
 v_exp_f32 v225, v225
 v_exp_f32_e64 v226, v226
 v_smfmac_f32_32x32x32_bf16 v[96:111], v[180:183], v[216:223], v240
 v_exp_f32 v227, v227
 v_exp_f32 v228, v228
 v_exp_f32 v229, v229
 v_exp_f32 v230, v230
 v_exp_f32 v231, v231
 v_exp_f32 v232, v232
 v_exp_f32_e64 v233, v233
 v_mfma_f32_32x32x16_bf16 v[208:223], v[184:187], v[128:131], 0
 v_exp_f32 v234, v234
 v_exp_f32 v235, v235
 v_exp_f32 v236, v236
 v_exp_f32 v237, v237
 v_exp_f32 v238, v238
 v_exp_f32 v239, v239
 v_smfmac_f32_32x32x32_bf16 v[112:127], v[176:179], v[224:231], v240
 v_exp_f32 v208, v208
 v_exp_f32 v209, v209
 v_exp_f32_e64 v210, v210
 v_smfmac_f32_32x32x32_bf16 v[112:127], v[180:183], v[232:239], v240
 v_exp_f32 v211, v211
 v_exp_f32 v212, v212
 v_exp_f32 v213, v213
 v_exp_f32 v214, v214
 v_exp_f32 v215, v215
 v_exp_f32 v216, v216
 v_exp_f32_e64 v217, v217
 v_mfma_f32_32x32x16_bf16 v[224:239], v[184:187], v[132:135], 0
 v_exp_f32 v218, v218
 v_exp_f32 v219, v219
 v_exp_f32 v220, v220
 v_exp_f32 v221, v221
 v_exp_f32 v222, v222
 v_exp_f32 v223, v223
 v_smfmac_f32_32x32x32_bf16 v[0:15], v[188:191], v[208:215], v240
 v_exp_f32 v224, v224
 v_exp_f32 v225, v225
 v_exp_f32_e64 v226, v226
 v_smfmac_f32_32x32x32_bf16 v[0:15], v[192:195], v[216:223], v240
 v_exp_f32 v227, v227
 v_exp_f32 v228, v228
 v_exp_f32 v229, v229
 v_exp_f32 v230, v230
 v_exp_f32 v231, v231
 v_exp_f32 v232, v232
 v_exp_f32_e64 v233, v233
 v_mfma_f32_32x32x16_bf16 v[208:223], v[184:187], v[136:139], 0
 buffer_load_dwordx4 v[172:175], v241, s[40:43], s71 offen sc1
 buffer_load_dwordx4 v[176:179], v242, s[40:43], s71 offen offset:1024 sc1
 buffer_load_dwordx4 v[180:183], v243, s[40:43], s71 offen offset:1536 sc1
 v_exp_f32 v234, v234
 v_exp_f32 v235, v235
 v_exp_f32 v236, v236
 v_exp_f32 v237, v237
 v_exp_f32 v238, v238
 v_exp_f32 v239, v239
 v_smfmac_f32_32x32x32_bf16 v[16:31], v[188:191], v[224:231], v240
 v_exp_f32 v208, v208
 v_exp_f32 v209, v209
 v_exp_f32_e64 v210, v210
 v_smfmac_f32_32x32x32_bf16 v[16:31], v[192:195], v[232:239], v240
 v_exp_f32 v211, v211
 v_exp_f32 v212, v212
 v_exp_f32 v213, v213
 v_exp_f32 v214, v214
 v_exp_f32 v215, v215
 v_exp_f32 v216, v216
 v_exp_f32_e64 v217, v217
 v_mfma_f32_32x32x16_bf16 v[224:239], v[184:187], v[140:143], 0
 v_exp_f32 v218, v218
 v_exp_f32 v219, v219
 v_exp_f32 v220, v220
 v_exp_f32 v221, v221
 v_exp_f32 v222, v222
 v_exp_f32 v223, v223
 v_smfmac_f32_32x32x32_bf16 v[32:47], v[188:191], v[208:215], v240
 v_exp_f32 v224, v224
 v_exp_f32 v225, v225
 v_exp_f32_e64 v226, v226
 v_smfmac_f32_32x32x32_bf16 v[32:47], v[192:195], v[216:223], v240
 v_exp_f32 v227, v227
 v_exp_f32 v228, v228
 v_exp_f32 v229, v229
 v_exp_f32 v230, v230
 v_exp_f32 v231, v231
 v_exp_f32 v232, v232
 v_exp_f32_e64 v233, v233
 v_mfma_f32_32x32x16_bf16 v[208:223], v[184:187], v[144:147], 0
 v_exp_f32 v234, v234
 v_exp_f32 v235, v235
 v_exp_f32 v236, v236
 v_exp_f32 v237, v237
 v_exp_f32 v238, v238
 v_exp_f32 v239, v239
 v_smfmac_f32_32x32x32_bf16 v[48:63], v[188:191], v[224:231], v240
 v_exp_f32 v208, v208
 v_exp_f32 v209, v209
 v_exp_f32_e64 v210, v210
 v_smfmac_f32_32x32x32_bf16 v[48:63], v[192:195], v[232:239], v240
 v_exp_f32 v211, v211
 v_exp_f32 v212, v212
 v_exp_f32 v213, v213
 v_exp_f32 v214, v214
 v_exp_f32 v215, v215
 v_exp_f32 v216, v216
 v_exp_f32_e64 v217, v217
 v_mfma_f32_32x32x16_bf16 v[224:239], v[184:187], v[148:151], 0
 v_exp_f32 v218, v218
 v_exp_f32 v219, v219
 v_exp_f32 v220, v220
 v_exp_f32 v221, v221
 v_exp_f32 v222, v222
 v_exp_f32 v223, v223
 v_smfmac_f32_32x32x32_bf16 v[64:79], v[188:191], v[208:215], v240
 v_exp_f32 v224, v224
 v_exp_f32 v225, v225
 v_exp_f32_e64 v226, v226
 v_smfmac_f32_32x32x32_bf16 v[64:79], v[192:195], v[216:223], v240
 v_exp_f32 v227, v227
 v_exp_f32 v228, v228
 v_exp_f32 v229, v229
 v_exp_f32 v230, v230
 v_exp_f32 v231, v231
 v_exp_f32 v232, v232
 v_exp_f32_e64 v233, v233
 v_mfma_f32_32x32x16_bf16 v[208:223], v[184:187], v[152:155], 0
 v_exp_f32 v234, v234
 v_exp_f32 v235, v235
 v_exp_f32 v236, v236
 v_exp_f32 v237, v237
 v_exp_f32 v238, v238
 v_exp_f32 v239, v239
 v_smfmac_f32_32x32x32_bf16 v[80:95], v[188:191], v[224:231], v240
 v_exp_f32 v208, v208
 v_exp_f32 v209, v209
 v_exp_f32_e64 v210, v210
 v_smfmac_f32_32x32x32_bf16 v[80:95], v[192:195], v[232:239], v240
 v_exp_f32 v211, v211
 v_exp_f32 v212, v212
 v_exp_f32 v213, v213
 v_exp_f32 v214, v214
 v_exp_f32 v215, v215
 v_exp_f32 v216, v216
 v_exp_f32_e64 v217, v217
 v_mfma_f32_32x32x16_bf16 v[224:239], v[184:187], v[156:159], 0
 s_waitcnt vmcnt(6)
 v_exp_f32 v218, v218
 v_exp_f32 v219, v219
 v_exp_f32 v220, v220
 v_exp_f32 v221, v221
 v_exp_f32 v222, v222
 v_exp_f32_e64 v223, v223
 v_smfmac_f32_32x32x32_bf16 v[96:111], v[188:191], v[208:215], v240
 v_exp_f32 v224, v224
 v_exp_f32 v225, v225
 v_exp_f32_e64 v226, v226
 v_smfmac_f32_32x32x32_bf16 v[96:111], v[192:195], v[216:223], v240
 v_exp_f32 v227, v227
 v_exp_f32 v228, v228
 v_exp_f32 v229, v229
 v_exp_f32 v230, v230
 v_exp_f32 v231, v231
 v_exp_f32 v232, v232
 v_exp_f32_e64 v233, v233
 v_mfma_f32_32x32x16_bf16 v[208:223], v[196:199], v[128:131], 0
 v_exp_f32 v234, v234
 v_exp_f32 v235, v235
 v_exp_f32 v236, v236
 v_exp_f32 v237, v237
 v_exp_f32 v238, v238
 v_exp_f32 v239, v239
 v_smfmac_f32_32x32x32_bf16 v[112:127], v[188:191], v[224:231], v240
 v_exp_f32 v208, v208
 v_exp_f32 v209, v209
 v_exp_f32_e64 v210, v210
 v_smfmac_f32_32x32x32_bf16 v[112:127], v[192:195], v[232:239], v240
 v_exp_f32 v211, v211
 v_exp_f32 v212, v212
 v_exp_f32 v213, v213
 v_exp_f32 v214, v214
 v_exp_f32 v215, v215
 v_exp_f32 v216, v216
 v_exp_f32_e64 v217, v217
 v_mfma_f32_32x32x16_bf16 v[224:239], v[196:199], v[132:135], 0
 v_exp_f32 v218, v218
 v_exp_f32 v219, v219
 v_exp_f32 v220, v220
 v_exp_f32 v221, v221
 v_exp_f32 v222, v222
 v_exp_f32 v223, v223
 v_smfmac_f32_32x32x32_bf16 v[0:15], v[200:203], v[208:215], v240
 v_exp_f32 v224, v224
 v_exp_f32 v225, v225
 v_exp_f32_e64 v226, v226
 v_smfmac_f32_32x32x32_bf16 v[0:15], v[204:207], v[216:223], v240
 v_exp_f32 v227, v227
 v_exp_f32 v228, v228
 v_exp_f32 v229, v229
 v_exp_f32 v230, v230
 v_exp_f32 v231, v231
 v_exp_f32 v232, v232
 v_exp_f32_e64 v233, v233
 v_mfma_f32_32x32x16_bf16 v[208:223], v[196:199], v[136:139], 0
 buffer_load_dwordx4 v[184:187], v241, s[40:43], s71 offen offset:2176 sc1
 buffer_load_dwordx4 v[188:191], v242, s[40:43], s71 offen offset:3200 sc1
 buffer_load_dwordx4 v[192:195], v243, s[40:43], s71 offen offset:3712 sc1
 s_add_u32 s71, s71, 4352
 v_exp_f32 v234, v234
 v_exp_f32 v235, v235
 v_exp_f32 v236, v236
 v_exp_f32 v237, v237
 v_exp_f32 v238, v238
 v_exp_f32 v239, v239
 v_smfmac_f32_32x32x32_bf16 v[16:31], v[200:203], v[224:231], v240
 v_exp_f32 v208, v208
 v_exp_f32 v209, v209
 v_exp_f32_e64 v210, v210
 v_smfmac_f32_32x32x32_bf16 v[16:31], v[204:207], v[232:239], v240
 v_exp_f32 v211, v211
 v_exp_f32 v212, v212
 v_exp_f32 v213, v213
 v_exp_f32 v214, v214
 v_exp_f32 v215, v215
 v_exp_f32 v216, v216
 v_exp_f32_e64 v217, v217
 v_mfma_f32_32x32x16_bf16 v[224:239], v[196:199], v[140:143], 0
 v_exp_f32 v218, v218
 v_exp_f32 v219, v219
 v_exp_f32 v220, v220
 v_exp_f32 v221, v221
 v_exp_f32 v222, v222
 v_exp_f32 v223, v223
 v_smfmac_f32_32x32x32_bf16 v[32:47], v[200:203], v[208:215], v240
 v_exp_f32 v224, v224
 v_exp_f32 v225, v225
 v_exp_f32_e64 v226, v226
 v_smfmac_f32_32x32x32_bf16 v[32:47], v[204:207], v[216:223], v240
 v_exp_f32 v227, v227
 v_exp_f32 v228, v228
 v_exp_f32 v229, v229
 v_exp_f32 v230, v230
 v_exp_f32 v231, v231
 v_exp_f32 v232, v232
 v_exp_f32_e64 v233, v233
 v_mfma_f32_32x32x16_bf16 v[208:223], v[196:199], v[144:147], 0
 v_exp_f32 v234, v234
 v_exp_f32 v235, v235
 v_exp_f32 v236, v236
 v_exp_f32 v237, v237
 v_exp_f32 v238, v238
 v_exp_f32 v239, v239
 v_smfmac_f32_32x32x32_bf16 v[48:63], v[200:203], v[224:231], v240
 v_exp_f32 v208, v208
 v_exp_f32 v209, v209
 v_exp_f32_e64 v210, v210
 v_smfmac_f32_32x32x32_bf16 v[48:63], v[204:207], v[232:239], v240
 v_exp_f32 v211, v211
 v_exp_f32 v212, v212
 v_exp_f32 v213, v213
 v_exp_f32 v214, v214
 v_exp_f32 v215, v215
 v_exp_f32 v216, v216
 v_exp_f32_e64 v217, v217
 v_mfma_f32_32x32x16_bf16 v[224:239], v[196:199], v[148:151], 0
 v_exp_f32 v218, v218
 v_exp_f32 v219, v219
 v_exp_f32 v220, v220
 v_exp_f32 v221, v221
 v_exp_f32 v222, v222
 v_exp_f32 v223, v223
 v_smfmac_f32_32x32x32_bf16 v[64:79], v[200:203], v[208:215], v240
 v_exp_f32 v224, v224
 v_exp_f32 v225, v225
 v_exp_f32_e64 v226, v226
 v_smfmac_f32_32x32x32_bf16 v[64:79], v[204:207], v[216:223], v240
 v_exp_f32 v227, v227
 v_exp_f32 v228, v228
 v_exp_f32 v229, v229
 v_exp_f32 v230, v230
 v_exp_f32 v231, v231
 v_exp_f32 v232, v232
 v_exp_f32_e64 v233, v233
 v_mfma_f32_32x32x16_bf16 v[208:223], v[196:199], v[152:155], 0
 v_exp_f32 v234, v234
 v_exp_f32 v235, v235
 v_exp_f32 v236, v236
 v_exp_f32 v237, v237
 v_exp_f32 v238, v238
 v_exp_f32 v239, v239
 v_smfmac_f32_32x32x32_bf16 v[80:95], v[200:203], v[224:231], v240
 v_exp_f32 v208, v208
 v_exp_f32 v209, v209
 v_exp_f32_e64 v210, v210
 v_smfmac_f32_32x32x32_bf16 v[80:95], v[204:207], v[232:239], v240
 v_exp_f32 v211, v211
 v_exp_f32 v212, v212
 v_exp_f32 v213, v213
 v_exp_f32 v214, v214
 v_exp_f32 v215, v215
 v_exp_f32 v216, v216
 v_exp_f32_e64 v217, v217
 v_mfma_f32_32x32x16_bf16 v[224:239], v[196:199], v[156:159], 0
 s_waitcnt vmcnt(6)
 v_exp_f32 v218, v218
 v_exp_f32 v219, v219
 v_exp_f32 v220, v220
 v_exp_f32 v221, v221
 v_exp_f32 v222, v222
 v_exp_f32_e64 v223, v223
 v_smfmac_f32_32x32x32_bf16 v[96:111], v[200:203], v[208:215], v240
 v_exp_f32 v224, v224
 v_exp_f32 v225, v225
 v_exp_f32_e64 v226, v226
 v_smfmac_f32_32x32x32_bf16 v[96:111], v[204:207], v[216:223], v240
 v_exp_f32 v227, v227
 v_exp_f32 v228, v228
 v_exp_f32 v229, v229
 v_exp_f32 v230, v230
 v_exp_f32 v231, v231
 v_exp_f32 v232, v232
 v_exp_f32_e64 v233, v233
 v_mfma_f32_32x32x16_bf16 v[208:223], v[160:163], v[128:131], 0
 v_exp_f32 v234, v234
 v_exp_f32 v235, v235
 v_exp_f32 v236, v236
 v_exp_f32 v237, v237
 v_exp_f32 v238, v238
 v_exp_f32 v239, v239
 v_smfmac_f32_32x32x32_bf16 v[112:127], v[200:203], v[224:231], v240
 v_exp_f32 v208, v208
 v_exp_f32 v209, v209
 v_exp_f32_e64 v210, v210
 v_smfmac_f32_32x32x32_bf16 v[112:127], v[204:207], v[232:239], v240
 v_exp_f32 v211, v211
 v_exp_f32 v212, v212
 v_exp_f32 v213, v213
 v_exp_f32 v214, v214
 v_exp_f32 v215, v215
 v_exp_f32 v216, v216
 v_exp_f32_e64 v217, v217
 v_mfma_f32_32x32x16_bf16 v[224:239], v[160:163], v[132:135], 0
 v_exp_f32 v218, v218
 v_exp_f32 v219, v219
 v_exp_f32 v220, v220
 v_exp_f32 v221, v221
 v_exp_f32 v222, v222
 v_exp_f32 v223, v223
 v_smfmac_f32_32x32x32_bf16 v[0:15], v[164:167], v[208:215], v240
 v_exp_f32 v224, v224
 v_exp_f32 v225, v225
 v_exp_f32_e64 v226, v226
 v_smfmac_f32_32x32x32_bf16 v[0:15], v[168:171], v[216:223], v240
 v_exp_f32 v227, v227
 v_exp_f32 v228, v228
 v_exp_f32 v229, v229
 v_exp_f32 v230, v230
 v_exp_f32 v231, v231
 v_exp_f32 v232, v232
 v_exp_f32_e64 v233, v233
 v_mfma_f32_32x32x16_bf16 v[208:223], v[160:163], v[136:139], 0
 buffer_load_dwordx4 v[196:199], v241, s[40:43], s71 offen sc1
 buffer_load_dwordx4 v[200:203], v242, s[40:43], s71 offen offset:1024 sc1
 buffer_load_dwordx4 v[204:207], v243, s[40:43], s71 offen offset:1536 sc1
 v_exp_f32 v234, v234
 v_exp_f32 v235, v235
 v_exp_f32 v236, v236
 v_exp_f32 v237, v237
 v_exp_f32 v238, v238
 v_exp_f32 v239, v239
 v_smfmac_f32_32x32x32_bf16 v[16:31], v[164:167], v[224:231], v240
 v_exp_f32 v208, v208
 v_exp_f32 v209, v209
 v_exp_f32_e64 v210, v210
 v_smfmac_f32_32x32x32_bf16 v[16:31], v[168:171], v[232:239], v240
 v_exp_f32 v211, v211
 v_exp_f32 v212, v212
 v_exp_f32 v213, v213
 v_exp_f32 v214, v214
 v_exp_f32 v215, v215
 v_exp_f32 v216, v216
 v_exp_f32_e64 v217, v217
 v_mfma_f32_32x32x16_bf16 v[224:239], v[160:163], v[140:143], 0
 v_exp_f32 v218, v218
 v_exp_f32 v219, v219
 v_exp_f32 v220, v220
 v_exp_f32 v221, v221
 v_exp_f32 v222, v222
 v_exp_f32 v223, v223
 v_smfmac_f32_32x32x32_bf16 v[32:47], v[164:167], v[208:215], v240
 v_exp_f32 v224, v224
 v_exp_f32 v225, v225
 v_exp_f32_e64 v226, v226
 v_smfmac_f32_32x32x32_bf16 v[32:47], v[168:171], v[216:223], v240
 v_exp_f32 v227, v227
 v_exp_f32 v228, v228
 v_exp_f32 v229, v229
 v_exp_f32 v230, v230
 v_exp_f32 v231, v231
 v_exp_f32 v232, v232
 v_exp_f32_e64 v233, v233
 v_mfma_f32_32x32x16_bf16 v[208:223], v[160:163], v[144:147], 0
 v_exp_f32 v234, v234
 v_exp_f32 v235, v235
 v_exp_f32 v236, v236
 v_exp_f32 v237, v237
 v_exp_f32 v238, v238
 v_exp_f32 v239, v239
 v_smfmac_f32_32x32x32_bf16 v[48:63], v[164:167], v[224:231], v240
 v_exp_f32 v208, v208
 v_exp_f32 v209, v209
 v_exp_f32_e64 v210, v210
 v_smfmac_f32_32x32x32_bf16 v[48:63], v[168:171], v[232:239], v240
 v_exp_f32 v211, v211
 v_exp_f32 v212, v212
 v_exp_f32 v213, v213
 v_exp_f32 v214, v214
 v_exp_f32 v215, v215
 v_exp_f32 v216, v216
 v_exp_f32_e64 v217, v217
 v_mfma_f32_32x32x16_bf16 v[224:239], v[160:163], v[148:151], 0
 v_exp_f32 v218, v218
 v_exp_f32 v219, v219
 v_exp_f32 v220, v220
 v_exp_f32 v221, v221
 v_exp_f32 v222, v222
 v_exp_f32 v223, v223
 v_smfmac_f32_32x32x32_bf16 v[64:79], v[164:167], v[208:215], v240
 v_exp_f32 v224, v224
 v_exp_f32 v225, v225
 v_exp_f32_e64 v226, v226
 v_smfmac_f32_32x32x32_bf16 v[64:79], v[168:171], v[216:223], v240
 v_exp_f32 v227, v227
 v_exp_f32 v228, v228
 v_exp_f32 v229, v229
 v_exp_f32 v230, v230
 v_exp_f32 v231, v231
 v_exp_f32 v232, v232
 v_exp_f32_e64 v233, v233
 v_mfma_f32_32x32x16_bf16 v[208:223], v[160:163], v[152:155], 0
 v_exp_f32 v234, v234
 v_exp_f32 v235, v235
 v_exp_f32 v236, v236
 v_exp_f32 v237, v237
 v_exp_f32 v238, v238
 v_exp_f32 v239, v239
 v_smfmac_f32_32x32x32_bf16 v[80:95], v[164:167], v[224:231], v240
 v_exp_f32 v208, v208
 v_exp_f32 v209, v209
 v_exp_f32_e64 v210, v210
 v_smfmac_f32_32x32x32_bf16 v[80:95], v[168:171], v[232:239], v240
 v_exp_f32 v211, v211
 v_exp_f32 v212, v212
 v_exp_f32 v213, v213
 v_exp_f32 v214, v214
 v_exp_f32 v215, v215
 v_exp_f32 v216, v216
 v_exp_f32_e64 v217, v217
 v_mfma_f32_32x32x16_bf16 v[224:239], v[160:163], v[156:159], 0
 s_waitcnt vmcnt(6)
 v_exp_f32 v218, v218
 v_exp_f32 v219, v219
 v_exp_f32 v220, v220
 v_exp_f32 v221, v221
 v_exp_f32 v222, v222
 v_exp_f32_e64 v223, v223
 v_smfmac_f32_32x32x32_bf16 v[96:111], v[164:167], v[208:215], v240
 v_exp_f32 v224, v224
 v_exp_f32 v225, v225
 v_exp_f32_e64 v226, v226
 v_smfmac_f32_32x32x32_bf16 v[96:111], v[168:171], v[216:223], v240
 v_exp_f32 v227, v227
 v_exp_f32 v228, v228
 v_exp_f32 v229, v229
 v_exp_f32 v230, v230
 v_exp_f32 v231, v231
 v_exp_f32 v232, v232
 v_exp_f32_e64 v233, v233
 v_mfma_f32_32x32x16_bf16 v[208:223], v[172:175], v[128:131], 0
 v_exp_f32 v234, v234
 v_exp_f32 v235, v235
 v_exp_f32 v236, v236
 v_exp_f32 v237, v237
 v_exp_f32 v238, v238
 v_exp_f32 v239, v239
 v_smfmac_f32_32x32x32_bf16 v[112:127], v[164:167], v[224:231], v240
 v_exp_f32 v208, v208
 v_exp_f32 v209, v209
 v_exp_f32_e64 v210, v210
 v_smfmac_f32_32x32x32_bf16 v[112:127], v[168:171], v[232:239], v240
 v_exp_f32 v211, v211
 v_exp_f32 v212, v212
 v_exp_f32 v213, v213
 v_exp_f32 v214, v214
 v_exp_f32 v215, v215
 v_exp_f32 v216, v216
 v_exp_f32_e64 v217, v217
 v_mfma_f32_32x32x16_bf16 v[224:239], v[172:175], v[132:135], 0
 v_exp_f32 v218, v218
 v_exp_f32 v219, v219
 v_exp_f32 v220, v220
 v_exp_f32 v221, v221
 v_exp_f32 v222, v222
 v_exp_f32 v223, v223
 v_smfmac_f32_32x32x32_bf16 v[0:15], v[176:179], v[208:215], v240
 v_exp_f32 v224, v224
 v_exp_f32 v225, v225
 v_exp_f32_e64 v226, v226
 v_smfmac_f32_32x32x32_bf16 v[0:15], v[180:183], v[216:223], v240
 v_exp_f32 v227, v227
 v_exp_f32 v228, v228
 v_exp_f32 v229, v229
 v_exp_f32 v230, v230
 v_exp_f32 v231, v231
 v_exp_f32 v232, v232
 v_exp_f32_e64 v233, v233
 v_mfma_f32_32x32x16_bf16 v[208:223], v[172:175], v[136:139], 0
 buffer_load_dwordx4 v[160:163], v241, s[40:43], s71 offen offset:2176 sc1
 buffer_load_dwordx4 v[164:167], v242, s[40:43], s71 offen offset:3200 sc1
 buffer_load_dwordx4 v[168:171], v243, s[40:43], s71 offen offset:3712 sc1
 s_add_u32 s71, s71, 4352
 v_exp_f32 v234, v234
 v_exp_f32 v235, v235
 v_exp_f32 v236, v236
 v_exp_f32 v237, v237
 v_exp_f32 v238, v238
 v_exp_f32 v239, v239
 v_smfmac_f32_32x32x32_bf16 v[16:31], v[176:179], v[224:231], v240
 v_exp_f32 v208, v208
 v_exp_f32 v209, v209
 v_exp_f32_e64 v210, v210
 v_smfmac_f32_32x32x32_bf16 v[16:31], v[180:183], v[232:239], v240
 v_exp_f32 v211, v211
 v_exp_f32 v212, v212
 v_exp_f32 v213, v213
 v_exp_f32 v214, v214
 v_exp_f32 v215, v215
 v_exp_f32 v216, v216
 v_exp_f32_e64 v217, v217
 v_mfma_f32_32x32x16_bf16 v[224:239], v[172:175], v[140:143], 0
 v_exp_f32 v218, v218
 v_exp_f32 v219, v219
 v_exp_f32 v220, v220
 v_exp_f32 v221, v221
 v_exp_f32 v222, v222
 v_exp_f32 v223, v223
 v_smfmac_f32_32x32x32_bf16 v[32:47], v[176:179], v[208:215], v240
 v_exp_f32 v224, v224
 v_exp_f32 v225, v225
 v_exp_f32_e64 v226, v226
 v_smfmac_f32_32x32x32_bf16 v[32:47], v[180:183], v[216:223], v240
 v_exp_f32 v227, v227
 v_exp_f32 v228, v228
 v_exp_f32 v229, v229
 v_exp_f32 v230, v230
 v_exp_f32 v231, v231
 v_exp_f32 v232, v232
 v_exp_f32_e64 v233, v233
 v_mfma_f32_32x32x16_bf16 v[208:223], v[172:175], v[144:147], 0
 v_exp_f32 v234, v234
 v_exp_f32 v235, v235
 v_exp_f32 v236, v236
 v_exp_f32 v237, v237
 v_exp_f32 v238, v238
 v_exp_f32 v239, v239
 v_smfmac_f32_32x32x32_bf16 v[48:63], v[176:179], v[224:231], v240
 v_exp_f32 v208, v208
 v_exp_f32 v209, v209
 v_exp_f32_e64 v210, v210
 v_smfmac_f32_32x32x32_bf16 v[48:63], v[180:183], v[232:239], v240
 v_exp_f32 v211, v211
 v_exp_f32 v212, v212
 v_exp_f32 v213, v213
 v_exp_f32 v214, v214
 v_exp_f32 v215, v215
 v_exp_f32 v216, v216
 v_exp_f32_e64 v217, v217
 v_mfma_f32_32x32x16_bf16 v[224:239], v[172:175], v[148:151], 0
 v_exp_f32 v218, v218
 v_exp_f32 v219, v219
 v_exp_f32 v220, v220
 v_exp_f32 v221, v221
 v_exp_f32 v222, v222
 v_exp_f32 v223, v223
 v_smfmac_f32_32x32x32_bf16 v[64:79], v[176:179], v[208:215], v240
 v_exp_f32 v224, v224
 v_exp_f32 v225, v225
 v_exp_f32_e64 v226, v226
 v_smfmac_f32_32x32x32_bf16 v[64:79], v[180:183], v[216:223], v240
 v_exp_f32 v227, v227
 v_exp_f32 v228, v228
 v_exp_f32 v229, v229
 v_exp_f32 v230, v230
 v_exp_f32 v231, v231
 v_exp_f32 v232, v232
 v_exp_f32_e64 v233, v233
 v_mfma_f32_32x32x16_bf16 v[208:223], v[172:175], v[152:155], 0
 v_exp_f32 v234, v234
 v_exp_f32 v235, v235
 v_exp_f32 v236, v236
 v_exp_f32 v237, v237
 v_exp_f32 v238, v238
 v_exp_f32 v239, v239
 v_smfmac_f32_32x32x32_bf16 v[80:95], v[176:179], v[224:231], v240
 v_exp_f32 v208, v208
 v_exp_f32 v209, v209
 v_exp_f32_e64 v210, v210
 v_smfmac_f32_32x32x32_bf16 v[80:95], v[180:183], v[232:239], v240
 v_exp_f32 v211, v211
 v_exp_f32 v212, v212
 v_exp_f32 v213, v213
 v_exp_f32 v214, v214
 v_exp_f32 v215, v215
 v_exp_f32 v216, v216
 v_exp_f32_e64 v217, v217
 v_mfma_f32_32x32x16_bf16 v[224:239], v[172:175], v[156:159], 0
 s_waitcnt vmcnt(6)
 v_exp_f32 v218, v218
 v_exp_f32 v219, v219
 v_exp_f32 v220, v220
 v_exp_f32 v221, v221
 v_exp_f32 v222, v222
 v_exp_f32_e64 v223, v223
 v_smfmac_f32_32x32x32_bf16 v[96:111], v[176:179], v[208:215], v240
 v_exp_f32 v224, v224
 v_exp_f32 v225, v225
 v_exp_f32_e64 v226, v226
 v_smfmac_f32_32x32x32_bf16 v[96:111], v[180:183], v[216:223], v240
 v_exp_f32 v227, v227
 v_exp_f32 v228, v228
 v_exp_f32 v229, v229
 v_exp_f32 v230, v230
 v_exp_f32 v231, v231
 v_exp_f32 v232, v232
 v_exp_f32_e64 v233, v233
 v_mfma_f32_32x32x16_bf16 v[208:223], v[184:187], v[128:131], 0
 v_exp_f32 v234, v234
 v_exp_f32 v235, v235
 v_exp_f32 v236, v236
 v_exp_f32 v237, v237
 v_exp_f32 v238, v238
 v_exp_f32 v239, v239
 v_smfmac_f32_32x32x32_bf16 v[112:127], v[176:179], v[224:231], v240
 v_exp_f32 v208, v208
 v_exp_f32 v209, v209
 v_exp_f32_e64 v210, v210
 v_smfmac_f32_32x32x32_bf16 v[112:127], v[180:183], v[232:239], v240
 v_exp_f32 v211, v211
 v_exp_f32 v212, v212
 v_exp_f32 v213, v213
 v_exp_f32 v214, v214
 v_exp_f32 v215, v215
 v_exp_f32 v216, v216
 v_exp_f32_e64 v217, v217
 v_mfma_f32_32x32x16_bf16 v[224:239], v[184:187], v[132:135], 0
 v_exp_f32 v218, v218
 v_exp_f32 v219, v219
 v_exp_f32 v220, v220
 v_exp_f32 v221, v221
 v_exp_f32 v222, v222
 v_exp_f32 v223, v223
 v_smfmac_f32_32x32x32_bf16 v[0:15], v[188:191], v[208:215], v240
 v_exp_f32 v224, v224
 v_exp_f32 v225, v225
 v_exp_f32_e64 v226, v226
 v_smfmac_f32_32x32x32_bf16 v[0:15], v[192:195], v[216:223], v240
 v_exp_f32 v227, v227
 v_exp_f32 v228, v228
 v_exp_f32 v229, v229
 v_exp_f32 v230, v230
 v_exp_f32 v231, v231
 v_exp_f32 v232, v232
 v_exp_f32_e64 v233, v233
 v_mfma_f32_32x32x16_bf16 v[208:223], v[184:187], v[136:139], 0
 buffer_load_dwordx4 v[172:175], v241, s[40:43], s71 offen sc1
 buffer_load_dwordx4 v[176:179], v242, s[40:43], s71 offen offset:1024 sc1
 buffer_load_dwordx4 v[180:183], v243, s[40:43], s71 offen offset:1536 sc1
 v_exp_f32 v234, v234
 v_exp_f32 v235, v235
 v_exp_f32 v236, v236
 v_exp_f32 v237, v237
 v_exp_f32 v238, v238
 v_exp_f32 v239, v239
 v_smfmac_f32_32x32x32_bf16 v[16:31], v[188:191], v[224:231], v240
 v_exp_f32 v208, v208
 v_exp_f32 v209, v209
 v_exp_f32_e64 v210, v210
 v_smfmac_f32_32x32x32_bf16 v[16:31], v[192:195], v[232:239], v240
 v_exp_f32 v211, v211
 v_exp_f32 v212, v212
 v_exp_f32 v213, v213
 v_exp_f32 v214, v214
 v_exp_f32 v215, v215
 v_exp_f32 v216, v216
 v_exp_f32_e64 v217, v217
 v_mfma_f32_32x32x16_bf16 v[224:239], v[184:187], v[140:143], 0
 v_exp_f32 v218, v218
 v_exp_f32 v219, v219
 v_exp_f32 v220, v220
 v_exp_f32 v221, v221
 v_exp_f32 v222, v222
 v_exp_f32 v223, v223
 v_smfmac_f32_32x32x32_bf16 v[32:47], v[188:191], v[208:215], v240
 v_exp_f32 v224, v224
 v_exp_f32 v225, v225
 v_exp_f32_e64 v226, v226
 v_smfmac_f32_32x32x32_bf16 v[32:47], v[192:195], v[216:223], v240
 v_exp_f32 v227, v227
 v_exp_f32 v228, v228
 v_exp_f32 v229, v229
 v_exp_f32 v230, v230
 v_exp_f32 v231, v231
 v_exp_f32 v232, v232
 v_exp_f32_e64 v233, v233
 v_mfma_f32_32x32x16_bf16 v[208:223], v[184:187], v[144:147], 0
 v_exp_f32 v234, v234
 v_exp_f32 v235, v235
 v_exp_f32 v236, v236
 v_exp_f32 v237, v237
 v_exp_f32 v238, v238
 v_exp_f32 v239, v239
 v_smfmac_f32_32x32x32_bf16 v[48:63], v[188:191], v[224:231], v240
 v_exp_f32 v208, v208
 v_exp_f32 v209, v209
 v_exp_f32_e64 v210, v210
 v_smfmac_f32_32x32x32_bf16 v[48:63], v[192:195], v[232:239], v240
 v_exp_f32 v211, v211
 v_exp_f32 v212, v212
 v_exp_f32 v213, v213
 v_exp_f32 v214, v214
 v_exp_f32 v215, v215
 v_exp_f32 v216, v216
 v_exp_f32_e64 v217, v217
 v_mfma_f32_32x32x16_bf16 v[224:239], v[184:187], v[148:151], 0
 v_exp_f32 v218, v218
 v_exp_f32 v219, v219
 v_exp_f32 v220, v220
 v_exp_f32 v221, v221
 v_exp_f32 v222, v222
 v_exp_f32 v223, v223
 v_smfmac_f32_32x32x32_bf16 v[64:79], v[188:191], v[208:215], v240
 v_exp_f32 v224, v224
 v_exp_f32 v225, v225
 v_exp_f32_e64 v226, v226
 v_smfmac_f32_32x32x32_bf16 v[64:79], v[192:195], v[216:223], v240
 v_exp_f32 v227, v227
 v_exp_f32 v228, v228
 v_exp_f32 v229, v229
 v_exp_f32 v230, v230
 v_exp_f32 v231, v231
 v_exp_f32 v232, v232
 v_exp_f32_e64 v233, v233
 v_mfma_f32_32x32x16_bf16 v[208:223], v[184:187], v[152:155], 0
 v_exp_f32 v234, v234
 v_exp_f32 v235, v235
 v_exp_f32 v236, v236
 v_exp_f32 v237, v237
 v_exp_f32 v238, v238
 v_exp_f32 v239, v239
 v_smfmac_f32_32x32x32_bf16 v[80:95], v[188:191], v[224:231], v240
 v_exp_f32 v208, v208
 v_exp_f32 v209, v209
 v_exp_f32_e64 v210, v210
 v_smfmac_f32_32x32x32_bf16 v[80:95], v[192:195], v[232:239], v240
 v_exp_f32 v211, v211
 v_exp_f32 v212, v212
 v_exp_f32 v213, v213
 v_exp_f32 v214, v214
 v_exp_f32 v215, v215
 v_exp_f32 v216, v216
 v_exp_f32_e64 v217, v217
 v_mfma_f32_32x32x16_bf16 v[224:239], v[184:187], v[156:159], 0
 s_waitcnt vmcnt(6)
 v_exp_f32 v218, v218
 v_exp_f32 v219, v219
 v_exp_f32 v220, v220
 v_exp_f32 v221, v221
 v_exp_f32 v222, v222
 v_exp_f32_e64 v223, v223
 v_smfmac_f32_32x32x32_bf16 v[96:111], v[188:191], v[208:215], v240
 v_exp_f32 v224, v224
 v_exp_f32 v225, v225
 v_exp_f32_e64 v226, v226
 v_smfmac_f32_32x32x32_bf16 v[96:111], v[192:195], v[216:223], v240
 v_exp_f32 v227, v227
 v_exp_f32 v228, v228
 v_exp_f32 v229, v229
 v_exp_f32 v230, v230
 v_exp_f32 v231, v231
 v_exp_f32 v232, v232
 v_exp_f32_e64 v233, v233
 v_mfma_f32_32x32x16_bf16 v[208:223], v[196:199], v[128:131], 0
 v_exp_f32 v234, v234
 v_exp_f32 v235, v235
 v_exp_f32 v236, v236
 v_exp_f32 v237, v237
 v_exp_f32 v238, v238
 v_exp_f32 v239, v239
 v_smfmac_f32_32x32x32_bf16 v[112:127], v[188:191], v[224:231], v240
 v_exp_f32 v208, v208
 v_exp_f32 v209, v209
 v_exp_f32_e64 v210, v210
 v_smfmac_f32_32x32x32_bf16 v[112:127], v[192:195], v[232:239], v240
 v_exp_f32 v211, v211
 v_exp_f32 v212, v212
 v_exp_f32 v213, v213
 v_exp_f32 v214, v214
 v_exp_f32 v215, v215
 v_exp_f32 v216, v216
 v_exp_f32_e64 v217, v217
 v_mfma_f32_32x32x16_bf16 v[224:239], v[196:199], v[132:135], 0
 v_exp_f32 v218, v218
 v_exp_f32 v219, v219
 v_exp_f32 v220, v220
 v_exp_f32 v221, v221
 v_exp_f32 v222, v222
 v_exp_f32 v223, v223
 v_smfmac_f32_32x32x32_bf16 v[0:15], v[200:203], v[208:215], v240
 v_exp_f32 v224, v224
 v_exp_f32 v225, v225
 v_exp_f32_e64 v226, v226
 v_smfmac_f32_32x32x32_bf16 v[0:15], v[204:207], v[216:223], v240
 v_exp_f32 v227, v227
 v_exp_f32 v228, v228
 v_exp_f32 v229, v229
 v_exp_f32 v230, v230
 v_exp_f32 v231, v231
 v_exp_f32 v232, v232
 v_exp_f32_e64 v233, v233
 v_mfma_f32_32x32x16_bf16 v[208:223], v[196:199], v[136:139], 0
 buffer_load_dwordx4 v[184:187], v241, s[40:43], s71 offen offset:2176 sc1
 buffer_load_dwordx4 v[188:191], v242, s[40:43], s71 offen offset:3200 sc1
 buffer_load_dwordx4 v[192:195], v243, s[40:43], s71 offen offset:3712 sc1
 s_add_u32 s71, s71, 4352
 v_exp_f32 v234, v234
 v_exp_f32 v235, v235
 v_exp_f32 v236, v236
 v_exp_f32 v237, v237
 v_exp_f32 v238, v238
 v_exp_f32 v239, v239
 v_smfmac_f32_32x32x32_bf16 v[16:31], v[200:203], v[224:231], v240
 v_exp_f32 v208, v208
 v_exp_f32 v209, v209
 v_exp_f32_e64 v210, v210
 v_smfmac_f32_32x32x32_bf16 v[16:31], v[204:207], v[232:239], v240
 v_exp_f32 v211, v211
 v_exp_f32 v212, v212
 v_exp_f32 v213, v213
 v_exp_f32 v214, v214
 v_exp_f32 v215, v215
 v_exp_f32 v216, v216
 v_exp_f32_e64 v217, v217
 v_mfma_f32_32x32x16_bf16 v[224:239], v[196:199], v[140:143], 0
 v_exp_f32 v218, v218
 v_exp_f32 v219, v219
 v_exp_f32 v220, v220
 v_exp_f32 v221, v221
 v_exp_f32 v222, v222
 v_exp_f32 v223, v223
 v_smfmac_f32_32x32x32_bf16 v[32:47], v[200:203], v[208:215], v240
 v_exp_f32 v224, v224
 v_exp_f32 v225, v225
 v_exp_f32_e64 v226, v226
 v_smfmac_f32_32x32x32_bf16 v[32:47], v[204:207], v[216:223], v240
 v_exp_f32 v227, v227
 v_exp_f32 v228, v228
 v_exp_f32 v229, v229
 v_exp_f32 v230, v230
 v_exp_f32 v231, v231
 v_exp_f32 v232, v232
 v_exp_f32_e64 v233, v233
 v_mfma_f32_32x32x16_bf16 v[208:223], v[196:199], v[144:147], 0
 v_exp_f32 v234, v234
 v_exp_f32 v235, v235
 v_exp_f32 v236, v236
 v_exp_f32 v237, v237
 v_exp_f32 v238, v238
 v_exp_f32 v239, v239
 v_smfmac_f32_32x32x32_bf16 v[48:63], v[200:203], v[224:231], v240
 v_exp_f32 v208, v208
 v_exp_f32 v209, v209
 v_exp_f32_e64 v210, v210
 v_smfmac_f32_32x32x32_bf16 v[48:63], v[204:207], v[232:239], v240
 v_exp_f32 v211, v211
 v_exp_f32 v212, v212
 v_exp_f32 v213, v213
 v_exp_f32 v214, v214
 v_exp_f32 v215, v215
 v_exp_f32 v216, v216
 v_exp_f32_e64 v217, v217
 v_mfma_f32_32x32x16_bf16 v[224:239], v[196:199], v[148:151], 0
 v_exp_f32 v218, v218
 v_exp_f32 v219, v219
 v_exp_f32 v220, v220
 v_exp_f32 v221, v221
 v_exp_f32 v222, v222
 v_exp_f32 v223, v223
 v_smfmac_f32_32x32x32_bf16 v[64:79], v[200:203], v[208:215], v240
 v_exp_f32 v224, v224
 v_exp_f32 v225, v225
 v_exp_f32_e64 v226, v226
 v_smfmac_f32_32x32x32_bf16 v[64:79], v[204:207], v[216:223], v240
 v_exp_f32 v227, v227
 v_exp_f32 v228, v228
 v_exp_f32 v229, v229
 v_exp_f32 v230, v230
 v_exp_f32 v231, v231
 v_exp_f32 v232, v232
 v_exp_f32_e64 v233, v233
 v_mfma_f32_32x32x16_bf16 v[208:223], v[196:199], v[152:155], 0
 v_exp_f32 v234, v234
 v_exp_f32 v235, v235
 v_exp_f32 v236, v236
 v_exp_f32 v237, v237
 v_exp_f32 v238, v238
 v_exp_f32 v239, v239
 v_smfmac_f32_32x32x32_bf16 v[80:95], v[200:203], v[224:231], v240
 v_exp_f32 v208, v208
 v_exp_f32 v209, v209
 v_exp_f32_e64 v210, v210
 v_smfmac_f32_32x32x32_bf16 v[80:95], v[204:207], v[232:239], v240
 v_exp_f32 v211, v211
 v_exp_f32 v212, v212
 v_exp_f32 v213, v213
 v_exp_f32 v214, v214
 v_exp_f32 v215, v215
 v_exp_f32 v216, v216
 v_exp_f32_e64 v217, v217
 v_mfma_f32_32x32x16_bf16 v[224:239], v[196:199], v[156:159], 0
 s_waitcnt vmcnt(6)
 v_exp_f32 v218, v218
 v_exp_f32 v219, v219
 v_exp_f32 v220, v220
 v_exp_f32 v221, v221
 v_exp_f32 v222, v222
 v_exp_f32_e64 v223, v223
 v_smfmac_f32_32x32x32_bf16 v[96:111], v[200:203], v[208:215], v240
 v_exp_f32 v224, v224
 v_exp_f32 v225, v225
 v_exp_f32_e64 v226, v226
 v_smfmac_f32_32x32x32_bf16 v[96:111], v[204:207], v[216:223], v240
 v_exp_f32 v227, v227
 v_exp_f32 v228, v228
 v_exp_f32 v229, v229
 v_exp_f32 v230, v230
 v_exp_f32 v231, v231
 v_exp_f32 v232, v232
 v_exp_f32_e64 v233, v233
 v_mfma_f32_32x32x16_bf16 v[208:223], v[160:163], v[128:131], 0
 v_exp_f32 v234, v234
 v_exp_f32 v235, v235
 v_exp_f32 v236, v236
 v_exp_f32 v237, v237
 v_exp_f32 v238, v238
 v_exp_f32 v239, v239
 v_smfmac_f32_32x32x32_bf16 v[112:127], v[200:203], v[224:231], v240
 v_exp_f32 v208, v208
 v_exp_f32 v209, v209
 v_exp_f32_e64 v210, v210
 v_smfmac_f32_32x32x32_bf16 v[112:127], v[204:207], v[232:239], v240
 v_exp_f32 v211, v211
 v_exp_f32 v212, v212
 v_exp_f32 v213, v213
 v_exp_f32 v214, v214
 v_exp_f32 v215, v215
 v_exp_f32 v216, v216
 v_exp_f32_e64 v217, v217
 v_mfma_f32_32x32x16_bf16 v[224:239], v[160:163], v[132:135], 0
 v_exp_f32 v218, v218
 v_exp_f32 v219, v219
 v_exp_f32 v220, v220
 v_exp_f32 v221, v221
 v_exp_f32 v222, v222
 v_exp_f32 v223, v223
 v_smfmac_f32_32x32x32_bf16 v[0:15], v[164:167], v[208:215], v240
 v_exp_f32 v224, v224
 v_exp_f32 v225, v225
 v_exp_f32_e64 v226, v226
 v_smfmac_f32_32x32x32_bf16 v[0:15], v[168:171], v[216:223], v240
 v_exp_f32 v227, v227
 v_exp_f32 v228, v228
 v_exp_f32 v229, v229
 v_exp_f32 v230, v230
 v_exp_f32 v231, v231
 v_exp_f32 v232, v232
 v_exp_f32_e64 v233, v233
 v_mfma_f32_32x32x16_bf16 v[208:223], v[160:163], v[136:139], 0
 buffer_load_dwordx4 v[196:199], v241, s[40:43], s71 offen sc1
 buffer_load_dwordx4 v[200:203], v242, s[40:43], s71 offen offset:1024 sc1
 buffer_load_dwordx4 v[204:207], v243, s[40:43], s71 offen offset:1536 sc1
 v_exp_f32 v234, v234
 v_exp_f32 v235, v235
 v_exp_f32 v236, v236
 v_exp_f32 v237, v237
 v_exp_f32 v238, v238
 v_exp_f32 v239, v239
 v_smfmac_f32_32x32x32_bf16 v[16:31], v[164:167], v[224:231], v240
 v_exp_f32 v208, v208
 v_exp_f32 v209, v209
 v_exp_f32_e64 v210, v210
 v_smfmac_f32_32x32x32_bf16 v[16:31], v[168:171], v[232:239], v240
 v_exp_f32 v211, v211
 v_exp_f32 v212, v212
 v_exp_f32 v213, v213
 v_exp_f32 v214, v214
 v_exp_f32 v215, v215
 v_exp_f32 v216, v216
 v_exp_f32_e64 v217, v217
 v_mfma_f32_32x32x16_bf16 v[224:239], v[160:163], v[140:143], 0
 v_exp_f32 v218, v218
 v_exp_f32 v219, v219
 v_exp_f32 v220, v220
 v_exp_f32 v221, v221
 v_exp_f32 v222, v222
 v_exp_f32 v223, v223
 v_smfmac_f32_32x32x32_bf16 v[32:47], v[164:167], v[208:215], v240
 v_exp_f32 v224, v224
 v_exp_f32 v225, v225
 v_exp_f32_e64 v226, v226
 v_smfmac_f32_32x32x32_bf16 v[32:47], v[168:171], v[216:223], v240
 v_exp_f32 v227, v227
 v_exp_f32 v228, v228
 v_exp_f32 v229, v229
 v_exp_f32 v230, v230
 v_exp_f32 v231, v231
 v_exp_f32 v232, v232
 v_exp_f32_e64 v233, v233
 v_mfma_f32_32x32x16_bf16 v[208:223], v[160:163], v[144:147], 0
 v_exp_f32 v234, v234
 v_exp_f32 v235, v235
 v_exp_f32 v236, v236
 v_exp_f32 v237, v237
 v_exp_f32 v238, v238
 v_exp_f32 v239, v239
 v_smfmac_f32_32x32x32_bf16 v[48:63], v[164:167], v[224:231], v240
 v_exp_f32 v208, v208
 v_exp_f32 v209, v209
 v_exp_f32_e64 v210, v210
 v_smfmac_f32_32x32x32_bf16 v[48:63], v[168:171], v[232:239], v240
 v_exp_f32 v211, v211
 v_exp_f32 v212, v212
 v_exp_f32 v213, v213
 v_exp_f32 v214, v214
 v_exp_f32 v215, v215
 v_exp_f32 v216, v216
 v_exp_f32_e64 v217, v217
 v_mfma_f32_32x32x16_bf16 v[224:239], v[160:163], v[148:151], 0
 v_exp_f32 v218, v218
 v_exp_f32 v219, v219
 v_exp_f32 v220, v220
 v_exp_f32 v221, v221
 v_exp_f32 v222, v222
 v_exp_f32 v223, v223
 v_smfmac_f32_32x32x32_bf16 v[64:79], v[164:167], v[208:215], v240
 v_exp_f32 v224, v224
 v_exp_f32 v225, v225
 v_exp_f32_e64 v226, v226
 v_smfmac_f32_32x32x32_bf16 v[64:79], v[168:171], v[216:223], v240
 v_exp_f32 v227, v227
 v_exp_f32 v228, v228
 v_exp_f32 v229, v229
 v_exp_f32 v230, v230
 v_exp_f32 v231, v231
 v_exp_f32 v232, v232
 v_exp_f32_e64 v233, v233
 v_mfma_f32_32x32x16_bf16 v[208:223], v[160:163], v[152:155], 0
 v_exp_f32 v234, v234
 v_exp_f32 v235, v235
 v_exp_f32 v236, v236
 v_exp_f32 v237, v237
 v_exp_f32 v238, v238
 v_exp_f32 v239, v239
 v_smfmac_f32_32x32x32_bf16 v[80:95], v[164:167], v[224:231], v240
 v_exp_f32 v208, v208
 v_exp_f32 v209, v209
 v_exp_f32_e64 v210, v210
 v_smfmac_f32_32x32x32_bf16 v[80:95], v[168:171], v[232:239], v240
 v_exp_f32 v211, v211
 v_exp_f32 v212, v212
 v_exp_f32 v213, v213
 v_exp_f32 v214, v214
 v_exp_f32 v215, v215
 v_exp_f32 v216, v216
 v_exp_f32_e64 v217, v217
 v_mfma_f32_32x32x16_bf16 v[224:239], v[160:163], v[156:159], 0
 s_waitcnt vmcnt(6)
 v_exp_f32 v218, v218
 v_exp_f32 v219, v219
 v_exp_f32 v220, v220
 v_exp_f32 v221, v221
 v_exp_f32 v222, v222
 v_exp_f32_e64 v223, v223
 v_smfmac_f32_32x32x32_bf16 v[96:111], v[164:167], v[208:215], v240
 v_exp_f32 v224, v224
 v_exp_f32 v225, v225
 v_exp_f32_e64 v226, v226
 v_smfmac_f32_32x32x32_bf16 v[96:111], v[168:171], v[216:223], v240
 v_exp_f32 v227, v227
 v_exp_f32 v228, v228
 v_exp_f32 v229, v229
 v_exp_f32 v230, v230
 v_exp_f32 v231, v231
 v_exp_f32 v232, v232
 v_exp_f32_e64 v233, v233
 v_mfma_f32_32x32x16_bf16 v[208:223], v[172:175], v[128:131], 0
 v_exp_f32 v234, v234
 v_exp_f32 v235, v235
 v_exp_f32 v236, v236
 v_exp_f32 v237, v237
 v_exp_f32 v238, v238
 v_exp_f32 v239, v239
 v_smfmac_f32_32x32x32_bf16 v[112:127], v[164:167], v[224:231], v240
 v_exp_f32 v208, v208
 v_exp_f32 v209, v209
 v_exp_f32_e64 v210, v210
 v_smfmac_f32_32x32x32_bf16 v[112:127], v[168:171], v[232:239], v240
 v_exp_f32 v211, v211
 v_exp_f32 v212, v212
 v_exp_f32 v213, v213
 v_exp_f32 v214, v214
 v_exp_f32 v215, v215
 v_exp_f32 v216, v216
 v_exp_f32_e64 v217, v217
 v_mfma_f32_32x32x16_bf16 v[224:239], v[172:175], v[132:135], 0
 v_exp_f32 v218, v218
 v_exp_f32 v219, v219
 v_exp_f32 v220, v220
 v_exp_f32 v221, v221
 v_exp_f32 v222, v222
 v_exp_f32 v223, v223
 v_smfmac_f32_32x32x32_bf16 v[0:15], v[176:179], v[208:215], v240
 v_exp_f32 v224, v224
 v_exp_f32 v225, v225
 v_exp_f32_e64 v226, v226
 v_smfmac_f32_32x32x32_bf16 v[0:15], v[180:183], v[216:223], v240
 v_exp_f32 v227, v227
 v_exp_f32 v228, v228
 v_exp_f32 v229, v229
 v_exp_f32 v230, v230
 v_exp_f32 v231, v231
 v_exp_f32 v232, v232
 v_exp_f32_e64 v233, v233
 v_mfma_f32_32x32x16_bf16 v[208:223], v[172:175], v[136:139], 0
 v_exp_f32 v234, v234
 v_exp_f32 v235, v235
 v_exp_f32 v236, v236
 v_exp_f32 v237, v237
 v_exp_f32 v238, v238
 v_exp_f32 v239, v239
 v_smfmac_f32_32x32x32_bf16 v[16:31], v[176:179], v[224:231], v240
 v_exp_f32 v208, v208
 v_exp_f32 v209, v209
 v_exp_f32_e64 v210, v210
 v_smfmac_f32_32x32x32_bf16 v[16:31], v[180:183], v[232:239], v240
 v_exp_f32 v211, v211
 v_exp_f32 v212, v212
 v_exp_f32 v213, v213
 v_exp_f32 v214, v214
 v_exp_f32 v215, v215
 v_exp_f32 v216, v216
 v_exp_f32_e64 v217, v217
 v_mfma_f32_32x32x16_bf16 v[224:239], v[172:175], v[140:143], 0
 v_exp_f32 v218, v218
 v_exp_f32 v219, v219
 v_exp_f32 v220, v220
 v_exp_f32 v221, v221
 v_exp_f32 v222, v222
 v_exp_f32 v223, v223
 v_smfmac_f32_32x32x32_bf16 v[32:47], v[176:179], v[208:215], v240
 v_exp_f32 v224, v224
 v_exp_f32 v225, v225
 v_exp_f32_e64 v226, v226
 v_smfmac_f32_32x32x32_bf16 v[32:47], v[180:183], v[216:223], v240
 v_exp_f32 v227, v227
 v_exp_f32 v228, v228
 v_exp_f32 v229, v229
 v_exp_f32 v230, v230
 v_exp_f32 v231, v231
 v_exp_f32 v232, v232
 v_exp_f32_e64 v233, v233
 v_mfma_f32_32x32x16_bf16 v[208:223], v[172:175], v[144:147], 0
 v_exp_f32 v234, v234
 v_exp_f32 v235, v235
 v_exp_f32 v236, v236
 v_exp_f32 v237, v237
 v_exp_f32 v238, v238
 v_exp_f32 v239, v239
 v_smfmac_f32_32x32x32_bf16 v[48:63], v[176:179], v[224:231], v240
 v_exp_f32 v208, v208
 v_exp_f32 v209, v209
 v_exp_f32_e64 v210, v210
 v_smfmac_f32_32x32x32_bf16 v[48:63], v[180:183], v[232:239], v240
 v_exp_f32 v211, v211
 v_exp_f32 v212, v212
 v_exp_f32 v213, v213
 v_exp_f32 v214, v214
 v_exp_f32 v215, v215
 v_exp_f32 v216, v216
 v_exp_f32_e64 v217, v217
 v_mfma_f32_32x32x16_bf16 v[224:239], v[172:175], v[148:151], 0
 v_exp_f32 v218, v218
 v_exp_f32 v219, v219
 v_exp_f32 v220, v220
 v_exp_f32 v221, v221
 v_exp_f32 v222, v222
 v_exp_f32 v223, v223
 v_smfmac_f32_32x32x32_bf16 v[64:79], v[176:179], v[208:215], v240
 v_exp_f32 v224, v224
 v_exp_f32 v225, v225
 v_exp_f32_e64 v226, v226
 v_smfmac_f32_32x32x32_bf16 v[64:79], v[180:183], v[216:223], v240
 v_exp_f32 v227, v227
 v_exp_f32 v228, v228
 v_exp_f32 v229, v229
 v_exp_f32 v230, v230
 v_exp_f32 v231, v231
 v_exp_f32 v232, v232
 v_exp_f32_e64 v233, v233
 v_mfma_f32_32x32x16_bf16 v[208:223], v[172:175], v[152:155], 0
 v_exp_f32 v234, v234
 v_exp_f32 v235, v235
 v_exp_f32 v236, v236
 v_exp_f32 v237, v237
 v_exp_f32 v238, v238
 v_exp_f32 v239, v239
 v_smfmac_f32_32x32x32_bf16 v[80:95], v[176:179], v[224:231], v240
 v_exp_f32 v208, v208
 v_exp_f32 v209, v209
 v_exp_f32_e64 v210, v210
 v_smfmac_f32_32x32x32_bf16 v[80:95], v[180:183], v[232:239], v240
 v_exp_f32 v211, v211
 v_exp_f32 v212, v212
 v_exp_f32 v213, v213
 v_exp_f32 v214, v214
 v_exp_f32 v215, v215
 v_exp_f32 v216, v216
 v_exp_f32_e64 v217, v217
 v_mfma_f32_32x32x16_bf16 v[224:239], v[172:175], v[156:159], 0
 s_waitcnt vmcnt(3)
 v_exp_f32 v218, v218
 v_exp_f32 v219, v219
 v_exp_f32 v220, v220
 v_exp_f32 v221, v221
 v_exp_f32 v222, v222
 v_exp_f32_e64 v223, v223
 v_smfmac_f32_32x32x32_bf16 v[96:111], v[176:179], v[208:215], v240
 v_exp_f32 v224, v224
 v_exp_f32 v225, v225
 v_exp_f32_e64 v226, v226
 v_smfmac_f32_32x32x32_bf16 v[96:111], v[180:183], v[216:223], v240
 v_exp_f32 v227, v227
 v_exp_f32 v228, v228
 v_exp_f32 v229, v229
 v_exp_f32 v230, v230
 v_exp_f32 v231, v231
 v_exp_f32 v232, v232
 v_exp_f32_e64 v233, v233
 v_mfma_f32_32x32x16_bf16 v[208:223], v[184:187], v[128:131], 0
 v_exp_f32 v234, v234
 v_exp_f32 v235, v235
 v_exp_f32 v236, v236
 v_exp_f32 v237, v237
 v_exp_f32 v238, v238
 v_exp_f32 v239, v239
 v_smfmac_f32_32x32x32_bf16 v[112:127], v[176:179], v[224:231], v240
 v_exp_f32 v208, v208
 v_exp_f32 v209, v209
 v_exp_f32_e64 v210, v210
 v_smfmac_f32_32x32x32_bf16 v[112:127], v[180:183], v[232:239], v240
 v_exp_f32 v211, v211
 v_exp_f32 v212, v212
 v_exp_f32 v213, v213
 v_exp_f32 v214, v214
 v_exp_f32 v215, v215
 v_exp_f32 v216, v216
 v_exp_f32_e64 v217, v217
 v_mfma_f32_32x32x16_bf16 v[224:239], v[184:187], v[132:135], 0
 v_exp_f32 v218, v218
 v_exp_f32 v219, v219
 v_exp_f32 v220, v220
 v_exp_f32 v221, v221
 v_exp_f32 v222, v222
 v_exp_f32 v223, v223
 v_smfmac_f32_32x32x32_bf16 v[0:15], v[188:191], v[208:215], v240
 v_exp_f32 v224, v224
 v_exp_f32 v225, v225
 v_exp_f32_e64 v226, v226
 v_smfmac_f32_32x32x32_bf16 v[0:15], v[192:195], v[216:223], v240
 v_exp_f32 v227, v227
 v_exp_f32 v228, v228
 v_exp_f32 v229, v229
 v_exp_f32 v230, v230
 v_exp_f32 v231, v231
 v_exp_f32 v232, v232
 v_exp_f32_e64 v233, v233
 v_mfma_f32_32x32x16_bf16 v[208:223], v[184:187], v[136:139], 0
 v_exp_f32 v234, v234
 v_exp_f32 v235, v235
 v_exp_f32 v236, v236
 v_exp_f32 v237, v237
 v_exp_f32 v238, v238
 v_exp_f32 v239, v239
 v_smfmac_f32_32x32x32_bf16 v[16:31], v[188:191], v[224:231], v240
 v_exp_f32 v208, v208
 v_exp_f32 v209, v209
 v_exp_f32_e64 v210, v210
 v_smfmac_f32_32x32x32_bf16 v[16:31], v[192:195], v[232:239], v240
 v_exp_f32 v211, v211
 v_exp_f32 v212, v212
 v_exp_f32 v213, v213
 v_exp_f32 v214, v214
 v_exp_f32 v215, v215
 v_exp_f32 v216, v216
 v_exp_f32_e64 v217, v217
 v_mfma_f32_32x32x16_bf16 v[224:239], v[184:187], v[140:143], 0
 v_exp_f32 v218, v218
 v_exp_f32 v219, v219
 v_exp_f32 v220, v220
 v_exp_f32 v221, v221
 v_exp_f32 v222, v222
 v_exp_f32 v223, v223
 v_smfmac_f32_32x32x32_bf16 v[32:47], v[188:191], v[208:215], v240
 v_exp_f32 v224, v224
 v_exp_f32 v225, v225
 v_exp_f32_e64 v226, v226
 v_smfmac_f32_32x32x32_bf16 v[32:47], v[192:195], v[216:223], v240
 v_exp_f32 v227, v227
 v_exp_f32 v228, v228
 v_exp_f32 v229, v229
 v_exp_f32 v230, v230
 v_exp_f32 v231, v231
 v_exp_f32 v232, v232
 v_exp_f32_e64 v233, v233
 v_mfma_f32_32x32x16_bf16 v[208:223], v[184:187], v[144:147], 0
 v_exp_f32 v234, v234
 v_exp_f32 v235, v235
 v_exp_f32 v236, v236
 v_exp_f32 v237, v237
 v_exp_f32 v238, v238
 v_exp_f32 v239, v239
 v_smfmac_f32_32x32x32_bf16 v[48:63], v[188:191], v[224:231], v240
 v_exp_f32 v208, v208
 v_exp_f32 v209, v209
 v_exp_f32_e64 v210, v210
 v_smfmac_f32_32x32x32_bf16 v[48:63], v[192:195], v[232:239], v240
 v_exp_f32 v211, v211
 v_exp_f32 v212, v212
 v_exp_f32 v213, v213
 v_exp_f32 v214, v214
 v_exp_f32 v215, v215
 v_exp_f32 v216, v216
 v_exp_f32_e64 v217, v217
 v_mfma_f32_32x32x16_bf16 v[224:239], v[184:187], v[148:151], 0
 v_exp_f32 v218, v218
 v_exp_f32 v219, v219
 v_exp_f32 v220, v220
 v_exp_f32 v221, v221
 v_exp_f32 v222, v222
 v_exp_f32 v223, v223
 v_smfmac_f32_32x32x32_bf16 v[64:79], v[188:191], v[208:215], v240
 v_exp_f32 v224, v224
 v_exp_f32 v225, v225
 v_exp_f32_e64 v226, v226
 v_smfmac_f32_32x32x32_bf16 v[64:79], v[192:195], v[216:223], v240
 v_exp_f32 v227, v227
 v_exp_f32 v228, v228
 v_exp_f32 v229, v229
 v_exp_f32 v230, v230
 v_exp_f32 v231, v231
 v_exp_f32 v232, v232
 v_exp_f32_e64 v233, v233
 v_mfma_f32_32x32x16_bf16 v[208:223], v[184:187], v[152:155], 0
 v_exp_f32 v234, v234
 v_exp_f32 v235, v235
 v_exp_f32 v236, v236
 v_exp_f32 v237, v237
 v_exp_f32 v238, v238
 v_exp_f32 v239, v239
 v_smfmac_f32_32x32x32_bf16 v[80:95], v[188:191], v[224:231], v240
 v_exp_f32 v208, v208
 v_exp_f32 v209, v209
 v_exp_f32_e64 v210, v210
 v_smfmac_f32_32x32x32_bf16 v[80:95], v[192:195], v[232:239], v240
 v_exp_f32 v211, v211
 v_exp_f32 v212, v212
 v_exp_f32 v213, v213
 v_exp_f32 v214, v214
 v_exp_f32 v215, v215
 v_exp_f32 v216, v216
 v_exp_f32_e64 v217, v217
 v_mfma_f32_32x32x16_bf16 v[224:239], v[184:187], v[156:159], 0
 s_waitcnt vmcnt(0)
 ds_read_b32 v252, v253 offset:16
 v_exp_f32 v218, v218
 v_exp_f32 v219, v219
 v_exp_f32 v220, v220
 v_exp_f32 v221, v221
 v_exp_f32 v222, v222
 v_exp_f32_e64 v223, v223
 v_smfmac_f32_32x32x32_bf16 v[96:111], v[188:191], v[208:215], v240
 v_exp_f32 v224, v224
 v_exp_f32 v225, v225
 v_exp_f32_e64 v226, v226
 v_smfmac_f32_32x32x32_bf16 v[96:111], v[192:195], v[216:223], v240
 v_exp_f32 v227, v227
 v_exp_f32 v228, v228
 v_exp_f32 v229, v229
 v_exp_f32 v230, v230
 v_exp_f32 v231, v231
 v_exp_f32 v232, v232
 v_exp_f32_e64 v233, v233
 v_mfma_f32_32x32x16_bf16 v[208:223], v[196:199], v[128:131], 0
 v_exp_f32 v234, v234
 v_exp_f32 v235, v235
 v_exp_f32 v236, v236
 v_exp_f32 v237, v237
 v_exp_f32 v238, v238
 v_exp_f32 v239, v239
LLAST:
 s_waitcnt lgkmcnt(0)
 v_cmp_gt_u32 vcc, 4, v252
 s_cbranch_vccz Lgd_24
 s_mov_b32 s70, 0
Llp_25:
 ds_read_b32 v252, v253 offset:16
 s_add_u32 s70, s70, 1
 s_waitcnt lgkmcnt(0)
 v_cmp_gt_u32 vcc, 4, v252
 s_cmp_gt_u32 s70, 1600000
 s_cbranch_scc1 Llpd_26
 s_cbranch_vccz Llpd_26
 s_sleep 1
 s_branch Llp_25
Llpd_26:
Lgd_24:
 v_smfmac_f32_32x32x32_bf16 v[112:127], v[188:191], v[224:231], v240
 v_exp_f32 v208, v208
 v_exp_f32 v209, v209
 v_exp_f32 v210, v210
 v_smfmac_f32_32x32x32_bf16 v[112:127], v[192:195], v[232:239], v240
 v_exp_f32 v211, v211
 v_exp_f32 v212, v212
 v_exp_f32 v213, v213
 v_exp_f32 v214, v214
 v_exp_f32 v215, v215
 v_exp_f32 v216, v216
 v_exp_f32_e64 v217, v217
 v_mfma_f32_32x32x16_bf16 v[224:239], v[196:199], v[132:135], 0
 v_exp_f32 v218, v218
 v_exp_f32 v219, v219
 v_exp_f32 v220, v220
 v_exp_f32 v221, v221
 v_exp_f32 v222, v222
 v_exp_f32 v223, v223
 v_smfmac_f32_32x32x32_bf16 v[0:15], v[200:203], v[208:215], v240
 v_exp_f32 v224, v224
 v_exp_f32 v225, v225
 v_exp_f32_e64 v226, v226
 v_smfmac_f32_32x32x32_bf16 v[0:15], v[204:207], v[216:223], v240
 v_exp_f32 v227, v227
 v_exp_f32 v228, v228
 v_exp_f32 v229, v229
 v_exp_f32 v230, v230
 v_exp_f32 v231, v231
 v_exp_f32 v232, v232
 v_exp_f32_e64 v233, v233
 v_mfma_f32_32x32x16_bf16 v[208:223], v[196:199], v[136:139], 0
 v_exp_f32 v234, v234
 v_exp_f32 v235, v235
 v_exp_f32 v236, v236
 v_exp_f32 v237, v237
 v_exp_f32 v238, v238
 v_exp_f32 v239, v239
 ds_write_b128 v244, v[0:3] offset:0
 ds_write_b128 v244, v[4:7] offset:1024
 ds_write_b32 v245, v8 offset:2048
 v_smfmac_f32_32x32x32_bf16 v[16:31], v[200:203], v[224:231], v240
 v_exp_f32 v208, v208
 v_exp_f32 v209, v209
 v_exp_f32_e64 v210, v210
 v_smfmac_f32_32x32x32_bf16 v[16:31], v[204:207], v[232:239], v240
 v_exp_f32 v211, v211
 v_exp_f32 v212, v212
 v_exp_f32 v213, v213
 v_exp_f32 v214, v214
 v_exp_f32 v215, v215
 v_exp_f32 v216, v216
 v_exp_f32_e64 v217, v217
 v_mfma_f32_32x32x16_bf16 v[224:239], v[196:199], v[140:143], 0
 v_exp_f32 v218, v218
 v_exp_f32 v219, v219
 v_exp_f32 v220, v220
 v_exp_f32 v221, v221
 v_exp_f32 v222, v222
 v_exp_f32 v223, v223
 ds_write_b128 v244, v[16:19] offset:2304
 ds_write_b128 v244, v[20:23] offset:3328
 ds_write_b32 v245, v24 offset:4352
 v_smfmac_f32_32x32x32_bf16 v[32:47], v[200:203], v[208:215], v240
 v_exp_f32 v224, v224
 v_exp_f32 v225, v225
 v_exp_f32_e64 v226, v226
 v_smfmac_f32_32x32x32_bf16 v[32:47], v[204:207], v[216:223], v240
 v_exp_f32 v227, v227
 v_exp_f32 v228, v228
 v_exp_f32 v229, v229
 v_exp_f32 v230, v230
 v_exp_f32 v231, v231
 v_exp_f32 v232, v232
 v_exp_f32_e64 v233, v233
 v_mfma_f32_32x32x16_bf16 v[208:223], v[196:199], v[144:147], 0
 v_exp_f32 v234, v234
 v_exp_f32 v235, v235
 v_exp_f32 v236, v236
 v_exp_f32 v237, v237
 v_exp_f32 v238, v238
 v_exp_f32 v239, v239
 ds_write_b128 v246, v[32:35] offset:0
 ds_write_b128 v246, v[36:39] offset:1024
 ds_write_b32 v247, v40 offset:2048
 v_smfmac_f32_32x32x32_bf16 v[48:63], v[200:203], v[224:231], v240
 v_exp_f32 v208, v208
 v_exp_f32 v209, v209
 v_exp_f32_e64 v210, v210
 v_smfmac_f32_32x32x32_bf16 v[48:63], v[204:207], v[232:239], v240
 v_exp_f32 v211, v211
 v_exp_f32 v212, v212
 v_exp_f32 v213, v213
 v_exp_f32 v214, v214
 v_exp_f32 v215, v215
 v_exp_f32 v216, v216
 v_exp_f32_e64 v217, v217
 v_mfma_f32_32x32x16_bf16 v[224:239], v[196:199], v[148:151], 0
 v_exp_f32 v218, v218
 v_exp_f32 v219, v219
 v_exp_f32 v220, v220
 v_exp_f32 v221, v221
 v_exp_f32 v222, v222
 v_exp_f32 v223, v223
 ds_write_b128 v246, v[48:51] offset:2304
 ds_write_b128 v246, v[52:55] offset:3328
 ds_write_b32 v247, v56 offset:4352
 v_smfmac_f32_32x32x32_bf16 v[64:79], v[200:203], v[208:215], v240
 v_exp_f32 v224, v224
 v_exp_f32 v225, v225
 v_exp_f32_e64 v226, v226
 v_smfmac_f32_32x32x32_bf16 v[64:79], v[204:207], v[216:223], v240
 v_exp_f32 v227, v227
 v_exp_f32 v228, v228
 v_exp_f32 v229, v229
 v_exp_f32 v230, v230
 v_exp_f32 v231, v231
 v_exp_f32 v232, v232
 v_exp_f32_e64 v233, v233
 v_mfma_f32_32x32x16_bf16 v[208:223], v[196:199], v[152:155], 0
 v_exp_f32 v234, v234
 v_exp_f32 v235, v235
 v_exp_f32 v236, v236
 v_exp_f32 v237, v237
 v_exp_f32 v238, v238
 v_exp_f32 v239, v239
 ds_write_b128 v248, v[64:67] offset:0
 ds_write_b128 v248, v[68:71] offset:1024
 ds_write_b32 v249, v72 offset:2048
 v_smfmac_f32_32x32x32_bf16 v[80:95], v[200:203], v[224:231], v240
 v_exp_f32 v208, v208
 v_exp_f32 v209, v209
 v_exp_f32_e64 v210, v210
 v_smfmac_f32_32x32x32_bf16 v[80:95], v[204:207], v[232:239], v240
 v_exp_f32 v211, v211
 v_exp_f32 v212, v212
 v_exp_f32 v213, v213
 v_exp_f32 v214, v214
 v_exp_f32 v215, v215
 v_exp_f32 v216, v216
 v_exp_f32_e64 v217, v217
 v_mfma_f32_32x32x16_bf16 v[224:239], v[196:199], v[156:159], 0
 v_exp_f32 v218, v218
 v_exp_f32 v219, v219
 v_exp_f32 v220, v220
 v_exp_f32 v221, v221
 v_exp_f32 v222, v222
 v_exp_f32 v223, v223
 ds_write_b128 v248, v[80:83] offset:2304
 ds_write_b128 v248, v[84:87] offset:3328
 ds_write_b32 v249, v88 offset:4352
 v_smfmac_f32_32x32x32_bf16 v[96:111], v[200:203], v[208:215], v240
 v_exp_f32 v224, v224
 v_exp_f32 v225, v225
 v_exp_f32_e64 v226, v226
 v_smfmac_f32_32x32x32_bf16 v[96:111], v[204:207], v[216:223], v240
 v_exp_f32 v227, v227
 v_exp_f32 v228, v228
 v_exp_f32 v229, v229
 v_exp_f32 v230, v230
 v_exp_f32 v231, v231
 v_exp_f32 v232, v232
 v_exp_f32 v233, v233
 v_exp_f32 v234, v234
 v_exp_f32 v235, v235
 v_exp_f32 v236, v236
 v_exp_f32 v237, v237
 v_exp_f32 v238, v238
 v_exp_f32_e64 v239, v239
 s_mul_i32 s67, s30, 13824
 s_add_u32 s67, s67, 66560
 v_smfmac_f32_32x32x32_bf16 v[112:127], v[200:203], v[224:231], v240
 v_smfmac_f32_32x32x32_bf16 v[112:127], v[204:207], v[232:239], v240
LCOMB:
 v_add_u32 v244, s67, v241
 v_add_u32 v245, s67, v251
 s_lshl_b32 s67, s31, 5
 s_lshl_b32 s68, s3, 2
 s_add_u32 s67, s67, s68
 s_add_u32 s67, s67, s30
 s_lshl_b32 s67, s67, 11
 s_add_u32 s67, s67, 1048576
 s_waitcnt lgkmcnt(0)
 s_barrier
 s_nop 0
 ds_read_b128 v[0:3], v244 offset:0
 ds_read_b128 v[4:7], v244 offset:1024
 ds_read_b32 v8, v245 offset:2048
 ds_read_b128 v[10:13], v244 offset:4608
 ds_read_b128 v[14:17], v244 offset:5632
 ds_read_b32 v18, v245 offset:6656
 ds_read_b128 v[20:23], v244 offset:9216
 ds_read_b128 v[24:27], v244 offset:10240
 ds_read_b32 v28, v245 offset:11264
 ds_read_b128 v[32:35], v244 offset:2304
 ds_read_b128 v[36:39], v244 offset:3328
 ds_read_b32 v40, v245 offset:4352
 ds_read_b128 v[42:45], v244 offset:6912
 ds_read_b128 v[46:49], v244 offset:7936
 ds_read_b32 v50, v245 offset:8960
 ds_read_b128 v[52:55], v244 offset:11520
 ds_read_b128 v[56:59], v244 offset:12544
 ds_read_b32 v60, v245 offset:13568
 s_waitcnt lgkmcnt(15)
 v_add_f32 v104, v104, v8
 v_pk_add_f32 v[96:97], v[96:97], v[0:1]
 v_pk_add_f32 v[98:99], v[98:99], v[2:3]
 v_pk_add_f32 v[100:101], v[100:101], v[4:5]
 v_pk_add_f32 v[102:103], v[102:103], v[6:7]
 s_waitcnt lgkmcnt(12)
 v_add_f32 v104, v104, v18
 v_pk_add_f32 v[96:97], v[96:97], v[10:11]
 v_pk_add_f32 v[98:99], v[98:99], v[12:13]
 v_pk_add_f32 v[100:101], v[100:101], v[14:15]
 v_pk_add_f32 v[102:103], v[102:103], v[16:17]
 s_waitcnt lgkmcnt(9)
 v_add_f32 v104, v104, v28
 v_rcp_f32_e64 v104, v104
 v_pk_add_f32 v[96:97], v[96:97], v[20:21]
 v_pk_add_f32 v[98:99], v[98:99], v[22:23]
 v_pk_add_f32 v[100:101], v[100:101], v[24:25]
 v_pk_add_f32 v[102:103], v[102:103], v[26:27]
 v_pk_mul_f32 v[96:97], v[96:97], v[104:105] op_sel_hi:[1,0]
 v_pk_mul_f32 v[98:99], v[98:99], v[104:105] op_sel_hi:[1,0]
 v_pk_mul_f32 v[100:101], v[100:101], v[104:105] op_sel_hi:[1,0]
 v_pk_mul_f32 v[102:103], v[102:103], v[104:105] op_sel_hi:[1,0]
 v_cvt_pk_bf16_f32 v108, v96, v97
 v_cvt_pk_bf16_f32 v109, v98, v99
 v_cvt_pk_bf16_f32 v110, v100, v101
 v_cvt_pk_bf16_f32 v111, v102, v103
 v_min_u32 v108, -2, v108
 v_min_u32 v109, -2, v109
 v_min_u32 v110, -2, v110
 v_min_u32 v111, -2, v111
 buffer_store_dwordx4 v[108:111], v241, s[40:43], s67 offen offset:0 sc1
 s_waitcnt lgkmcnt(6)
 v_add_f32 v120, v120, v40
 v_pk_add_f32 v[112:113], v[112:113], v[32:33]
 v_pk_add_f32 v[114:115], v[114:115], v[34:35]
 v_pk_add_f32 v[116:117], v[116:117], v[36:37]
 v_pk_add_f32 v[118:119], v[118:119], v[38:39]
 s_waitcnt lgkmcnt(3)
 v_add_f32 v120, v120, v50
 v_pk_add_f32 v[112:113], v[112:113], v[42:43]
 v_pk_add_f32 v[114:115], v[114:115], v[44:45]
 v_pk_add_f32 v[116:117], v[116:117], v[46:47]
 v_pk_add_f32 v[118:119], v[118:119], v[48:49]
 s_waitcnt lgkmcnt(0)
 v_add_f32 v120, v120, v60
 v_rcp_f32_e64 v120, v120
 v_pk_add_f32 v[112:113], v[112:113], v[52:53]
 v_pk_add_f32 v[114:115], v[114:115], v[54:55]
 v_pk_add_f32 v[116:117], v[116:117], v[56:57]
 v_pk_add_f32 v[118:119], v[118:119], v[58:59]
 v_pk_mul_f32 v[112:113], v[112:113], v[120:121] op_sel_hi:[1,0]
 v_pk_mul_f32 v[114:115], v[114:115], v[120:121] op_sel_hi:[1,0]
 v_pk_mul_f32 v[116:117], v[116:117], v[120:121] op_sel_hi:[1,0]
 v_pk_mul_f32 v[118:119], v[118:119], v[120:121] op_sel_hi:[1,0]
 v_cvt_pk_bf16_f32 v124, v112, v113
 v_cvt_pk_bf16_f32 v125, v114, v115
 v_cvt_pk_bf16_f32 v126, v116, v117
 v_cvt_pk_bf16_f32 v127, v118, v119
 v_min_u32 v124, -2, v124
 v_min_u32 v125, -2, v125
 v_min_u32 v126, -2, v126
 v_min_u32 v127, -2, v127
 buffer_store_dwordx4 v[124:127], v241, s[40:43], s67 offen offset:1024 sc1
 s_barrier
 s_endpgm
.p2align 6
LG:
 s_and_b32 s70, s31, 7
 s_mul_i32 s72, s3, 224
 s_lshl_b32 s67, s62, 5
 s_mul_i32 s68, s62, 192
 s_add_u32 s73, s72, 192
 s_sub_u32 s73, s73, s68
 s_add_u32 s72, s72, s67
 s_cmp_eq_u32 s60, 0
 s_cselect_b32 s36, s6, s16
 s_cselect_b32 s37, s7, s17
 s_mov_b32 s76, 3584
 s_cselect_b32 s76, 1024, s76
 s_lshl_b32 s38, s76, 9
 s_mov_b32 s39, 0x20000
 s_lshl_b32 s66, s76, 3
 s_lshl_b32 s67, s3, 7
 s_lshl_b32 s79, s60, 6
 s_add_u32 s79, s79, s72
 s_sub_u32 s79, s79, 64
 s_lshl_b32 s65, s79, 1
 s_cmp_eq_u32 s60, 0
 s_cselect_b32 s65, s67, s65
 s_mov_b32 s56, s18
 s_mov_b32 s57, s19
 s_mov_b32 s58, 3584
 s_mov_b32 s59, 0x20000
 s_cmp_eq_u32 s60, 0
 s_cselect_b32 s79, s73, s79
 s_lshl_b32 s79, s79, 1
 v_lshrrev_b32 v2, 5, v255
 v_lshlrev_b32_e64 v2, 20, v2
 v_lshl_add_u32 v2, v255, 1, v2
 v_mov_b32_e64 v39, v2
 s_mov_b32 s44, s26
 s_mov_b32 s45, s27
 s_mov_b32 s46, 256
 s_mov_b32 s47, 0x20000
 s_lshl_b32 s67, s2, 3
 s_add_u32 s67, s67, s30
 s_cmp_eq_u32 s67, 7
 s_cbranch_scc0 Lnottag_27
 s_memrealtime s[0:1]
 v_mov_b32 v38, 0
 s_waitcnt lgkmcnt(0)
 s_or_b32 s0, s0, 1
 v_mov_b32 v36, s0
 v_mov_b32 v37, s1
 s_mov_b64 exec, 1
 buffer_store_dwordx2 v[36:37], v38, s[44:47], 0 offen sc1
 s_mov_b64 exec, -1
Lnottag_27:
 v_lshl_add_u32 v45, v255, 3, s70
 v_mul_lo_u32 v3, v45, s76
 s_cmp_eq_u32 s62, 0
 s_cselect_b32 s48, s8, s10
 s_cselect_b32 s49, s9, s11
 s_mov_b32 s50, 16384
 s_mov_b32 s51, 0x20000
 s_mul_i32 s64, s60, 18432
 s_add_u32 s64, s64, 66560
 s_mov_b32 s52, s16
 s_mov_b32 s53, s17
 s_mov_b32 s54, 1835008
 s_mov_b32 s55, 0x20000
 s_mov_b32 s40, s28
 s_mov_b32 s41, s29
 s_mov_b32 s42, 33554432
 s_mov_b32 s43, 0x20000
 v_lshrrev_b32_e64 v2, 3, v255
 v_mul_lo_u32 v41, v2, s76
 v_bfe_u32 v2, v255, 4, 1
 v_lshlrev_b32 v2, 2, v2
 v_and_b32 v38, 7, v255
 v_xor_b32_e64 v38, v38, v2
 v_lshl_add_u32 v41, v38, 4, v41
 v_mov_b32 v47, 0
 v_lshlrev_b32 v2, 2, v255
 v_add_u32 v2, 140288, v2
 ds_write_b32 v2, v47
 v_and_b32 v2, 15, v255
 v_lshrrev_b32 v2, 2, v2
 v_lshrrev_b32_e64 v38, 5, v255
 v_lshl_add_u32 v42, v38, 3, v2
 v_lshlrev_b32 v42, 7, v42
 v_and_b32 v38, 3, v255
 v_lshl_add_u32 v42, v38, 3, v42
 v_bfe_u32 v38, v255, 4, 1
 v_lshl_add_u32 v42, v38, 5, v42
 v_bfe_u32 v38, v255, 3, 1
 v_lshlrev_b32 v38, 6, v38
 v_xor_b32 v42, v42, v38
 v_add_u32 v42, s64, v42
 v_xor_b32 v43, 64, v42
 v_and_b32_e64 v2, 31, v255
 v_mul_u32_u24 v234, 1040, v2
 v_lshrrev_b32_e64 v2, 5, v255
 v_lshl_add_u32 v234, v2, 4, v234
 v_lshlrev_b32_e64 v236, 4, v255
 v_add_u32 v228, 66560, v236
 v_add_u32 v233, 140544, v236
 v_and_b32 v2, 15, v255
 v_lshrrev_b32 v2, 2, v2
 v_lshrrev_b32_e64 v38, 5, v255
 v_lshl_add_u32 v237, v38, 2, v2
 v_lshlrev_b32 v237, 7, v237
 v_and_b32 v38, 3, v255
 v_lshl_add_u32 v237, v38, 3, v237
 v_bfe_u32 v38, v255, 4, 1
 v_lshl_add_u32 v237, v38, 5, v237
 v_bfe_u32 v38, v255, 3, 1
 v_lshlrev_b32 v38, 6, v38
 v_xor_b32 v237, v237, v38
 v_add_u32_e64 v230, s64, v237
 v_xor_b32 v231, 64, v230
 s_lshl_b32 s75, s60, 11
 s_add_u32 s75, s75, 152832
 v_add_u32 v229, s75, v237
 v_xor_b32 v199, 64, v229
 s_mov_b32 s68, 1024
 v_lshrrev_b32_e64 v2, 3, v255
 v_mul_lo_u32 v232, v2, s68
 v_bfe_u32 v2, v255, 4, 1
 v_lshlrev_b32 v2, 2, v2
 v_and_b32 v38, 7, v255
 v_xor_b32_e64 v38, v38, v2
 v_lshl_add_u32 v232, v38, 4, v232
 v_and_b32 v2, 15, v255
 v_lshrrev_b32 v2, 2, v2
 v_lshrrev_b32_e64 v38, 5, v255
 v_lshl_add_u32 v235, v38, 3, v2
 v_lshlrev_b32 v235, 6, v235
 v_and_b32 v38, 3, v255
 v_lshl_add_u32 v235, v38, 3, v235
 v_bfe_u32 v38, v255, 4, 1
 v_lshl_add_u32 v235, v38, 5, v235
 v_add_u32 v235, 144640, v235
 v_lshrrev_b32_e64 v2, 2, v255
 v_mul_u32_u24 v198, 3584, v2
 v_and_b32_e64 v2, 3, v255
 v_lshl_add_u32 v198, v2, 4, v198
 v_mov_b32 v51, 0
 v_mov_b32 v52, 0
 v_mov_b32 v53, 0
 v_mov_b32 v55, 0
 v_mov_b32 v56, 0
 v_mov_b32 v57, 0
 v_mov_b32 v59, 0
 v_mov_b32 v60, 0
 v_mov_b32_e64 v61, 0
 v_mov_b32 v58, 0x3f80
 v_mov_b32 v202, 140288
 v_mov_b32_e64 v203, 1
 v_bfe_u32 v12, v255, 3, 1
 v_bfe_u32 v13, v255, 4, 1
 v_xor_b32 v12, v12, v13
 v_mul_u32_u24 v12, 24, v12
 v_xor_b32 v12, v12, v255
 v_lshlrev_b32 v12, 4, v12
 s_lshl_b32 s67, s60, 7
 v_add_u32 v46, s67, v45
 v_mul_u32_u24 v46, 3584, v46
 buffer_load_dwordx4 v[84:87], v40, s[32:35], s69 offen offset:640
 buffer_load_dwordx4 v[88:91], v40, s[32:35], s69 offen offset:768
 buffer_load_dwordx4 v[92:95], v40, s[32:35], s69 offen offset:896
 s_add_u32 m0, s64, 0
 s_nop 0
 buffer_load_dwordx4 v41, s[36:39], s65 offen lds
 s_add_u32 s65, s65, s66
 s_add_u32 m0, s64, 1024
 s_nop 0
 buffer_load_dwordx4 v41, s[36:39], s65 offen lds
 s_add_u32 s65, s65, s66
 s_add_u32 m0, s64, 2048
 s_nop 0
 buffer_load_dwordx4 v41, s[36:39], s65 offen lds
 s_add_u32 s65, s65, s66
 s_add_u32 m0, s64, 3072
 s_nop 0
 buffer_load_dwordx4 v41, s[36:39], s65 offen lds
 s_add_u32 s65, s65, s66
 s_add_u32 m0, s64, 4096
 s_nop 0
 buffer_load_dwordx4 v41, s[36:39], s65 offen lds
 s_add_u32 s65, s65, s66
 s_add_u32 m0, s64, 5120
 s_nop 0
 buffer_load_dwordx4 v41, s[36:39], s65 offen lds
 s_add_u32 s65, s65, s66
 s_lshl_b32 s67, s60, 12
 s_add_u32 s68, s67, 140544
 s_add_u32 m0, s68, 0
 s_add_u32 s70, s67, 0
 buffer_load_dwordx4 v12, s[48:51], s70 offen lds
 s_add_u32 m0, s68, 1024
 s_add_u32 s70, s67, 1024
 buffer_load_dwordx4 v12, s[48:51], s70 offen lds
 s_add_u32 m0, s68, 2048
 s_add_u32 s70, s67, 2048
 buffer_load_dwordx4 v12, s[48:51], s70 offen lds
 s_add_u32 m0, s68, 3072
 s_add_u32 s70, s67, 3072
 buffer_load_dwordx4 v12, s[48:51], s70 offen lds
 s_add_u32 m0, s64, 6144
 s_nop 0
 buffer_load_dwordx4 v41, s[36:39], s65 offen lds
 s_add_u32 s65, s65, s66
 s_add_u32 m0, s64, 7168
 s_nop 0
 buffer_load_dwordx4 v41, s[36:39], s65 offen lds
 s_add_u32 s65, s65, s66
 s_add_u32 m0, s64, 8192
 s_nop 0
 buffer_load_dwordx4 v41, s[36:39], s65 offen lds
 s_add_u32 s65, s65, s66
 s_add_u32 m0, s64, 9216
 s_nop 0
 buffer_load_dwordx4 v41, s[36:39], s65 offen lds
 s_add_u32 s65, s65, s66
 s_add_u32 m0, s64, 10240
 s_nop 0
 buffer_load_dwordx4 v41, s[36:39], s65 offen lds
 s_add_u32 s65, s65, s66
 s_add_u32 m0, s64, 11264
 s_nop 0
 buffer_load_dwordx4 v41, s[36:39], s65 offen lds
 s_add_u32 s65, s65, s66
 s_add_u32 m0, s64, 12288
 s_nop 0
 buffer_load_dwordx4 v41, s[36:39], s65 offen lds
 s_add_u32 s65, s65, s66
 s_add_u32 m0, s64, 13312
 s_nop 0
 buffer_load_dwordx4 v41, s[36:39], s65 offen lds
 s_add_u32 s65, s65, s66
 s_add_u32 m0, s64, 14336
 s_nop 0
 buffer_load_dwordx4 v41, s[36:39], s65 offen lds
 s_add_u32 s65, s65, s66
 s_add_u32 m0, s64, 15360
 s_nop 0
 buffer_load_dwordx4 v41, s[36:39], s65 offen lds
 s_add_u32 s65, s65, s66
 s_add_u32 m0, s64, 16384
 s_nop 0
 buffer_load_dwordx4 v41, s[36:39], s65 offen lds
 s_add_u32 s65, s65, s66
 s_add_u32 m0, s64, 17408
 s_nop 0
 buffer_load_dwordx4 v41, s[36:39], s65 offen lds
 s_add_u32 s65, s65, s66
 buffer_load_ushort v50, v39, s[56:59], s79 offen
 buffer_load_ushort v54, v39, s[56:59], s79 offen offset:64
 s_mov_b32 exec_hi, 0x3fff
 buffer_load_dword v254, v3, s[36:39], s65 offen
 s_mov_b64 exec, 0xffff
 s_lshl_b32 s68, s73, 1
 buffer_load_dword v254, v46, s[52:55], s68 offen
 s_mov_b64 exec, -1
 s_waitcnt vmcnt(26)
 s_branch LLN
LG2:
 s_setprio 1
 s_waitcnt vmcnt(16) lgkmcnt(0)
 s_barrier
 s_nop 0
 ds_read_b128 v[64:67], v234 offset:0
 ds_read_b64_tr_b16 v[72:73], v42 offset:0
 ds_read_b64_tr_b16 v[74:75], v42 offset:512
 ds_read_b128 v[68:71], v234 offset:33280
 ds_read_b64_tr_b16 v[76:77], v43 offset:0
 ds_read_b64_tr_b16 v[78:79], v43 offset:512
 ds_read_b128 v[80:83], v234 offset:32
 ds_read_b64_tr_b16 v[88:89], v42 offset:2048
 ds_read_b64_tr_b16 v[90:91], v42 offset:2560
 ds_read_b128 v[84:87], v234 offset:33312
 ds_read_b64_tr_b16 v[92:93], v43 offset:2048
 ds_read_b64_tr_b16 v[94:95], v43 offset:2560
 s_sub_u32 s67, s66, 1024
 v_add_u32_e64 v44, s67, v41
 s_lshl_b32 s66, s66, 1
 s_waitcnt lgkmcnt(6)
 v_mfma_f32_32x32x16_bf16 v[128:143], v[72:75], v[64:67], 0
 ds_read_b128 v[96:99], v234 offset:64
 ds_read_b64_tr_b16 v[104:105], v42 offset:4096
 ds_read_b64_tr_b16 v[106:107], v42 offset:4608
 v_mfma_f32_32x32x16_bf16 v[160:175], v[76:79], v[64:67], 0
 ds_read_b128 v[100:103], v234 offset:33344
 ds_read_b64_tr_b16 v[108:109], v43 offset:4096
 ds_read_b64_tr_b16 v[110:111], v43 offset:4608
 s_add_u32 m0, s64, 0
 s_nop 0
 v_mfma_f32_32x32x16_bf16 v[176:191], v[76:79], v[68:71], 0
 buffer_load_dwordx4 v41, s[36:39], s65 offen lds
 v_mfma_f32_32x32x16_bf16 v[144:159], v[72:75], v[68:71], 0
 buffer_load_dwordx4 v44, s[36:39], s65 offen offset:1024 lds
 s_add_u32 s65, s65, s66
 s_waitcnt vmcnt(16) lgkmcnt(6)
 v_mfma_f32_32x32x16_bf16 v[128:143], v[88:91], v[80:83], v[128:143]
 ds_read_b128 v[64:67], v234 offset:96
 ds_read_b64_tr_b16 v[72:73], v42 offset:6144
 ds_read_b64_tr_b16 v[74:75], v42 offset:6656
 v_mfma_f32_32x32x16_bf16 v[160:175], v[92:95], v[80:83], v[160:175]
 ds_read_b128 v[68:71], v234 offset:33376
 ds_read_b64_tr_b16 v[76:77], v43 offset:6144
 ds_read_b64_tr_b16 v[78:79], v43 offset:6656
 s_add_u32 m0, s64, 2048
 v_mfma_f32_32x32x16_bf16 v[176:191], v[92:95], v[84:87], v[176:191]
 buffer_load_dwordx4 v41, s[36:39], s65 offen lds
 v_mfma_f32_32x32x16_bf16 v[144:159], v[88:91], v[84:87], v[144:159]
 buffer_load_dwordx4 v44, s[36:39], s65 offen offset:1024 lds
 s_add_u32 s65, s65, s66
 s_waitcnt vmcnt(16) lgkmcnt(6)
 v_mfma_f32_32x32x16_bf16 v[128:143], v[104:107], v[96:99], v[128:143]
 ds_read_b128 v[80:83], v234 offset:128
 ds_read_b64_tr_b16 v[88:89], v42 offset:8192
 ds_read_b64_tr_b16 v[90:91], v42 offset:8704
 v_mfma_f32_32x32x16_bf16 v[160:175], v[108:111], v[96:99], v[160:175]
 ds_read_b128 v[84:87], v234 offset:33408
 ds_read_b64_tr_b16 v[92:93], v43 offset:8192
 ds_read_b64_tr_b16 v[94:95], v43 offset:8704
 s_add_u32 m0, s64, 4096
 v_mfma_f32_32x32x16_bf16 v[176:191], v[108:111], v[100:103], v[176:191]
 buffer_load_dwordx4 v41, s[36:39], s65 offen lds
 v_mfma_f32_32x32x16_bf16 v[144:159], v[104:107], v[100:103], v[144:159]
 buffer_load_dwordx4 v44, s[36:39], s65 offen offset:1024 lds
 s_add_u32 s65, s65, s66
 s_waitcnt vmcnt(16) lgkmcnt(6)
 v_mfma_f32_32x32x16_bf16 v[128:143], v[72:75], v[64:67], v[128:143]
 ds_read_b128 v[96:99], v234 offset:160
 ds_read_b64_tr_b16 v[104:105], v42 offset:10240
 ds_read_b64_tr_b16 v[106:107], v42 offset:10752
 v_mfma_f32_32x32x16_bf16 v[160:175], v[76:79], v[64:67], v[160:175]
 ds_read_b128 v[100:103], v234 offset:33440
 ds_read_b64_tr_b16 v[108:109], v43 offset:10240
 ds_read_b64_tr_b16 v[110:111], v43 offset:10752
 s_add_u32 m0, s64, 6144
 v_mfma_f32_32x32x16_bf16 v[176:191], v[76:79], v[68:71], v[176:191]
 buffer_load_dwordx4 v41, s[36:39], s65 offen lds
 v_mfma_f32_32x32x16_bf16 v[144:159], v[72:75], v[68:71], v[144:159]
 buffer_load_dwordx4 v44, s[36:39], s65 offen offset:1024 lds
 s_add_u32 s65, s65, s66
 s_waitcnt vmcnt(16) lgkmcnt(6)
 v_mfma_f32_32x32x16_bf16 v[128:143], v[88:91], v[80:83], v[128:143]
 ds_read_b128 v[64:67], v234 offset:192
 ds_read_b64_tr_b16 v[72:73], v42 offset:12288
 ds_read_b64_tr_b16 v[74:75], v42 offset:12800
 v_mfma_f32_32x32x16_bf16 v[160:175], v[92:95], v[80:83], v[160:175]
 ds_read_b128 v[68:71], v234 offset:33472
 ds_read_b64_tr_b16 v[76:77], v43 offset:12288
 ds_read_b64_tr_b16 v[78:79], v43 offset:12800
 s_add_u32 m0, s64, 8192
 v_mfma_f32_32x32x16_bf16 v[176:191], v[92:95], v[84:87], v[176:191]
 buffer_load_dwordx4 v41, s[36:39], s65 offen lds
 v_mfma_f32_32x32x16_bf16 v[144:159], v[88:91], v[84:87], v[144:159]
 buffer_load_dwordx4 v44, s[36:39], s65 offen offset:1024 lds
 s_add_u32 s65, s65, s66
 s_waitcnt vmcnt(16) lgkmcnt(6)
 v_mfma_f32_32x32x16_bf16 v[128:143], v[104:107], v[96:99], v[128:143]
 ds_read_b128 v[80:83], v234 offset:224
 ds_read_b64_tr_b16 v[88:89], v42 offset:14336
 ds_read_b64_tr_b16 v[90:91], v42 offset:14848
 v_mfma_f32_32x32x16_bf16 v[160:175], v[108:111], v[96:99], v[160:175]
 ds_read_b128 v[84:87], v234 offset:33504
 ds_read_b64_tr_b16 v[92:93], v43 offset:14336
 ds_read_b64_tr_b16 v[94:95], v43 offset:14848
 s_add_u32 m0, s64, 10240
 v_mfma_f32_32x32x16_bf16 v[176:191], v[108:111], v[100:103], v[176:191]
 buffer_load_dwordx4 v41, s[36:39], s65 offen lds
 v_mfma_f32_32x32x16_bf16 v[144:159], v[104:107], v[100:103], v[144:159]
 buffer_load_dwordx4 v44, s[36:39], s65 offen offset:1024 lds
 s_add_u32 s65, s65, s66
 s_waitcnt vmcnt(16) lgkmcnt(6)
 v_mfma_f32_32x32x16_bf16 v[128:143], v[72:75], v[64:67], v[128:143]
 ds_read_b128 v[96:99], v234 offset:256
 ds_read_b64_tr_b16 v[104:105], v42 offset:16384
 ds_read_b64_tr_b16 v[106:107], v42 offset:16896
 v_mfma_f32_32x32x16_bf16 v[160:175], v[76:79], v[64:67], v[160:175]
 ds_read_b128 v[100:103], v234 offset:33536
 ds_read_b64_tr_b16 v[108:109], v43 offset:16384
 ds_read_b64_tr_b16 v[110:111], v43 offset:16896
 s_add_u32 m0, s64, 12288
 v_mfma_f32_32x32x16_bf16 v[176:191], v[76:79], v[68:71], v[176:191]
 buffer_load_dwordx4 v41, s[36:39], s65 offen lds
 v_mfma_f32_32x32x16_bf16 v[144:159], v[72:75], v[68:71], v[144:159]
 buffer_load_dwordx4 v44, s[36:39], s65 offen offset:1024 lds
 s_add_u32 s65, s65, s66
 s_waitcnt vmcnt(12) lgkmcnt(6)
 v_mfma_f32_32x32x16_bf16 v[128:143], v[88:91], v[80:83], v[128:143]
 ds_read_b128 v[64:67], v234 offset:288
 ds_read_b64_tr_b16 v[72:73], v42 offset:0
 ds_read_b64_tr_b16 v[74:75], v42 offset:512
 v_mfma_f32_32x32x16_bf16 v[160:175], v[92:95], v[80:83], v[160:175]
 ds_read_b128 v[68:71], v234 offset:33568
 ds_read_b64_tr_b16 v[76:77], v43 offset:0
 ds_read_b64_tr_b16 v[78:79], v43 offset:512
 s_add_u32 m0, s64, 14336
 v_mfma_f32_32x32x16_bf16 v[176:191], v[92:95], v[84:87], v[176:191]
 buffer_load_dwordx4 v41, s[36:39], s65 offen lds
 v_mfma_f32_32x32x16_bf16 v[144:159], v[88:91], v[84:87], v[144:159]
 buffer_load_dwordx4 v44, s[36:39], s65 offen offset:1024 lds
 s_add_u32 s65, s65, s66
 s_waitcnt vmcnt(12) lgkmcnt(6)
 v_mfma_f32_32x32x16_bf16 v[128:143], v[104:107], v[96:99], v[128:143]
 ds_read_b128 v[80:83], v234 offset:320
 ds_read_b64_tr_b16 v[88:89], v42 offset:2048
 ds_read_b64_tr_b16 v[90:91], v42 offset:2560
 v_mfma_f32_32x32x16_bf16 v[160:175], v[108:111], v[96:99], v[160:175]
 ds_read_b128 v[84:87], v234 offset:33600
 ds_read_b64_tr_b16 v[92:93], v43 offset:2048
 ds_read_b64_tr_b16 v[94:95], v43 offset:2560
 s_lshr_b32 s61, s60, 1
 v_lshrrev_b32 v14, 5, v255
 v_mov_b32 v246, v39
 v_and_b32 v15, 31, v255
 s_add_u32 m0, s64, 16384
 v_mfma_f32_32x32x16_bf16 v[176:191], v[108:111], v[100:103], v[176:191]
 buffer_load_dwordx4 v41, s[36:39], s65 offen lds
 v_mfma_f32_32x32x16_bf16 v[144:159], v[104:107], v[100:103], v[144:159]
 buffer_load_dwordx4 v44, s[36:39], s65 offen offset:1024 lds
 s_add_u32 s65, s65, s66
 s_waitcnt vmcnt(12) lgkmcnt(6)
 v_mfma_f32_32x32x16_bf16 v[128:143], v[72:75], v[64:67], v[128:143]
 ds_read_b128 v[96:99], v234 offset:352
 ds_read_b64_tr_b16 v[104:105], v42 offset:4096
 ds_read_b64_tr_b16 v[106:107], v42 offset:4608
 v_mfma_f32_32x32x16_bf16 v[160:175], v[76:79], v[64:67], v[160:175]
 ds_read_b128 v[100:103], v234 offset:33632
 ds_read_b64_tr_b16 v[108:109], v43 offset:4096
 ds_read_b64_tr_b16 v[110:111], v43 offset:4608
 v_lshlrev_b32_e64 v15, 10, v15
 v_lshl_add_u32 v247, v14, 3, v15
 v_lshl_add_u32 v241, v14, 4, v15
 v_bfe_u32 v16, v255, 2, 1
 s_add_u32 m0, s64, 0
 s_nop 0
 v_mfma_f32_32x32x16_bf16 v[176:191], v[76:79], v[68:71], v[176:191]
 buffer_load_dwordx4 v41, s[36:39], s65 offen lds
 v_mfma_f32_32x32x16_bf16 v[144:159], v[72:75], v[68:71], v[144:159]
 buffer_load_dwordx4 v44, s[36:39], s65 offen offset:1024 lds
 s_add_u32 s65, s65, s66
 s_waitcnt vmcnt(12) lgkmcnt(6)
 v_mfma_f32_32x32x16_bf16 v[128:143], v[88:91], v[80:83], v[128:143]
 ds_read_b128 v[64:67], v234 offset:384
 ds_read_b64_tr_b16 v[72:73], v42 offset:6144
 ds_read_b64_tr_b16 v[74:75], v42 offset:6656
 v_mfma_f32_32x32x16_bf16 v[160:175], v[92:95], v[80:83], v[160:175]
 ds_read_b128 v[68:71], v234 offset:33664
 ds_read_b64_tr_b16 v[76:77], v43 offset:6144
 ds_read_b64_tr_b16 v[78:79], v43 offset:6656
 v_cmp_eq_u32 vcc, v16, v14
 v_and_b32 v17, 1, v255
 v_lshlrev_b32_e64 v17, 4, v17
 v_mov_b32 v18, 0x3f80
 s_add_u32 m0, s64, 2048
 v_mfma_f32_32x32x16_bf16 v[176:191], v[92:95], v[84:87], v[176:191]
 buffer_load_dwordx4 v41, s[36:39], s65 offen lds
 v_mfma_f32_32x32x16_bf16 v[144:159], v[88:91], v[84:87], v[144:159]
 buffer_load_dwordx4 v44, s[36:39], s65 offen offset:1024 lds
 s_add_u32 s65, s65, s66
 s_waitcnt vmcnt(12) lgkmcnt(6)
 v_mfma_f32_32x32x16_bf16 v[128:143], v[104:107], v[96:99], v[128:143]
 ds_read_b128 v[80:83], v234 offset:416
 ds_read_b64_tr_b16 v[88:89], v42 offset:8192
 ds_read_b64_tr_b16 v[90:91], v42 offset:8704
 v_mfma_f32_32x32x16_bf16 v[160:175], v[108:111], v[96:99], v[160:175]
 ds_read_b128 v[84:87], v234 offset:33696
 ds_read_b64_tr_b16 v[92:93], v43 offset:8192
 ds_read_b64_tr_b16 v[94:95], v43 offset:8704
 v_lshlrev_b32 v18, v17, v18
 v_cndmask_b32 v18, 0, v18, vcc
 v_bfe_u32 v16, v255, 1, 1
 v_bfe_u32 v17, v255, 3, 2
 s_add_u32 m0, s64, 4096
 v_mfma_f32_32x32x16_bf16 v[176:191], v[108:111], v[100:103], v[176:191]
 buffer_load_dwordx4 v41, s[36:39], s65 offen lds
 v_mfma_f32_32x32x16_bf16 v[144:159], v[104:107], v[100:103], v[144:159]
 buffer_load_dwordx4 v44, s[36:39], s65 offen offset:1024 lds
 s_add_u32 s65, s65, s66
 s_waitcnt vmcnt(12) lgkmcnt(6)
 v_mfma_f32_32x32x16_bf16 v[128:143], v[72:75], v[64:67], v[128:143]
 ds_read_b128 v[96:99], v234 offset:448
 ds_read_b64_tr_b16 v[104:105], v42 offset:10240
 ds_read_b64_tr_b16 v[106:107], v42 offset:10752
 v_mfma_f32_32x32x16_bf16 v[160:175], v[76:79], v[64:67], v[160:175]
 ds_read_b128 v[100:103], v234 offset:33728
 ds_read_b64_tr_b16 v[108:109], v43 offset:10240
 ds_read_b64_tr_b16 v[110:111], v43 offset:10752
 v_lshl_add_u32 v16, v17, 1, v16
 v_cmp_eq_u32 vcc, 0, v16
 s_nop 1
 v_cndmask_b32 v220, 0, v18, vcc
 s_nop 0
 s_add_u32 m0, s64, 6144
 v_mfma_f32_32x32x16_bf16 v[176:191], v[76:79], v[68:71], v[176:191]
 buffer_load_dwordx4 v41, s[36:39], s65 offen lds
 v_mfma_f32_32x32x16_bf16 v[144:159], v[72:75], v[68:71], v[144:159]
 buffer_load_dwordx4 v44, s[36:39], s65 offen offset:1024 lds
 s_add_u32 s65, s65, s66
 s_waitcnt vmcnt(12) lgkmcnt(6)
 v_mfma_f32_32x32x16_bf16 v[128:143], v[88:91], v[80:83], v[128:143]
 ds_read_b128 v[64:67], v234 offset:480
 ds_read_b64_tr_b16 v[72:73], v42 offset:12288
 ds_read_b64_tr_b16 v[74:75], v42 offset:12800
 v_mfma_f32_32x32x16_bf16 v[160:175], v[92:95], v[80:83], v[160:175]
 ds_read_b128 v[68:71], v234 offset:33760
 ds_read_b64_tr_b16 v[76:77], v43 offset:12288
 ds_read_b64_tr_b16 v[78:79], v43 offset:12800
 v_cmp_eq_u32 vcc, 1, v16
 s_nop 1
 v_cndmask_b32 v221, 0, v18, vcc
 v_cmp_eq_u32 vcc, 2, v16
 s_add_u32 m0, s64, 8192
 v_mfma_f32_32x32x16_bf16 v[176:191], v[92:95], v[84:87], v[176:191]
 buffer_load_dwordx4 v41, s[36:39], s65 offen lds
 v_mfma_f32_32x32x16_bf16 v[144:159], v[88:91], v[84:87], v[144:159]
 buffer_load_dwordx4 v44, s[36:39], s65 offen offset:1024 lds
 s_add_u32 s65, s65, s66
 s_waitcnt vmcnt(12) lgkmcnt(6)
 v_mfma_f32_32x32x16_bf16 v[128:143], v[104:107], v[96:99], v[128:143]
 ds_read_b128 v[80:83], v234 offset:512
 ds_read_b64_tr_b16 v[88:89], v42 offset:14336
 ds_read_b64_tr_b16 v[90:91], v42 offset:14848
 v_mfma_f32_32x32x16_bf16 v[160:175], v[108:111], v[96:99], v[160:175]
 ds_read_b128 v[84:87], v234 offset:33792
 ds_read_b64_tr_b16 v[92:93], v43 offset:14336
 ds_read_b64_tr_b16 v[94:95], v43 offset:14848
 s_nop 1
 v_cndmask_b32 v222, 0, v18, vcc
 v_cmp_eq_u32 vcc, 3, v16
 s_nop 1
 s_add_u32 m0, s64, 10240
 v_mfma_f32_32x32x16_bf16 v[176:191], v[108:111], v[100:103], v[176:191]
 buffer_load_dwordx4 v41, s[36:39], s65 offen lds
 v_mfma_f32_32x32x16_bf16 v[144:159], v[104:107], v[100:103], v[144:159]
 buffer_load_dwordx4 v44, s[36:39], s65 offen offset:1024 lds
 s_add_u32 s65, s65, s66
 s_waitcnt vmcnt(12) lgkmcnt(6)
 v_mfma_f32_32x32x16_bf16 v[128:143], v[72:75], v[64:67], v[128:143]
 ds_read_b128 v[96:99], v234 offset:544
 ds_read_b64_tr_b16 v[104:105], v42 offset:16384
 ds_read_b64_tr_b16 v[106:107], v42 offset:16896
 v_mfma_f32_32x32x16_bf16 v[160:175], v[76:79], v[64:67], v[160:175]
 ds_read_b128 v[100:103], v234 offset:33824
 ds_read_b64_tr_b16 v[108:109], v43 offset:16384
 ds_read_b64_tr_b16 v[110:111], v43 offset:16896
 v_cndmask_b32 v223, 0, v18, vcc
 v_cmp_eq_u32 vcc, 4, v16
 s_nop 1
 v_cndmask_b32 v224, 0, v18, vcc
 s_add_u32 m0, s64, 12288
 v_mfma_f32_32x32x16_bf16 v[176:191], v[76:79], v[68:71], v[176:191]
 buffer_load_dwordx4 v41, s[36:39], s65 offen lds
 v_mfma_f32_32x32x16_bf16 v[144:159], v[72:75], v[68:71], v[144:159]
 buffer_load_dwordx4 v44, s[36:39], s65 offen offset:1024 lds
 s_add_u32 s65, s65, s66
 s_waitcnt vmcnt(12) lgkmcnt(6)
 v_mfma_f32_32x32x16_bf16 v[128:143], v[88:91], v[80:83], v[128:143]
 ds_read_b128 v[64:67], v234 offset:576
 ds_read_b64_tr_b16 v[72:73], v42 offset:0
 ds_read_b64_tr_b16 v[74:75], v42 offset:512
 v_mfma_f32_32x32x16_bf16 v[160:175], v[92:95], v[80:83], v[160:175]
 ds_read_b128 v[68:71], v234 offset:33856
 ds_read_b64_tr_b16 v[76:77], v43 offset:0
 ds_read_b64_tr_b16 v[78:79], v43 offset:512
 v_cmp_eq_u32 vcc, 5, v16
 s_nop 1
 v_cndmask_b32 v225, 0, v18, vcc
 v_cmp_eq_u32 vcc, 6, v16
 s_add_u32 m0, s64, 14336
 v_mfma_f32_32x32x16_bf16 v[176:191], v[92:95], v[84:87], v[176:191]
 buffer_load_dwordx4 v41, s[36:39], s65 offen lds
 v_mfma_f32_32x32x16_bf16 v[144:159], v[88:91], v[84:87], v[144:159]
 buffer_load_dwordx4 v44, s[36:39], s65 offen offset:1024 lds
 s_add_u32 s65, s65, s66
 s_waitcnt vmcnt(12) lgkmcnt(6)
 v_mfma_f32_32x32x16_bf16 v[128:143], v[104:107], v[96:99], v[128:143]
 ds_read_b128 v[80:83], v234 offset:608
 ds_read_b64_tr_b16 v[88:89], v42 offset:2048
 ds_read_b64_tr_b16 v[90:91], v42 offset:2560
 v_mfma_f32_32x32x16_bf16 v[160:175], v[108:111], v[96:99], v[160:175]
 ds_read_b128 v[84:87], v234 offset:33888
 ds_read_b64_tr_b16 v[92:93], v43 offset:2048
 ds_read_b64_tr_b16 v[94:95], v43 offset:2560
 s_nop 1
 v_cndmask_b32 v226, 0, v18, vcc
 v_cmp_eq_u32 vcc, 7, v16
 s_nop 1
 s_add_u32 m0, s64, 16384
 v_mfma_f32_32x32x16_bf16 v[176:191], v[108:111], v[100:103], v[176:191]
 buffer_load_dwordx4 v41, s[36:39], s65 offen lds
 v_mfma_f32_32x32x16_bf16 v[144:159], v[104:107], v[100:103], v[144:159]
 buffer_load_dwordx4 v44, s[36:39], s65 offen offset:1024 lds
 s_add_u32 s65, s65, s66
 s_waitcnt vmcnt(12) lgkmcnt(6)
 v_mfma_f32_32x32x16_bf16 v[128:143], v[72:75], v[64:67], v[128:143]
 ds_read_b128 v[96:99], v234 offset:640
 ds_read_b64_tr_b16 v[104:105], v42 offset:4096
 ds_read_b64_tr_b16 v[106:107], v42 offset:4608
 v_mfma_f32_32x32x16_bf16 v[160:175], v[76:79], v[64:67], v[160:175]
 ds_read_b128 v[100:103], v234 offset:33920
 ds_read_b64_tr_b16 v[108:109], v43 offset:4096
 ds_read_b64_tr_b16 v[110:111], v43 offset:4608
 v_cndmask_b32 v227, 0, v18, vcc
 v_lshrrev_b32 v16, 2, v255
 v_and_b32_e64 v17, 3, v255
 v_lshlrev_b32 v17, 3, v17
 s_add_u32 m0, s64, 0
 v_mfma_f32_32x32x16_bf16 v[176:191], v[76:79], v[68:71], v[176:191]
 buffer_load_dwordx4 v41, s[36:39], s65 offen lds
 v_mfma_f32_32x32x16_bf16 v[144:159], v[72:75], v[68:71], v[144:159]
 buffer_load_dwordx4 v44, s[36:39], s65 offen offset:1024 lds
 s_add_u32 s65, s65, s66
 s_waitcnt vmcnt(12) lgkmcnt(6)
 v_mfma_f32_32x32x16_bf16 v[128:143], v[88:91], v[80:83], v[128:143]
 ds_read_b128 v[64:67], v234 offset:672
 ds_read_b64_tr_b16 v[72:73], v42 offset:6144
 ds_read_b64_tr_b16 v[74:75], v42 offset:6656
 v_mfma_f32_32x32x16_bf16 v[160:175], v[92:95], v[80:83], v[160:175]
 ds_read_b128 v[68:71], v234 offset:33952
 ds_read_b64_tr_b16 v[76:77], v43 offset:6144
 ds_read_b64_tr_b16 v[78:79], v43 offset:6656
 v_lshl_add_u32 v248, v16, 7, v17
 s_lshl_b32 s67, s61, 15
 s_lshl_b32 s68, s61, 6
 v_add_u32_e64 v244, s67, v237
 s_add_u32 m0, s64, 2048
 v_mfma_f32_32x32x16_bf16 v[176:191], v[92:95], v[84:87], v[176:191]
 buffer_load_dwordx4 v41, s[36:39], s65 offen lds
 v_mfma_f32_32x32x16_bf16 v[144:159], v[88:91], v[84:87], v[144:159]
 buffer_load_dwordx4 v44, s[36:39], s65 offen offset:1024 lds
 s_add_u32 s65, s65, s66
 s_waitcnt vmcnt(12) lgkmcnt(6)
 v_mfma_f32_32x32x16_bf16 v[128:143], v[104:107], v[96:99], v[128:143]
 ds_read_b128 v[80:83], v234 offset:704
 ds_read_b64_tr_b16 v[88:89], v42 offset:8192
 ds_read_b64_tr_b16 v[90:91], v42 offset:8704
 v_mfma_f32_32x32x16_bf16 v[160:175], v[108:111], v[96:99], v[160:175]
 ds_read_b128 v[84:87], v234 offset:33984
 ds_read_b64_tr_b16 v[92:93], v43 offset:8192
 ds_read_b64_tr_b16 v[94:95], v43 offset:8704
 v_xor_b32 v244, s68, v244
 v_xor_b32 v245, 64, v244
 v_mov_b32 v240, v236
 s_lshl_b32 s67, s60, 12
 s_add_u32 m0, s64, 4096
 v_mfma_f32_32x32x16_bf16 v[176:191], v[108:111], v[100:103], v[176:191]
 buffer_load_dwordx4 v41, s[36:39], s65 offen lds
 v_mfma_f32_32x32x16_bf16 v[144:159], v[104:107], v[100:103], v[144:159]
 buffer_load_dwordx4 v44, s[36:39], s65 offen offset:1024 lds
 s_add_u32 s65, s65, s66
 s_waitcnt vmcnt(12) lgkmcnt(6)
 v_mfma_f32_32x32x16_bf16 v[128:143], v[72:75], v[64:67], v[128:143]
 ds_read_b128 v[96:99], v234 offset:736
 ds_read_b64_tr_b16 v[104:105], v42 offset:10240
 ds_read_b64_tr_b16 v[106:107], v42 offset:10752
 v_mfma_f32_32x32x16_bf16 v[160:175], v[76:79], v[64:67], v[160:175]
 ds_read_b128 v[100:103], v234 offset:34016
 ds_read_b64_tr_b16 v[108:109], v43 offset:10240
 ds_read_b64_tr_b16 v[110:111], v43 offset:10752
 s_add_u32 s67, s67, 121856
 v_add_u32_e64 v242, s67, v236
 s_xor_b32 s67, s60, 2
 s_lshl_b32 s67, s67, 12
 s_add_u32 m0, s64, 6144
 v_mfma_f32_32x32x16_bf16 v[176:191], v[76:79], v[68:71], v[176:191]
 buffer_load_dwordx4 v41, s[36:39], s65 offen lds
 v_mfma_f32_32x32x16_bf16 v[144:159], v[72:75], v[68:71], v[144:159]
 buffer_load_dwordx4 v44, s[36:39], s65 offen offset:1024 lds
 s_add_u32 s65, s65, s66
 s_waitcnt vmcnt(12) lgkmcnt(6)
 v_mfma_f32_32x32x16_bf16 v[128:143], v[88:91], v[80:83], v[128:143]
 ds_read_b128 v[64:67], v234 offset:768
 ds_read_b64_tr_b16 v[72:73], v42 offset:12288
 ds_read_b64_tr_b16 v[74:75], v42 offset:12800
 v_mfma_f32_32x32x16_bf16 v[160:175], v[92:95], v[80:83], v[160:175]
 ds_read_b128 v[68:71], v234 offset:34048
 ds_read_b64_tr_b16 v[76:77], v43 offset:12288
 ds_read_b64_tr_b16 v[78:79], v43 offset:12800
 s_add_u32 s67, s67, 121856
 v_add_u32_e64 v243, s67, v236
 s_add_u32 m0, s64, 8192
 v_mfma_f32_32x32x16_bf16 v[176:191], v[92:95], v[84:87], v[176:191]
 buffer_load_dwordx4 v41, s[36:39], s65 offen lds
 v_mfma_f32_32x32x16_bf16 v[144:159], v[88:91], v[84:87], v[144:159]
 buffer_load_dwordx4 v44, s[36:39], s65 offen offset:1024 lds
 s_add_u32 s65, s65, s66
 s_mov_b64 exec, 1
 ds_add_u32 v202, v203 offset:32
 s_mov_b64 exec, -1
 s_waitcnt vmcnt(12) lgkmcnt(7)
 v_mfma_f32_32x32x16_bf16 v[128:143], v[104:107], v[96:99], v[128:143]
 ds_read_b128 v[80:83], v234 offset:800
 ds_read_b64_tr_b16 v[88:89], v42 offset:14336
 ds_read_b64_tr_b16 v[90:91], v42 offset:14848
 v_mfma_f32_32x32x16_bf16 v[160:175], v[108:111], v[96:99], v[160:175]
 ds_read_b128 v[84:87], v234 offset:34080
 ds_read_b64_tr_b16 v[92:93], v43 offset:14336
 ds_read_b64_tr_b16 v[94:95], v43 offset:14848
 v_mfma_f32_32x32x16_bf16 v[176:191], v[108:111], v[100:103], v[176:191]
 v_mfma_f32_32x32x16_bf16 v[144:159], v[104:107], v[100:103], v[144:159]
 s_waitcnt vmcnt(10) lgkmcnt(6)
 s_nop 0
 v_mfma_f32_32x32x16_bf16 v[128:143], v[72:75], v[64:67], v[128:143]
 ds_read_b128 v[96:99], v234 offset:832
 ds_read_b64_tr_b16 v[104:105], v42 offset:16384
 ds_read_b64_tr_b16 v[106:107], v42 offset:16896
 v_mfma_f32_32x32x16_bf16 v[160:175], v[76:79], v[64:67], v[160:175]
 ds_read_b128 v[100:103], v234 offset:34112
 ds_read_b64_tr_b16 v[108:109], v43 offset:16384
 ds_read_b64_tr_b16 v[110:111], v43 offset:16896
 v_mfma_f32_32x32x16_bf16 v[176:191], v[76:79], v[68:71], v[176:191]
 v_mfma_f32_32x32x16_bf16 v[144:159], v[72:75], v[68:71], v[144:159]
 s_waitcnt vmcnt(8) lgkmcnt(6)
 s_nop 0
 v_mfma_f32_32x32x16_bf16 v[128:143], v[88:91], v[80:83], v[128:143]
 ds_read_b128 v[64:67], v234 offset:864
 ds_read_b64_tr_b16 v[72:73], v42 offset:0
 ds_read_b64_tr_b16 v[74:75], v42 offset:512
 v_mfma_f32_32x32x16_bf16 v[160:175], v[92:95], v[80:83], v[160:175]
 ds_read_b128 v[68:71], v234 offset:34144
 ds_read_b64_tr_b16 v[76:77], v43 offset:0
 ds_read_b64_tr_b16 v[78:79], v43 offset:512
 v_mfma_f32_32x32x16_bf16 v[176:191], v[92:95], v[84:87], v[176:191]
 v_mfma_f32_32x32x16_bf16 v[144:159], v[88:91], v[84:87], v[144:159]
 s_waitcnt vmcnt(6) lgkmcnt(6)
 s_nop 0
 v_mfma_f32_32x32x16_bf16 v[128:143], v[104:107], v[96:99], v[128:143]
 ds_read_b128 v[80:83], v234 offset:896
 ds_read_b64_tr_b16 v[88:89], v42 offset:2048
 ds_read_b64_tr_b16 v[90:91], v42 offset:2560
 v_mfma_f32_32x32x16_bf16 v[160:175], v[108:111], v[96:99], v[160:175]
 ds_read_b128 v[84:87], v234 offset:34176
 ds_read_b64_tr_b16 v[92:93], v43 offset:2048
 ds_read_b64_tr_b16 v[94:95], v43 offset:2560
 v_mfma_f32_32x32x16_bf16 v[176:191], v[108:111], v[100:103], v[176:191]
 v_mfma_f32_32x32x16_bf16 v[144:159], v[104:107], v[100:103], v[144:159]
 s_waitcnt vmcnt(4) lgkmcnt(6)
 s_nop 0
 v_mfma_f32_32x32x16_bf16 v[128:143], v[72:75], v[64:67], v[128:143]
 ds_read_b128 v[96:99], v234 offset:928
 ds_read_b64_tr_b16 v[104:105], v42 offset:4096
 ds_read_b64_tr_b16 v[106:107], v42 offset:4608
 v_mfma_f32_32x32x16_bf16 v[160:175], v[76:79], v[64:67], v[160:175]
 ds_read_b128 v[100:103], v234 offset:34208
 ds_read_b64_tr_b16 v[108:109], v43 offset:4096
 ds_read_b64_tr_b16 v[110:111], v43 offset:4608
 v_mfma_f32_32x32x16_bf16 v[176:191], v[76:79], v[68:71], v[176:191]
 v_mfma_f32_32x32x16_bf16 v[144:159], v[72:75], v[68:71], v[144:159]
 s_waitcnt vmcnt(2) lgkmcnt(6)
 s_nop 0
 v_mfma_f32_32x32x16_bf16 v[128:143], v[88:91], v[80:83], v[128:143]
 ds_read_b128 v[64:67], v234 offset:960
 ds_read_b64_tr_b16 v[72:73], v42 offset:6144
 ds_read_b64_tr_b16 v[74:75], v42 offset:6656
 v_mfma_f32_32x32x16_bf16 v[160:175], v[92:95], v[80:83], v[160:175]
 ds_read_b128 v[68:71], v234 offset:34240
 ds_read_b64_tr_b16 v[76:77], v43 offset:6144
 ds_read_b64_tr_b16 v[78:79], v43 offset:6656
 v_mfma_f32_32x32x16_bf16 v[176:191], v[92:95], v[84:87], v[176:191]
 v_mfma_f32_32x32x16_bf16 v[144:159], v[88:91], v[84:87], v[144:159]
 s_waitcnt vmcnt(0) lgkmcnt(6)
 s_nop 0
 v_mfma_f32_32x32x16_bf16 v[128:143], v[104:107], v[96:99], v[128:143]
 ds_read_b128 v[80:83], v234 offset:992
 ds_read_b64_tr_b16 v[88:89], v42 offset:8192
 ds_read_b64_tr_b16 v[90:91], v42 offset:8704
 v_mfma_f32_32x32x16_bf16 v[160:175], v[108:111], v[96:99], v[160:175]
 ds_read_b128 v[84:87], v234 offset:34272
 ds_read_b64_tr_b16 v[92:93], v43 offset:8192
 ds_read_b64_tr_b16 v[94:95], v43 offset:8704
 v_mfma_f32_32x32x16_bf16 v[176:191], v[108:111], v[100:103], v[176:191]
 v_mfma_f32_32x32x16_bf16 v[144:159], v[104:107], v[100:103], v[144:159]
 s_waitcnt lgkmcnt(6)
 s_nop 0
 v_mfma_f32_32x32x16_bf16 v[128:143], v[72:75], v[64:67], v[128:143]
 v_mfma_f32_32x32x16_bf16 v[160:175], v[76:79], v[64:67], v[160:175]
 v_mfma_f32_32x32x16_bf16 v[176:191], v[76:79], v[68:71], v[176:191]
 v_mfma_f32_32x32x16_bf16 v[144:159], v[72:75], v[68:71], v[144:159]
 s_waitcnt lgkmcnt(0)
 s_nop 0
 v_mfma_f32_32x32x16_bf16 v[128:143], v[88:91], v[80:83], v[128:143]
 v_mfma_f32_32x32x16_bf16 v[160:175], v[92:95], v[80:83], v[160:175]
 v_mfma_f32_32x32x16_bf16 v[176:191], v[92:95], v[84:87], v[176:191]
 v_mfma_f32_32x32x16_bf16 v[144:159], v[88:91], v[84:87], v[144:159]
 s_mov_b32 s48, s20
 s_mov_b32 s49, s21
 s_mov_b32 s50, 1835008
 s_mov_b32 s51, 0x20000
 s_mov_b32 s36, s12
 s_mov_b32 s37, s13
 s_mov_b32 s38, 524288
 s_mov_b32 s39, 0x20000
 s_lshl_b32 s65, s72, 10
 s_lshl_b32 s67, s60, 8
 s_add_u32 s65, s65, s67
 v_add_u32 v42, s64, v236
 s_cmp_eq_u32 s60, 0
 s_cbranch_scc1 Lqepi_28
 v_mfma_f32_32x32x16_bf16 v[128:143], v[50:53], v[58:61], v[128:143]
 v_mfma_f32_32x32x16_bf16 v[144:159], v[50:53], v[58:61], v[144:159]
 v_mfma_f32_32x32x16_bf16 v[160:175], v[54:57], v[58:61], v[160:175]
 v_mfma_f32_32x32x16_bf16 v[176:191], v[54:57], v[58:61], v[176:191]
 s_nop 3
 s_nop 0
 v_mov_b32 v44, 0xc0135761
 v_mov_b32 v45, 0xc0135761
 v_mov_b32 v46, 0xbdd2d3e8
 v_mov_b32 v47, 0xbdd2d3e8
 v_mov_b32 v48, 1.0
 v_mov_b32 v49, 1.0
 s_setprio 2
 s_lshl_b32 s67, s60, 2
 v_add_u32_e64 v43, s67, v202
 v_pk_mul_f32 v[64:65], v[128:129], v[128:129]
 v_pk_mul_f32 v[66:67], v[130:131], v[130:131]
 v_pk_mul_f32 v[68:69], v[132:133], v[132:133]
 v_pk_mul_f32 v[70:71], v[134:135], v[134:135]
 v_pk_fma_f32 v[64:65], v[64:65], v[46:47], v[44:45]
 v_pk_fma_f32 v[66:67], v[66:67], v[46:47], v[44:45]
 v_pk_fma_f32 v[68:69], v[68:69], v[46:47], v[44:45]
 v_pk_fma_f32 v[70:71], v[70:71], v[46:47], v[44:45]
 v_pk_mul_f32 v[64:65], v[64:65], v[128:129]
 v_pk_mul_f32 v[66:67], v[66:67], v[130:131]
 v_pk_mul_f32 v[68:69], v[68:69], v[132:133]
 v_pk_mul_f32 v[70:71], v[70:71], v[134:135]
 v_exp_f32 v64, v64
 v_exp_f32 v65, v65
 v_exp_f32 v66, v66
 v_exp_f32 v67, v67
 v_exp_f32 v68, v68
 v_exp_f32 v69, v69
 v_exp_f32 v70, v70
 v_exp_f32 v71, v71
 v_pk_add_f32 v[64:65], v[64:65], v[48:49]
 v_pk_add_f32 v[66:67], v[66:67], v[48:49]
 v_pk_add_f32 v[68:69], v[68:69], v[48:49]
 v_pk_add_f32 v[70:71], v[70:71], v[48:49]
 v_rcp_f32 v64, v64
 v_rcp_f32 v65, v65
 v_rcp_f32 v66, v66
 v_rcp_f32 v67, v67
 v_rcp_f32 v68, v68
 v_rcp_f32 v69, v69
 v_rcp_f32 v70, v70
 v_rcp_f32 v71, v71
 v_pk_mul_f32 v[128:129], v[128:129], v[64:65]
 v_pk_mul_f32 v[130:131], v[130:131], v[66:67]
 v_pk_mul_f32 v[132:133], v[132:133], v[68:69]
 v_pk_mul_f32 v[134:135], v[134:135], v[70:71]
 v_pk_mul_f32 v[64:65], v[136:137], v[136:137]
 v_pk_mul_f32 v[66:67], v[138:139], v[138:139]
 v_pk_mul_f32 v[68:69], v[140:141], v[140:141]
 v_pk_mul_f32 v[70:71], v[142:143], v[142:143]
 v_pk_fma_f32 v[64:65], v[64:65], v[46:47], v[44:45]
 v_pk_fma_f32 v[66:67], v[66:67], v[46:47], v[44:45]
 v_pk_fma_f32 v[68:69], v[68:69], v[46:47], v[44:45]
 v_pk_fma_f32 v[70:71], v[70:71], v[46:47], v[44:45]
 v_pk_mul_f32 v[64:65], v[64:65], v[136:137]
 v_pk_mul_f32 v[66:67], v[66:67], v[138:139]
 v_pk_mul_f32 v[68:69], v[68:69], v[140:141]
 v_pk_mul_f32 v[70:71], v[70:71], v[142:143]
 v_exp_f32 v64, v64
 v_exp_f32 v65, v65
 v_exp_f32 v66, v66
 v_exp_f32 v67, v67
 v_exp_f32 v68, v68
 v_exp_f32 v69, v69
 v_exp_f32 v70, v70
 v_exp_f32 v71, v71
 v_pk_add_f32 v[64:65], v[64:65], v[48:49]
 v_pk_add_f32 v[66:67], v[66:67], v[48:49]
 v_pk_add_f32 v[68:69], v[68:69], v[48:49]
 v_pk_add_f32 v[70:71], v[70:71], v[48:49]
 v_rcp_f32 v64, v64
 v_rcp_f32 v65, v65
 v_rcp_f32 v66, v66
 v_rcp_f32 v67, v67
 v_rcp_f32 v68, v68
 v_rcp_f32 v69, v69
 v_rcp_f32 v70, v70
 v_rcp_f32 v71, v71
 v_pk_mul_f32 v[136:137], v[136:137], v[64:65]
 v_pk_mul_f32 v[138:139], v[138:139], v[66:67]
 v_pk_mul_f32 v[140:141], v[140:141], v[68:69]
 v_pk_mul_f32 v[142:143], v[142:143], v[70:71]
 v_cvt_pk_bf16_f32 v72, v128, v129
 v_cvt_pk_bf16_f32 v73, v130, v131
 v_cvt_pk_bf16_f32 v74, v132, v133
 v_cvt_pk_bf16_f32 v75, v134, v135
 v_cvt_pk_bf16_f32 v76, v136, v137
 v_cvt_pk_bf16_f32 v77, v138, v139
 v_cvt_pk_bf16_f32 v78, v140, v141
 v_cvt_pk_bf16_f32 v79, v142, v143
 ds_write_b128 v42, v[72:75] offset:0
 ds_write_b128 v42, v[76:79] offset:2048
 v_pk_mul_f32 v[64:65], v[144:145], v[144:145]
 v_pk_mul_f32 v[66:67], v[146:147], v[146:147]
 v_pk_mul_f32 v[68:69], v[148:149], v[148:149]
 v_pk_mul_f32 v[70:71], v[150:151], v[150:151]
 v_pk_fma_f32 v[64:65], v[64:65], v[46:47], v[44:45]
 v_pk_fma_f32 v[66:67], v[66:67], v[46:47], v[44:45]
 v_pk_fma_f32 v[68:69], v[68:69], v[46:47], v[44:45]
 v_pk_fma_f32 v[70:71], v[70:71], v[46:47], v[44:45]
 v_pk_mul_f32 v[64:65], v[64:65], v[144:145]
 v_pk_mul_f32 v[66:67], v[66:67], v[146:147]
 v_pk_mul_f32 v[68:69], v[68:69], v[148:149]
 v_pk_mul_f32 v[70:71], v[70:71], v[150:151]
 v_exp_f32 v64, v64
 v_exp_f32 v65, v65
 v_exp_f32 v66, v66
 v_exp_f32 v67, v67
 v_exp_f32 v68, v68
 v_exp_f32 v69, v69
 v_exp_f32 v70, v70
 v_exp_f32 v71, v71
 v_pk_add_f32 v[64:65], v[64:65], v[48:49]
 v_pk_add_f32 v[66:67], v[66:67], v[48:49]
 v_pk_add_f32 v[68:69], v[68:69], v[48:49]
 v_pk_add_f32 v[70:71], v[70:71], v[48:49]
 v_rcp_f32 v64, v64
 v_rcp_f32 v65, v65
 v_rcp_f32 v66, v66
 v_rcp_f32 v67, v67
 v_rcp_f32 v68, v68
 v_rcp_f32 v69, v69
 v_rcp_f32 v70, v70
 v_rcp_f32 v71, v71
 v_pk_mul_f32 v[144:145], v[144:145], v[64:65]
 v_pk_mul_f32 v[146:147], v[146:147], v[66:67]
 v_pk_mul_f32 v[148:149], v[148:149], v[68:69]
 v_pk_mul_f32 v[150:151], v[150:151], v[70:71]
 v_pk_mul_f32 v[64:65], v[152:153], v[152:153]
 v_pk_mul_f32 v[66:67], v[154:155], v[154:155]
 v_pk_mul_f32 v[68:69], v[156:157], v[156:157]
 v_pk_mul_f32 v[70:71], v[158:159], v[158:159]
 v_pk_fma_f32 v[64:65], v[64:65], v[46:47], v[44:45]
 v_pk_fma_f32 v[66:67], v[66:67], v[46:47], v[44:45]
 v_pk_fma_f32 v[68:69], v[68:69], v[46:47], v[44:45]
 v_pk_fma_f32 v[70:71], v[70:71], v[46:47], v[44:45]
 v_pk_mul_f32 v[64:65], v[64:65], v[152:153]
 v_pk_mul_f32 v[66:67], v[66:67], v[154:155]
 v_pk_mul_f32 v[68:69], v[68:69], v[156:157]
 v_pk_mul_f32 v[70:71], v[70:71], v[158:159]
 v_exp_f32 v64, v64
 v_exp_f32 v65, v65
 v_exp_f32 v66, v66
 v_exp_f32 v67, v67
 v_exp_f32 v68, v68
 v_exp_f32 v69, v69
 v_exp_f32 v70, v70
 v_exp_f32 v71, v71
 v_pk_add_f32 v[64:65], v[64:65], v[48:49]
 v_pk_add_f32 v[66:67], v[66:67], v[48:49]
 v_pk_add_f32 v[68:69], v[68:69], v[48:49]
 v_pk_add_f32 v[70:71], v[70:71], v[48:49]
 v_rcp_f32 v64, v64
 v_rcp_f32 v65, v65
 v_rcp_f32 v66, v66
 v_rcp_f32 v67, v67
 v_rcp_f32 v68, v68
 v_rcp_f32 v69, v69
 v_rcp_f32 v70, v70
 v_rcp_f32 v71, v71
 v_pk_mul_f32 v[152:153], v[152:153], v[64:65]
 v_pk_mul_f32 v[154:155], v[154:155], v[66:67]
 v_pk_mul_f32 v[156:157], v[156:157], v[68:69]
 v_pk_mul_f32 v[158:159], v[158:159], v[70:71]
 v_cvt_pk_bf16_f32 v80, v144, v145
 v_cvt_pk_bf16_f32 v81, v146, v147
 v_cvt_pk_bf16_f32 v82, v148, v149
 v_cvt_pk_bf16_f32 v83, v150, v151
 v_cvt_pk_bf16_f32 v84, v152, v153
 v_cvt_pk_bf16_f32 v85, v154, v155
 v_cvt_pk_bf16_f32 v86, v156, v157
 v_cvt_pk_bf16_f32 v87, v158, v159
 ds_write_b128 v42, v[80:83] offset:1024
 ds_write_b128 v42, v[84:87] offset:3072
 v_pk_mul_f32 v[64:65], v[160:161], v[160:161]
 v_pk_mul_f32 v[66:67], v[162:163], v[162:163]
 v_pk_mul_f32 v[68:69], v[164:165], v[164:165]
 v_pk_mul_f32 v[70:71], v[166:167], v[166:167]
 v_pk_fma_f32 v[64:65], v[64:65], v[46:47], v[44:45]
 v_pk_fma_f32 v[66:67], v[66:67], v[46:47], v[44:45]
 v_pk_fma_f32 v[68:69], v[68:69], v[46:47], v[44:45]
 v_pk_fma_f32 v[70:71], v[70:71], v[46:47], v[44:45]
 v_pk_mul_f32 v[64:65], v[64:65], v[160:161]
 v_pk_mul_f32 v[66:67], v[66:67], v[162:163]
 v_pk_mul_f32 v[68:69], v[68:69], v[164:165]
 v_pk_mul_f32 v[70:71], v[70:71], v[166:167]
 v_exp_f32 v64, v64
 v_exp_f32 v65, v65
 v_exp_f32 v66, v66
 v_exp_f32 v67, v67
 v_exp_f32 v68, v68
 v_exp_f32 v69, v69
 v_exp_f32 v70, v70
 v_exp_f32 v71, v71
 v_pk_add_f32 v[64:65], v[64:65], v[48:49]
 v_pk_add_f32 v[66:67], v[66:67], v[48:49]
 v_pk_add_f32 v[68:69], v[68:69], v[48:49]
 v_pk_add_f32 v[70:71], v[70:71], v[48:49]
 v_rcp_f32 v64, v64
 v_rcp_f32 v65, v65
 v_rcp_f32 v66, v66
 v_rcp_f32 v67, v67
 v_rcp_f32 v68, v68
 v_rcp_f32 v69, v69
 v_rcp_f32 v70, v70
 v_rcp_f32 v71, v71
 v_pk_mul_f32 v[160:161], v[160:161], v[64:65]
 v_pk_mul_f32 v[162:163], v[162:163], v[66:67]
 v_pk_mul_f32 v[164:165], v[164:165], v[68:69]
 v_pk_mul_f32 v[166:167], v[166:167], v[70:71]
 v_pk_mul_f32 v[64:65], v[168:169], v[168:169]
 v_pk_mul_f32 v[66:67], v[170:171], v[170:171]
 v_pk_mul_f32 v[68:69], v[172:173], v[172:173]
 v_pk_mul_f32 v[70:71], v[174:175], v[174:175]
 v_pk_fma_f32 v[64:65], v[64:65], v[46:47], v[44:45]
 v_pk_fma_f32 v[66:67], v[66:67], v[46:47], v[44:45]
 v_pk_fma_f32 v[68:69], v[68:69], v[46:47], v[44:45]
 v_pk_fma_f32 v[70:71], v[70:71], v[46:47], v[44:45]
 v_pk_mul_f32 v[64:65], v[64:65], v[168:169]
 v_pk_mul_f32 v[66:67], v[66:67], v[170:171]
 v_pk_mul_f32 v[68:69], v[68:69], v[172:173]
 v_pk_mul_f32 v[70:71], v[70:71], v[174:175]
 v_exp_f32 v64, v64
 v_exp_f32 v65, v65
 v_exp_f32 v66, v66
 v_exp_f32 v67, v67
 v_exp_f32 v68, v68
 v_exp_f32 v69, v69
 v_exp_f32 v70, v70
 v_exp_f32 v71, v71
 v_pk_add_f32 v[64:65], v[64:65], v[48:49]
 v_pk_add_f32 v[66:67], v[66:67], v[48:49]
 v_pk_add_f32 v[68:69], v[68:69], v[48:49]
 v_pk_add_f32 v[70:71], v[70:71], v[48:49]
 v_rcp_f32 v64, v64
 v_rcp_f32 v65, v65
 v_rcp_f32 v66, v66
 v_rcp_f32 v67, v67
 v_rcp_f32 v68, v68
 v_rcp_f32 v69, v69
 v_rcp_f32 v70, v70
 v_rcp_f32 v71, v71
 v_pk_mul_f32 v[168:169], v[168:169], v[64:65]
 v_pk_mul_f32 v[170:171], v[170:171], v[66:67]
 v_pk_mul_f32 v[172:173], v[172:173], v[68:69]
 v_pk_mul_f32 v[174:175], v[174:175], v[70:71]
 v_cvt_pk_bf16_f32 v72, v160, v161
 v_cvt_pk_bf16_f32 v73, v162, v163
 v_cvt_pk_bf16_f32 v74, v164, v165
 v_cvt_pk_bf16_f32 v75, v166, v167
 v_cvt_pk_bf16_f32 v76, v168, v169
 v_cvt_pk_bf16_f32 v77, v170, v171
 v_cvt_pk_bf16_f32 v78, v172, v173
 v_cvt_pk_bf16_f32 v79, v174, v175
 ds_write_b128 v42, v[72:75] offset:4096
 ds_write_b128 v42, v[76:79] offset:6144
 v_pk_mul_f32 v[64:65], v[176:177], v[176:177]
 v_pk_mul_f32 v[66:67], v[178:179], v[178:179]
 v_pk_mul_f32 v[68:69], v[180:181], v[180:181]
 v_pk_mul_f32 v[70:71], v[182:183], v[182:183]
 v_pk_fma_f32 v[64:65], v[64:65], v[46:47], v[44:45]
 v_pk_fma_f32 v[66:67], v[66:67], v[46:47], v[44:45]
 v_pk_fma_f32 v[68:69], v[68:69], v[46:47], v[44:45]
 v_pk_fma_f32 v[70:71], v[70:71], v[46:47], v[44:45]
 v_pk_mul_f32 v[64:65], v[64:65], v[176:177]
 v_pk_mul_f32 v[66:67], v[66:67], v[178:179]
 v_pk_mul_f32 v[68:69], v[68:69], v[180:181]
 v_pk_mul_f32 v[70:71], v[70:71], v[182:183]
 v_exp_f32 v64, v64
 v_exp_f32 v65, v65
 v_exp_f32 v66, v66
 v_exp_f32 v67, v67
 v_exp_f32 v68, v68
 v_exp_f32 v69, v69
 v_exp_f32 v70, v70
 v_exp_f32 v71, v71
 v_pk_add_f32 v[64:65], v[64:65], v[48:49]
 v_pk_add_f32 v[66:67], v[66:67], v[48:49]
 v_pk_add_f32 v[68:69], v[68:69], v[48:49]
 v_pk_add_f32 v[70:71], v[70:71], v[48:49]
 v_rcp_f32 v64, v64
 v_rcp_f32 v65, v65
 v_rcp_f32 v66, v66
 v_rcp_f32 v67, v67
 v_rcp_f32 v68, v68
 v_rcp_f32 v69, v69
 v_rcp_f32 v70, v70
 v_rcp_f32 v71, v71
 v_pk_mul_f32 v[176:177], v[176:177], v[64:65]
 v_pk_mul_f32 v[178:179], v[178:179], v[66:67]
 v_pk_mul_f32 v[180:181], v[180:181], v[68:69]
 v_pk_mul_f32 v[182:183], v[182:183], v[70:71]
 v_pk_mul_f32 v[64:65], v[184:185], v[184:185]
 v_pk_mul_f32 v[66:67], v[186:187], v[186:187]
 v_pk_mul_f32 v[68:69], v[188:189], v[188:189]
 v_pk_mul_f32 v[70:71], v[190:191], v[190:191]
 v_pk_fma_f32 v[64:65], v[64:65], v[46:47], v[44:45]
 v_pk_fma_f32 v[66:67], v[66:67], v[46:47], v[44:45]
 v_pk_fma_f32 v[68:69], v[68:69], v[46:47], v[44:45]
 v_pk_fma_f32 v[70:71], v[70:71], v[46:47], v[44:45]
 v_pk_mul_f32 v[64:65], v[64:65], v[184:185]
 v_pk_mul_f32 v[66:67], v[66:67], v[186:187]
 v_pk_mul_f32 v[68:69], v[68:69], v[188:189]
 v_pk_mul_f32 v[70:71], v[70:71], v[190:191]
 v_exp_f32 v64, v64
 v_exp_f32 v65, v65
 v_exp_f32 v66, v66
 v_exp_f32 v67, v67
 ds_write_b32 v43, v203 offset:48
 v_exp_f32 v68, v68
 v_exp_f32 v69, v69
 v_exp_f32 v70, v70
 v_exp_f32 v71, v71
 v_pk_add_f32 v[64:65], v[64:65], v[48:49]
 v_pk_add_f32 v[66:67], v[66:67], v[48:49]
 v_pk_add_f32 v[68:69], v[68:69], v[48:49]
 v_pk_add_f32 v[70:71], v[70:71], v[48:49]
 v_rcp_f32 v64, v64
 v_rcp_f32 v65, v65
 v_rcp_f32 v66, v66
 v_rcp_f32 v67, v67
 v_rcp_f32 v68, v68
 v_rcp_f32 v69, v69
 v_rcp_f32 v70, v70
 v_rcp_f32 v71, v71
 v_pk_mul_f32 v[184:185], v[184:185], v[64:65]
 v_pk_mul_f32 v[186:187], v[186:187], v[66:67]
 v_pk_mul_f32 v[188:189], v[188:189], v[68:69]
 v_pk_mul_f32 v[190:191], v[190:191], v[70:71]
 v_cvt_pk_bf16_f32 v80, v176, v177
 v_cvt_pk_bf16_f32 v81, v178, v179
 v_cvt_pk_bf16_f32 v82, v180, v181
 v_cvt_pk_bf16_f32 v83, v182, v183
 v_cvt_pk_bf16_f32 v84, v184, v185
 v_cvt_pk_bf16_f32 v85, v186, v187
 v_cvt_pk_bf16_f32 v86, v188, v189
 v_cvt_pk_bf16_f32 v87, v190, v191
 ds_write_b128 v42, v[80:83] offset:5120
 ds_write_b128 v42, v[84:87] offset:7168
 s_mov_b64 exec, 1
 ds_write_b32 v43, v203 offset:48
 ds_add_u32 v202, v203 offset:24
 s_mov_b64 exec, -1
 s_add_u32 m0, s64, 8192
 s_add_u32 s67, s65, 0
 s_nop 0
 buffer_load_dwordx4 v232, s[48:51], s67 offen lds
 s_add_u32 m0, s64, 9216
 s_add_u32 s67, s65, 8192
 buffer_load_dwordx4 v232, s[48:51], s67 offen lds
 s_add_u32 m0, s64, 10240
 s_add_u32 s67, s65, 128
 buffer_load_dwordx4 v232, s[48:51], s67 offen lds
 s_add_u32 m0, s64, 11264
 s_add_u32 s67, s65, 8320
 buffer_load_dwordx4 v232, s[48:51], s67 offen lds
 s_add_u32 s65, s65, 16384
 s_add_u32 m0, s64, 12288
 s_add_u32 s67, s65, 0
 s_nop 0
 buffer_load_dwordx4 v232, s[48:51], s67 offen lds
 s_add_u32 m0, s64, 13312
 s_add_u32 s67, s65, 8192
 buffer_load_dwordx4 v232, s[48:51], s67 offen lds
 s_add_u32 m0, s64, 14336
 s_add_u32 s67, s65, 128
 buffer_load_dwordx4 v232, s[48:51], s67 offen lds
 s_add_u32 m0, s64, 15360
 s_add_u32 s67, s65, 8320
 buffer_load_dwordx4 v232, s[48:51], s67 offen lds
 s_add_u32 s65, s65, 16384
 s_branch Lepidone_29
Lqepi_28:
 v_mov_b32 v192, v50
 v_mov_b32 v50, 0x3eb8aa3b
 v_mov_b32 v51, 0x3eb8aa3b
 s_setprio 2
 s_nop 3
 v_pk_mul_f32 v[128:129], v[128:129], v[50:51]
 v_pk_mul_f32 v[130:131], v[130:131], v[50:51]
 v_pk_mul_f32 v[132:133], v[132:133], v[50:51]
 v_pk_mul_f32 v[134:135], v[134:135], v[50:51]
 v_pk_mul_f32 v[136:137], v[136:137], v[50:51]
 v_pk_mul_f32 v[138:139], v[138:139], v[50:51]
 v_pk_mul_f32 v[140:141], v[140:141], v[50:51]
 v_pk_mul_f32 v[142:143], v[142:143], v[50:51]
 v_pk_mul_f32 v[144:145], v[144:145], v[50:51]
 v_pk_mul_f32 v[146:147], v[146:147], v[50:51]
 v_pk_mul_f32 v[148:149], v[148:149], v[50:51]
 v_pk_mul_f32 v[150:151], v[150:151], v[50:51]
 v_pk_mul_f32 v[152:153], v[152:153], v[50:51]
 v_pk_mul_f32 v[154:155], v[154:155], v[50:51]
 v_pk_mul_f32 v[156:157], v[156:157], v[50:51]
 v_pk_mul_f32 v[158:159], v[158:159], v[50:51]
 v_pk_mul_f32 v[160:161], v[160:161], v[50:51]
 v_pk_mul_f32 v[162:163], v[162:163], v[50:51]
 v_pk_mul_f32 v[164:165], v[164:165], v[50:51]
 v_pk_mul_f32 v[166:167], v[166:167], v[50:51]
 v_pk_mul_f32 v[168:169], v[168:169], v[50:51]
 v_pk_mul_f32 v[170:171], v[170:171], v[50:51]
 v_pk_mul_f32 v[172:173], v[172:173], v[50:51]
 v_pk_mul_f32 v[174:175], v[174:175], v[50:51]
 v_pk_mul_f32 v[176:177], v[176:177], v[50:51]
 v_pk_mul_f32 v[178:179], v[178:179], v[50:51]
 v_pk_mul_f32 v[180:181], v[180:181], v[50:51]
 v_pk_mul_f32 v[182:183], v[182:183], v[50:51]
 v_pk_mul_f32 v[184:185], v[184:185], v[50:51]
 v_pk_mul_f32 v[186:187], v[186:187], v[50:51]
 v_pk_mul_f32 v[188:189], v[188:189], v[50:51]
 v_pk_mul_f32 v[190:191], v[190:191], v[50:51]
 v_cvt_pk_bf16_f32 v72, v128, v129
 v_cvt_pk_bf16_f32 v73, v130, v131
 v_cvt_pk_bf16_f32 v74, v132, v133
 v_cvt_pk_bf16_f32 v75, v134, v135
 v_cvt_pk_bf16_f32 v76, v136, v137
 v_cvt_pk_bf16_f32 v77, v138, v139
 v_cvt_pk_bf16_f32 v78, v140, v141
 v_cvt_pk_bf16_f32 v79, v142, v143
 ds_write_b128 v42, v[72:75] offset:0
 ds_write_b128 v42, v[76:79] offset:2048
 v_cvt_pk_bf16_f32 v80, v144, v145
 v_cvt_pk_bf16_f32 v81, v146, v147
 v_cvt_pk_bf16_f32 v82, v148, v149
 v_cvt_pk_bf16_f32 v83, v150, v151
 v_cvt_pk_bf16_f32 v84, v152, v153
 v_cvt_pk_bf16_f32 v85, v154, v155
 v_cvt_pk_bf16_f32 v86, v156, v157
 v_cvt_pk_bf16_f32 v87, v158, v159
 ds_write_b128 v42, v[80:83] offset:1024
 ds_write_b128 v42, v[84:87] offset:3072
 v_cvt_pk_bf16_f32 v72, v160, v161
 v_cvt_pk_bf16_f32 v73, v162, v163
 v_cvt_pk_bf16_f32 v74, v164, v165
 v_cvt_pk_bf16_f32 v75, v166, v167
 v_cvt_pk_bf16_f32 v76, v168, v169
 v_cvt_pk_bf16_f32 v77, v170, v171
 v_cvt_pk_bf16_f32 v78, v172, v173
 v_cvt_pk_bf16_f32 v79, v174, v175
 ds_write_b128 v42, v[72:75] offset:4096
 ds_write_b128 v42, v[76:79] offset:6144
 v_cvt_pk_bf16_f32 v80, v176, v177
 v_cvt_pk_bf16_f32 v81, v178, v179
 v_cvt_pk_bf16_f32 v82, v180, v181
 v_cvt_pk_bf16_f32 v83, v182, v183
 v_cvt_pk_bf16_f32 v84, v184, v185
 v_cvt_pk_bf16_f32 v85, v186, v187
 v_cvt_pk_bf16_f32 v86, v188, v189
 v_cvt_pk_bf16_f32 v87, v190, v191
 ds_write_b128 v42, v[80:83] offset:5120
 ds_write_b128 v42, v[84:87] offset:7168
 v_pk_mul_f32 v[96:97], v[128:129], v[128:129]
 v_pk_mul_f32 v[98:99], v[136:137], v[136:137]
 v_pk_mul_f32 v[100:101], v[144:145], v[144:145]
 v_pk_mul_f32 v[102:103], v[152:153], v[152:153]
 v_pk_mul_f32 v[104:105], v[160:161], v[160:161]
 v_pk_mul_f32 v[106:107], v[168:169], v[168:169]
 v_pk_mul_f32 v[108:109], v[176:177], v[176:177]
 v_pk_mul_f32 v[110:111], v[184:185], v[184:185]
 v_pk_fma_f32 v[96:97], v[130:131], v[130:131], v[96:97]
 v_pk_fma_f32 v[98:99], v[138:139], v[138:139], v[98:99]
 v_pk_fma_f32 v[100:101], v[146:147], v[146:147], v[100:101]
 v_pk_fma_f32 v[102:103], v[154:155], v[154:155], v[102:103]
 v_pk_fma_f32 v[104:105], v[162:163], v[162:163], v[104:105]
 v_pk_fma_f32 v[106:107], v[170:171], v[170:171], v[106:107]
 v_pk_fma_f32 v[108:109], v[178:179], v[178:179], v[108:109]
 v_pk_fma_f32 v[110:111], v[186:187], v[186:187], v[110:111]
 v_pk_fma_f32 v[96:97], v[132:133], v[132:133], v[96:97]
 v_pk_fma_f32 v[98:99], v[140:141], v[140:141], v[98:99]
 v_pk_fma_f32 v[100:101], v[148:149], v[148:149], v[100:101]
 v_pk_fma_f32 v[102:103], v[156:157], v[156:157], v[102:103]
 v_pk_fma_f32 v[104:105], v[164:165], v[164:165], v[104:105]
 v_pk_fma_f32 v[106:107], v[172:173], v[172:173], v[106:107]
 v_pk_fma_f32 v[108:109], v[180:181], v[180:181], v[108:109]
 v_pk_fma_f32 v[110:111], v[188:189], v[188:189], v[110:111]
 v_pk_fma_f32 v[96:97], v[134:135], v[134:135], v[96:97]
 v_pk_fma_f32 v[98:99], v[142:143], v[142:143], v[98:99]
 v_pk_fma_f32 v[100:101], v[150:151], v[150:151], v[100:101]
 v_pk_fma_f32 v[102:103], v[158:159], v[158:159], v[102:103]
 v_pk_fma_f32 v[104:105], v[166:167], v[166:167], v[104:105]
 v_pk_fma_f32 v[106:107], v[174:175], v[174:175], v[106:107]
 v_pk_fma_f32 v[108:109], v[182:183], v[182:183], v[108:109]
 v_pk_fma_f32 v[110:111], v[190:191], v[190:191], v[110:111]
 v_add_f32 v96, v96, v97
 v_add_f32 v98, v98, v99
 v_add_f32 v100, v100, v101
 v_add_f32 v102, v102, v103
 v_add_f32 v104, v104, v105
 v_add_f32 v106, v106, v107
 v_add_f32 v108, v108, v109
 v_add_f32 v110, v110, v111
 v_permlane32_swap_b32 v96, v98
 v_permlane32_swap_b32 v100, v102
 v_permlane32_swap_b32 v104, v106
 v_permlane32_swap_b32 v108, v110
 s_nop 0
 v_add_f32 v96, v96, v98
 v_add_f32 v100, v100, v102
 v_add_f32 v104, v104, v106
 v_add_f32_e64 v108, v108, v110
 v_max3_f32 v96, v96, v100, v104
 v_max_f32 v96, v96, v108
 s_nop 1
 v_max_u32_dpp v96, v96, v96 row_shr:1 row_mask:0xf bank_mask:0xf
 s_nop 1
 v_max_u32_dpp v96, v96, v96 row_shr:2 row_mask:0xf bank_mask:0xf
 s_nop 1
 v_max_u32_dpp v96, v96, v96 row_shr:4 row_mask:0xf bank_mask:0xf
 s_nop 1
 v_max_u32_dpp v96, v96, v96 row_shr:8 row_mask:0xf bank_mask:0xf
 s_nop 1
 v_max_u32_dpp v96, v96, v96 row_bcast:15 row_mask:0xf bank_mask:0xf
 s_nop 1
 v_max_u32_dpp v96, v96, v96 row_bcast:31 row_mask:0xf bank_mask:0xf
 s_mov_b32 exec_lo, 0
 s_mov_b32 exec_hi, 0x80000000
 ds_write_b32 v202, v96 offset:0
 ds_write_b32 v202, v203 offset:28
 ds_write_b32 v202, v203 offset:48
 s_mov_b64 exec, -1
 s_add_u32 m0, s64, 8192
 s_add_u32 s67, s65, 0
 buffer_load_dwordx4 v232, s[48:51], s67 offen lds
 s_add_u32 m0, s64, 9216
 s_add_u32 s67, s65, 8192
 buffer_load_dwordx4 v232, s[48:51], s67 offen lds
 s_add_u32 m0, s64, 10240
 s_add_u32 s67, s65, 128
 buffer_load_dwordx4 v232, s[48:51], s67 offen lds
 s_add_u32 m0, s64, 11264
 s_add_u32 s67, s65, 8320
 buffer_load_dwordx4 v232, s[48:51], s67 offen lds
 s_add_u32 s65, s65, 16384
 s_add_u32 m0, s64, 12288
 s_add_u32 s67, s65, 0
 s_nop 0
 buffer_load_dwordx4 v232, s[48:51], s67 offen lds
 s_add_u32 m0, s64, 13312
 s_add_u32 s67, s65, 8192
 buffer_load_dwordx4 v232, s[48:51], s67 offen lds
 s_add_u32 m0, s64, 14336
 s_add_u32 s67, s65, 128
 buffer_load_dwordx4 v232, s[48:51], s67 offen lds
 s_add_u32 m0, s64, 15360
 s_add_u32 s67, s65, 8320
 buffer_load_dwordx4 v232, s[48:51], s67 offen lds
 s_add_u32 s65, s65, 16384
Lepidone_29:
 v_mov_b64 v[176:177], -1
 v_mov_b64 v[178:179], -1
 v_mov_b32 v188, 0xc0135761
 v_mov_b32 v190, 0xbdd2d3e8
 s_cmp_eq_u32 s60, 0
 s_cbranch_scc0 LgN_30
 v_mov_b32 v193, 0
 v_mov_b32 v194, 0
 v_mov_b32 v195, 0
 v_mov_b32 v45, 0
 v_mov_b32 v46, 0
 v_mov_b32 v47, 0
 v_mov_b32 v44, 0x3f80
 s_lshl_b32 s66, s73, 1
 s_add_u32 s66, s66, 458752
 s_mov_b32 s70, 0
Llp_32:
 ds_read_b32 v205, v202 offset:40
 s_add_u32 s70, s70, 1
 s_waitcnt lgkmcnt(0)
 v_cmp_gt_u32 vcc, 1, v205
 s_cmp_gt_u32 s70, 1600000
 s_cbranch_scc1 Llpd_33
 s_cbranch_vccz Llpd_33
 s_sleep 1
 s_branch Llp_32
Llpd_33:
 s_setprio 2
 ds_read_b128 v[128:131], v234 offset:0
 ds_read_b64_tr_b16 v[136:137], v235 offset:0
 ds_read_b64_tr_b16 v[138:139], v235 offset:256
 ds_read_b128 v[132:135], v234 offset:33280
 ds_read_b128 v[140:143], v234 offset:32
 ds_read_b64_tr_b16 v[148:149], v235 offset:1024
 ds_read_b64_tr_b16 v[150:151], v235 offset:1280
 ds_read_b128 v[144:147], v234 offset:33312
 ds_read_b128 v[152:155], v234 offset:64
 ds_read_b64_tr_b16 v[160:161], v235 offset:2048
 ds_read_b64_tr_b16 v[162:163], v235 offset:2304
 ds_read_b128 v[156:159], v234 offset:33344
 v_mfma_f32_32x32x16_bf16 v[0:15], v[192:195], v[44:47], 0
 v_mfma_f32_32x32x16_bf16 v[16:31], v[192:195], v[44:47], 0
 s_waitcnt lgkmcnt(8)
 s_nop 0
 v_mfma_f32_32x32x16_bf16 v[0:15], v[136:139], v[128:131], v[0:15]
 ds_read_b128 v[164:167], v234 offset:96
 ds_read_b64_tr_b16 v[172:173], v235 offset:3072
 ds_read_b64_tr_b16 v[174:175], v235 offset:3328
 ds_read_b128 v[168:171], v234 offset:33376
 v_mfma_f32_32x32x16_bf16 v[16:31], v[136:139], v[132:135], v[16:31]
 s_mov_b32 m0, 144640
 s_nop 0
 buffer_load_dwordx4 v198, s[52:55], s66 offen lds
 s_add_u32 s66, s66, 57344
 s_waitcnt lgkmcnt(8)
 v_mfma_f32_32x32x16_bf16 v[0:15], v[148:151], v[140:143], v[0:15]
 ds_read_b128 v[128:131], v234 offset:128
 ds_read_b64_tr_b16 v[136:137], v235 offset:4096
 ds_read_b64_tr_b16 v[138:139], v235 offset:4352
 ds_read_b128 v[132:135], v234 offset:33408
 v_mfma_f32_32x32x16_bf16 v[16:31], v[148:151], v[144:147], v[16:31]
 s_mov_b32 m0, 145664
 s_nop 0
 buffer_load_dwordx4 v198, s[52:55], s66 offen lds
 s_add_u32 s66, s66, 57344
 s_waitcnt lgkmcnt(8)
 v_mfma_f32_32x32x16_bf16 v[0:15], v[160:163], v[152:155], v[0:15]
 ds_read_b128 v[140:143], v234 offset:160
 ds_read_b64_tr_b16 v[148:149], v235 offset:5120
 ds_read_b64_tr_b16 v[150:151], v235 offset:5376
 ds_read_b128 v[144:147], v234 offset:33440
 v_mfma_f32_32x32x16_bf16 v[16:31], v[160:163], v[156:159], v[16:31]
 s_mov_b32 m0, 146688
 s_nop 0
 buffer_load_dwordx4 v198, s[52:55], s66 offen lds
 s_add_u32 s66, s66, 57344
 s_waitcnt lgkmcnt(8)
 v_mfma_f32_32x32x16_bf16 v[0:15], v[172:175], v[164:167], v[0:15]
 ds_read_b128 v[152:155], v234 offset:192
 ds_read_b64_tr_b16 v[160:161], v235 offset:6144
 ds_read_b64_tr_b16 v[162:163], v235 offset:6400
 ds_read_b128 v[156:159], v234 offset:33472
 v_mfma_f32_32x32x16_bf16 v[16:31], v[172:175], v[168:171], v[16:31]
 s_mov_b32 m0, 147712
 s_nop 0
 buffer_load_dwordx4 v198, s[52:55], s66 offen lds
 s_add_u32 s66, s66, 57344
 s_waitcnt lgkmcnt(8)
 v_mfma_f32_32x32x16_bf16 v[0:15], v[136:139], v[128:131], v[0:15]
 ds_read_b128 v[164:167], v234 offset:224
 ds_read_b64_tr_b16 v[172:173], v235 offset:7168
 ds_read_b64_tr_b16 v[174:175], v235 offset:7424
 ds_read_b128 v[168:171], v234 offset:33504
 v_mfma_f32_32x32x16_bf16 v[16:31], v[136:139], v[132:135], v[16:31]
 s_mov_b32 m0, 148736
 s_nop 0
 buffer_load_dwordx4 v198, s[52:55], s66 offen lds
 s_add_u32 s66, s66, 57344
 s_waitcnt lgkmcnt(8)
 s_waitcnt vmcnt(4)
 s_nop 0
 v_mfma_f32_32x32x16_bf16 v[0:15], v[148:151], v[140:143], v[0:15]
 ds_read_b128 v[128:131], v234 offset:256
 ds_read_b64_tr_b16 v[136:137], v235 offset:0
 ds_read_b64_tr_b16 v[138:139], v235 offset:256
 ds_read_b128 v[132:135], v234 offset:33536
 v_mfma_f32_32x32x16_bf16 v[16:31], v[148:151], v[144:147], v[16:31]
 s_mov_b32 m0, 149760
 s_nop 0
 buffer_load_dwordx4 v198, s[52:55], s66 offen lds
 s_add_u32 s66, s66, 57344
 s_waitcnt lgkmcnt(8)
 s_waitcnt vmcnt(4)
 s_nop 0
 v_mfma_f32_32x32x16_bf16 v[0:15], v[160:163], v[152:155], v[0:15]
 ds_read_b128 v[140:143], v234 offset:288
 ds_read_b64_tr_b16 v[148:149], v235 offset:1024
 ds_read_b64_tr_b16 v[150:151], v235 offset:1280
 ds_read_b128 v[144:147], v234 offset:33568
 v_mfma_f32_32x32x16_bf16 v[16:31], v[160:163], v[156:159], v[16:31]
 s_mov_b32 m0, 150784
 s_nop 0
 buffer_load_dwordx4 v198, s[52:55], s66 offen lds
 s_add_u32 s66, s66, 57344
 s_waitcnt lgkmcnt(8)
 s_waitcnt vmcnt(4)
 s_nop 0
 v_mfma_f32_32x32x16_bf16 v[0:15], v[172:175], v[164:167], v[0:15]
 ds_read_b128 v[152:155], v234 offset:320
 ds_read_b64_tr_b16 v[160:161], v235 offset:2048
 ds_read_b64_tr_b16 v[162:163], v235 offset:2304
 ds_read_b128 v[156:159], v234 offset:33600
 v_mfma_f32_32x32x16_bf16 v[16:31], v[172:175], v[168:171], v[16:31]
 s_mov_b32 m0, 151808
 s_nop 0
 buffer_load_dwordx4 v198, s[52:55], s66 offen lds
 s_add_u32 s66, s66, 57344
 s_waitcnt lgkmcnt(8)
 s_waitcnt vmcnt(4)
 s_nop 0
 v_mfma_f32_32x32x16_bf16 v[0:15], v[136:139], v[128:131], v[0:15]
 ds_read_b128 v[164:167], v234 offset:352
 ds_read_b64_tr_b16 v[172:173], v235 offset:3072
 ds_read_b64_tr_b16 v[174:175], v235 offset:3328
 ds_read_b128 v[168:171], v234 offset:33632
 v_mfma_f32_32x32x16_bf16 v[16:31], v[136:139], v[132:135], v[16:31]
 s_mov_b32 m0, 144640
 s_nop 0
 buffer_load_dwordx4 v198, s[52:55], s66 offen lds
 s_add_u32 s66, s66, 57344
 s_waitcnt lgkmcnt(8)
 s_waitcnt vmcnt(4)
 s_nop 0
 v_mfma_f32_32x32x16_bf16 v[0:15], v[148:151], v[140:143], v[0:15]
 ds_read_b128 v[128:131], v234 offset:384
 ds_read_b64_tr_b16 v[136:137], v235 offset:4096
 ds_read_b64_tr_b16 v[138:139], v235 offset:4352
 ds_read_b128 v[132:135], v234 offset:33664
 v_mfma_f32_32x32x16_bf16 v[16:31], v[148:151], v[144:147], v[16:31]
 s_mov_b32 m0, 145664
 s_nop 0
 buffer_load_dwordx4 v198, s[52:55], s66 offen lds
 s_add_u32 s66, s66, 57344
 s_waitcnt lgkmcnt(8)
 s_waitcnt vmcnt(4)
 s_nop 0
 v_mfma_f32_32x32x16_bf16 v[0:15], v[160:163], v[152:155], v[0:15]
 ds_read_b128 v[140:143], v234 offset:416
 ds_read_b64_tr_b16 v[148:149], v235 offset:5120
 ds_read_b64_tr_b16 v[150:151], v235 offset:5376
 ds_read_b128 v[144:147], v234 offset:33696
 v_mfma_f32_32x32x16_bf16 v[16:31], v[160:163], v[156:159], v[16:31]
 s_mov_b32 m0, 146688
 s_nop 0
 buffer_load_dwordx4 v198, s[52:55], s66 offen lds
 s_add_u32 s66, s66, 57344
 s_waitcnt lgkmcnt(8)
 s_waitcnt vmcnt(4)
 s_nop 0
 v_mfma_f32_32x32x16_bf16 v[0:15], v[172:175], v[164:167], v[0:15]
 ds_read_b128 v[152:155], v234 offset:448
 ds_read_b64_tr_b16 v[160:161], v235 offset:6144
 ds_read_b64_tr_b16 v[162:163], v235 offset:6400
 ds_read_b128 v[156:159], v234 offset:33728
 v_mfma_f32_32x32x16_bf16 v[16:31], v[172:175], v[168:171], v[16:31]
 s_mov_b32 m0, 147712
 s_nop 0
 buffer_load_dwordx4 v198, s[52:55], s66 offen lds
 s_add_u32 s66, s66, 57344
 s_waitcnt lgkmcnt(8)
 s_waitcnt vmcnt(4)
 s_nop 0
 v_mfma_f32_32x32x16_bf16 v[0:15], v[136:139], v[128:131], v[0:15]
 ds_read_b128 v[164:167], v234 offset:480
 ds_read_b64_tr_b16 v[172:173], v235 offset:7168
 ds_read_b64_tr_b16 v[174:175], v235 offset:7424
 ds_read_b128 v[168:171], v234 offset:33760
 v_mfma_f32_32x32x16_bf16 v[16:31], v[136:139], v[132:135], v[16:31]
 s_mov_b32 m0, 148736
 s_nop 0
 buffer_load_dwordx4 v198, s[52:55], s66 offen lds
 s_add_u32 s66, s66, 57344
 s_waitcnt lgkmcnt(8)
 s_waitcnt vmcnt(4)
 s_nop 0
 v_mfma_f32_32x32x16_bf16 v[0:15], v[148:151], v[140:143], v[0:15]
 ds_read_b128 v[128:131], v234 offset:512
 ds_read_b64_tr_b16 v[136:137], v235 offset:0
 ds_read_b64_tr_b16 v[138:139], v235 offset:256
 ds_read_b128 v[132:135], v234 offset:33792
 v_mfma_f32_32x32x16_bf16 v[16:31], v[148:151], v[144:147], v[16:31]
 s_mov_b32 m0, 149760
 s_nop 0
 buffer_load_dwordx4 v198, s[52:55], s66 offen lds
 s_add_u32 s66, s66, 57344
 s_waitcnt lgkmcnt(8)
 s_waitcnt vmcnt(4)
 s_nop 0
 v_mfma_f32_32x32x16_bf16 v[0:15], v[160:163], v[152:155], v[0:15]
 ds_read_b128 v[140:143], v234 offset:544
 ds_read_b64_tr_b16 v[148:149], v235 offset:1024
 ds_read_b64_tr_b16 v[150:151], v235 offset:1280
 ds_read_b128 v[144:147], v234 offset:33824
 v_mfma_f32_32x32x16_bf16 v[16:31], v[160:163], v[156:159], v[16:31]
 s_mov_b32 m0, 150784
 s_nop 0
 buffer_load_dwordx4 v198, s[52:55], s66 offen lds
 s_add_u32 s66, s66, 57344
 s_waitcnt lgkmcnt(8)
 s_waitcnt vmcnt(4)
 s_nop 0
 v_mfma_f32_32x32x16_bf16 v[0:15], v[172:175], v[164:167], v[0:15]
 ds_read_b128 v[152:155], v234 offset:576
 ds_read_b64_tr_b16 v[160:161], v235 offset:2048
 ds_read_b64_tr_b16 v[162:163], v235 offset:2304
 ds_read_b128 v[156:159], v234 offset:33856
 v_mfma_f32_32x32x16_bf16 v[16:31], v[172:175], v[168:171], v[16:31]
 s_mov_b32 m0, 151808
 s_nop 0
 buffer_load_dwordx4 v198, s[52:55], s66 offen lds
 s_add_u32 s66, s66, 57344
 s_waitcnt lgkmcnt(8)
 s_waitcnt vmcnt(4)
 s_nop 0
 v_mfma_f32_32x32x16_bf16 v[0:15], v[136:139], v[128:131], v[0:15]
 ds_read_b128 v[164:167], v234 offset:608
 ds_read_b64_tr_b16 v[172:173], v235 offset:3072
 ds_read_b64_tr_b16 v[174:175], v235 offset:3328
 ds_read_b128 v[168:171], v234 offset:33888
 v_mfma_f32_32x32x16_bf16 v[16:31], v[136:139], v[132:135], v[16:31]
 s_mov_b32 m0, 144640
 s_nop 0
 buffer_load_dwordx4 v198, s[52:55], s66 offen lds
 s_add_u32 s66, s66, 57344
 s_waitcnt lgkmcnt(8)
 s_waitcnt vmcnt(4)
 s_nop 0
 v_mfma_f32_32x32x16_bf16 v[0:15], v[148:151], v[140:143], v[0:15]
 ds_read_b128 v[128:131], v234 offset:640
 ds_read_b64_tr_b16 v[136:137], v235 offset:4096
 ds_read_b64_tr_b16 v[138:139], v235 offset:4352
 ds_read_b128 v[132:135], v234 offset:33920
 v_mfma_f32_32x32x16_bf16 v[16:31], v[148:151], v[144:147], v[16:31]
 s_mov_b32 m0, 145664
 s_nop 0
 buffer_load_dwordx4 v198, s[52:55], s66 offen lds
 s_add_u32 s66, s66, 57344
 s_waitcnt lgkmcnt(8)
 s_waitcnt vmcnt(4)
 s_nop 0
 v_mfma_f32_32x32x16_bf16 v[0:15], v[160:163], v[152:155], v[0:15]
 ds_read_b128 v[140:143], v234 offset:672
 ds_read_b64_tr_b16 v[148:149], v235 offset:5120
 ds_read_b64_tr_b16 v[150:151], v235 offset:5376
 ds_read_b128 v[144:147], v234 offset:33952
 v_mfma_f32_32x32x16_bf16 v[16:31], v[160:163], v[156:159], v[16:31]
 s_mov_b32 m0, 146688
 s_nop 0
 buffer_load_dwordx4 v198, s[52:55], s66 offen lds
 s_add_u32 s66, s66, 57344
 s_waitcnt lgkmcnt(8)
 s_waitcnt vmcnt(4)
 s_nop 0
 v_mfma_f32_32x32x16_bf16 v[0:15], v[172:175], v[164:167], v[0:15]
 ds_read_b128 v[152:155], v234 offset:704
 ds_read_b64_tr_b16 v[160:161], v235 offset:6144
 ds_read_b64_tr_b16 v[162:163], v235 offset:6400
 ds_read_b128 v[156:159], v234 offset:33984
 v_mfma_f32_32x32x16_bf16 v[16:31], v[172:175], v[168:171], v[16:31]
 s_mov_b32 m0, 147712
 s_nop 0
 buffer_load_dwordx4 v198, s[52:55], s66 offen lds
 s_add_u32 s66, s66, 57344
 s_waitcnt lgkmcnt(8)
 s_waitcnt vmcnt(4)
 s_nop 0
 v_mfma_f32_32x32x16_bf16 v[0:15], v[136:139], v[128:131], v[0:15]
 ds_read_b128 v[164:167], v234 offset:736
 ds_read_b64_tr_b16 v[172:173], v235 offset:7168
 ds_read_b64_tr_b16 v[174:175], v235 offset:7424
 ds_read_b128 v[168:171], v234 offset:34016
 v_mfma_f32_32x32x16_bf16 v[16:31], v[136:139], v[132:135], v[16:31]
 s_mov_b32 m0, 148736
 s_nop 0
 buffer_load_dwordx4 v198, s[52:55], s66 offen lds
 s_add_u32 s66, s66, 57344
 s_waitcnt lgkmcnt(8)
 s_waitcnt vmcnt(4)
 s_nop 0
 v_mfma_f32_32x32x16_bf16 v[0:15], v[148:151], v[140:143], v[0:15]
 ds_read_b128 v[128:131], v234 offset:768
 ds_read_b64_tr_b16 v[136:137], v235 offset:0
 ds_read_b64_tr_b16 v[138:139], v235 offset:256
 ds_read_b128 v[132:135], v234 offset:34048
 v_mfma_f32_32x32x16_bf16 v[16:31], v[148:151], v[144:147], v[16:31]
 s_mov_b32 m0, 149760
 s_nop 0
 buffer_load_dwordx4 v198, s[52:55], s66 offen lds
 s_add_u32 s66, s66, 57344
 s_waitcnt lgkmcnt(8)
 s_waitcnt vmcnt(4)
 s_nop 0
 v_mfma_f32_32x32x16_bf16 v[0:15], v[160:163], v[152:155], v[0:15]
 ds_read_b128 v[140:143], v234 offset:800
 ds_read_b64_tr_b16 v[148:149], v235 offset:1024
 ds_read_b64_tr_b16 v[150:151], v235 offset:1280
 ds_read_b128 v[144:147], v234 offset:34080
 v_mfma_f32_32x32x16_bf16 v[16:31], v[160:163], v[156:159], v[16:31]
 s_mov_b32 m0, 150784
 s_nop 0
 buffer_load_dwordx4 v198, s[52:55], s66 offen lds
 s_add_u32 s66, s66, 57344
 s_waitcnt lgkmcnt(8)
 s_waitcnt vmcnt(4)
 s_nop 0
 v_mfma_f32_32x32x16_bf16 v[0:15], v[172:175], v[164:167], v[0:15]
 ds_read_b128 v[152:155], v234 offset:832
 ds_read_b64_tr_b16 v[160:161], v235 offset:2048
 ds_read_b64_tr_b16 v[162:163], v235 offset:2304
 ds_read_b128 v[156:159], v234 offset:34112
 v_mfma_f32_32x32x16_bf16 v[16:31], v[172:175], v[168:171], v[16:31]
 s_mov_b32 m0, 151808
 s_nop 0
 buffer_load_dwordx4 v198, s[52:55], s66 offen lds
 s_add_u32 s66, s66, 57344
 s_waitcnt lgkmcnt(8)
 s_waitcnt vmcnt(4)
 s_nop 0
 v_mfma_f32_32x32x16_bf16 v[0:15], v[136:139], v[128:131], v[0:15]
 ds_read_b128 v[164:167], v234 offset:864
 ds_read_b64_tr_b16 v[172:173], v235 offset:3072
 ds_read_b64_tr_b16 v[174:175], v235 offset:3328
 ds_read_b128 v[168:171], v234 offset:34144
 v_mfma_f32_32x32x16_bf16 v[16:31], v[136:139], v[132:135], v[16:31]
 s_waitcnt lgkmcnt(8)
 s_waitcnt vmcnt(3)
 v_mfma_f32_32x32x16_bf16 v[0:15], v[148:151], v[140:143], v[0:15]
 ds_read_b128 v[128:131], v234 offset:896
 ds_read_b64_tr_b16 v[136:137], v235 offset:4096
 ds_read_b64_tr_b16 v[138:139], v235 offset:4352
 ds_read_b128 v[132:135], v234 offset:34176
 v_mfma_f32_32x32x16_bf16 v[16:31], v[148:151], v[144:147], v[16:31]
 s_waitcnt lgkmcnt(8)
 s_waitcnt vmcnt(2)
 v_mfma_f32_32x32x16_bf16 v[0:15], v[160:163], v[152:155], v[0:15]
 ds_read_b128 v[140:143], v234 offset:928
 ds_read_b64_tr_b16 v[148:149], v235 offset:5120
 ds_read_b64_tr_b16 v[150:151], v235 offset:5376
 ds_read_b128 v[144:147], v234 offset:34208
 v_mfma_f32_32x32x16_bf16 v[16:31], v[160:163], v[156:159], v[16:31]
 s_waitcnt lgkmcnt(8)
 s_waitcnt vmcnt(1)
 v_mfma_f32_32x32x16_bf16 v[0:15], v[172:175], v[164:167], v[0:15]
 ds_read_b128 v[152:155], v234 offset:960
 ds_read_b64_tr_b16 v[160:161], v235 offset:6144
 ds_read_b64_tr_b16 v[162:163], v235 offset:6400
 ds_read_b128 v[156:159], v234 offset:34240
 v_mfma_f32_32x32x16_bf16 v[16:31], v[172:175], v[168:171], v[16:31]
 s_waitcnt lgkmcnt(8)
 s_waitcnt vmcnt(0)
 v_mfma_f32_32x32x16_bf16 v[0:15], v[136:139], v[128:131], v[0:15]
 ds_read_b128 v[164:167], v234 offset:992
 ds_read_b64_tr_b16 v[172:173], v235 offset:7168
 ds_read_b64_tr_b16 v[174:175], v235 offset:7424
 ds_read_b128 v[168:171], v234 offset:34272
 v_mfma_f32_32x32x16_bf16 v[16:31], v[136:139], v[132:135], v[16:31]
 s_waitcnt lgkmcnt(8)
 v_mfma_f32_32x32x16_bf16 v[0:15], v[148:151], v[140:143], v[0:15]
 v_mfma_f32_32x32x16_bf16 v[16:31], v[148:151], v[144:147], v[16:31]
 s_waitcnt lgkmcnt(4)
 v_mfma_f32_32x32x16_bf16 v[0:15], v[160:163], v[152:155], v[0:15]
 v_mfma_f32_32x32x16_bf16 v[16:31], v[160:163], v[156:159], v[16:31]
 s_waitcnt lgkmcnt(0)
 v_mfma_f32_32x32x16_bf16 v[0:15], v[172:175], v[164:167], v[0:15]
 v_mfma_f32_32x32x16_bf16 v[16:31], v[172:175], v[168:171], v[16:31]
 s_setprio 2
 v_add_u32 v204, 144640, v236
 s_nop 8
 s_nop 0
 ds_write_b128 v204, v[8:11] offset:2048
 ds_write_b128 v204, v[12:15] offset:3072
 ds_write_b128 v204, v[16:19] offset:4096
 ds_write_b128 v204, v[20:23] offset:5120
 ds_write_b128 v204, v[24:27] offset:6144
 ds_write_b128 v204, v[28:31] offset:7168
 s_waitcnt lgkmcnt(0)
 ds_write_b32 v202, v203 offset:8
 s_setprio 2
 v_mul_f32 v180, v0, v0
 v_mul_f32 v181, v1, v1
 v_mul_f32 v182, v2, v2
 v_mul_f32 v183, v3, v3
 v_mul_f32 v184, v4, v4
 v_mul_f32 v185, v5, v5
 v_mul_f32 v186, v6, v6
 v_mul_f32 v187, v7, v7
 v_fma_f32 v180, v180, v190, v188
 v_fma_f32 v181, v181, v190, v188
 v_fma_f32 v182, v182, v190, v188
 v_fma_f32 v183, v183, v190, v188
 v_fma_f32 v184, v184, v190, v188
 v_fma_f32 v185, v185, v190, v188
 v_fma_f32 v186, v186, v190, v188
 v_fma_f32 v187, v187, v190, v188
 v_mul_f32 v180, v180, v0
 v_mul_f32 v181, v181, v1
 v_mul_f32 v182, v182, v2
 v_mul_f32 v183, v183, v3
 v_mul_f32 v184, v184, v4
 v_mul_f32 v185, v185, v5
 v_mul_f32 v186, v186, v6
 v_mul_f32 v187, v187, v7
 v_exp_f32 v180, v180
 v_exp_f32 v181, v181
 v_exp_f32 v182, v182
 v_exp_f32 v183, v183
 v_exp_f32 v184, v184
 v_exp_f32 v185, v185
 v_exp_f32 v186, v186
 v_exp_f32 v187, v187
 v_add_f32 v180, 1.0, v180
 v_add_f32 v181, 1.0, v181
 v_add_f32 v182, 1.0, v182
 v_add_f32 v183, 1.0, v183
 v_add_f32 v184, 1.0, v184
 v_add_f32 v185, 1.0, v185
 v_add_f32 v186, 1.0, v186
 v_add_f32 v187, 1.0, v187
 v_rcp_f32 v180, v180
 v_rcp_f32 v181, v181
 v_rcp_f32 v182, v182
 v_rcp_f32 v183, v183
 v_rcp_f32 v184, v184
 v_rcp_f32 v185, v185
 v_rcp_f32 v186, v186
 v_rcp_f32 v187, v187
 v_mul_f32 v0, v0, v180
 v_mul_f32 v1, v1, v181
 v_mul_f32 v2, v2, v182
 v_mul_f32 v3, v3, v183
 v_mul_f32 v4, v4, v184
 v_mul_f32 v5, v5, v185
 v_mul_f32 v6, v6, v186
 v_mul_f32 v7, v7, v187
 v_cvt_pk_bf16_f32 v216, v0, v1
 v_cvt_pk_bf16_f32 v217, v2, v3
 v_cvt_pk_bf16_f32 v218, v4, v5
 v_cvt_pk_bf16_f32 v219, v6, v7
 s_lshl_b32 s67, s60, 10
 v_add_u32 v204, s67, v233
 ds_write_b128 v204, v[216:219]
 s_waitcnt lgkmcnt(0)
 s_mov_b64 exec, 1
 ds_add_u32 v202, v203 offset:4
 s_mov_b64 exec, -1
 s_setprio 0
LgN_30:
 s_setprio 2
 s_mov_b32 s70, 0
Llp_34:
 ds_read_b32 v205, v202 offset:24
 s_add_u32 s70, s70, 1
 s_waitcnt lgkmcnt(0)
 v_cmp_gt_u32 vcc, 4, v205
 s_cmp_gt_u32 s70, 1600000
 s_cbranch_scc1 Llpd_35
 s_cbranch_vccz Llpd_35
 s_sleep 1
 s_branch Llp_34
Llpd_35:
 s_setprio 0
 s_lshl_b32 s67, s31, 5
 s_lshl_b32 s68, s3, 2
 s_add_u32 s67, s67, s68
 s_add_u32 s67, s67, s60
 s_lshl_b32 s67, s67, 11
 s_nop 0
 s_add_u32 s67, s67, 1048576
 buffer_store_dwordx4 v[176:179], v236, s[40:43], s67 offen sc1
 buffer_store_dwordx4 v[176:179], v236, s[40:43], s67 offen offset:1024 sc1
 s_waitcnt vmcnt(6)
 s_nop 0
 ds_read_b128 v[128:131], v228 offset:18432
 ds_read_b128 v[132:135], v228 offset:19456
 ds_read_b64_tr_b16 v[136:137], v230 offset:8192
 ds_read_b64_tr_b16 v[138:139], v230 offset:9216
 ds_read_b64_tr_b16 v[140:141], v231 offset:8192
 ds_read_b64_tr_b16 v[142:143], v231 offset:9216
 ds_read_b64_tr_b16 v[144:145], v230 offset:10240
 ds_read_b64_tr_b16 v[146:147], v230 offset:11264
 ds_read_b64_tr_b16 v[148:149], v231 offset:10240
 ds_read_b64_tr_b16 v[150:151], v231 offset:11264
 s_add_u32 m0, s64, 16384
 s_add_u32 s67, s65, 0
 s_nop 0
 buffer_load_dwordx4 v232, s[48:51], s67 offen lds
 s_add_u32 m0, s64, 17408
 s_add_u32 s67, s65, 8192
 buffer_load_dwordx4 v232, s[48:51], s67 offen lds
 s_add_u32 m0, s75, 0
 s_nop 0
 s_add_u32 s67, s65, 128
 buffer_load_dwordx4 v232, s[48:51], s67 offen lds
 s_add_u32 m0, s75, 1024
 s_add_u32 s67, s65, 8320
 buffer_load_dwordx4 v232, s[48:51], s67 offen lds
 s_add_u32 s65, s65, 16384
 s_waitcnt lgkmcnt(0)
 s_waitcnt vmcnt(6)
 v_mfma_f32_32x32x16_bf16 v[0:15], v[136:139], v[128:131], 0
 ds_read_b128 v[152:155], v228 offset:20480
 ds_read_b128 v[156:159], v228 offset:21504
 v_mfma_f32_32x32x16_bf16 v[16:31], v[136:139], v[132:135], 0
 ds_read_b64_tr_b16 v[160:161], v230 offset:12288
 ds_read_b64_tr_b16 v[162:163], v230 offset:13312
 v_mfma_f32_32x32x16_bf16 v[48:63], v[140:143], v[132:135], 0
 ds_read_b64_tr_b16 v[164:165], v231 offset:12288
 ds_read_b64_tr_b16 v[166:167], v231 offset:13312
 v_mfma_f32_32x32x16_bf16 v[32:47], v[140:143], v[128:131], 0
 ds_read_b64_tr_b16 v[168:169], v230 offset:14336
 ds_read_b64_tr_b16 v[170:171], v230 offset:15360
 v_mfma_f32_32x32x16_bf16 v[64:79], v[144:147], v[128:131], 0
 ds_read_b64_tr_b16 v[172:173], v231 offset:14336
 ds_read_b64_tr_b16 v[174:175], v231 offset:15360
 s_add_u32 m0, s64, 8192
 s_add_u32 s67, s65, 0
 s_nop 0
 buffer_load_dwordx4 v232, s[48:51], s67 offen lds
 v_mfma_f32_32x32x16_bf16 v[80:95], v[144:147], v[132:135], 0
 s_add_u32 m0, s64, 9216
 s_add_u32 s67, s65, 8192
 buffer_load_dwordx4 v232, s[48:51], s67 offen lds
 v_mfma_f32_32x32x16_bf16 v[112:127], v[148:151], v[132:135], 0
 s_add_u32 m0, s64, 10240
 s_add_u32 s67, s65, 128
 buffer_load_dwordx4 v232, s[48:51], s67 offen lds
 v_mfma_f32_32x32x16_bf16 v[96:111], v[148:151], v[128:131], 0
 s_add_u32 m0, s64, 11264
 s_add_u32 s67, s65, 8320
 buffer_load_dwordx4 v232, s[48:51], s67 offen lds
 s_add_u32 s65, s65, 16384
 s_waitcnt lgkmcnt(0)
 s_waitcnt vmcnt(4)
 v_mfma_f32_32x32x16_bf16 v[0:15], v[160:163], v[152:155], v[0:15]
 ds_read_b128 v[128:131], v228 offset:22528
 ds_read_b128 v[132:135], v228 offset:23552
 v_mfma_f32_32x32x16_bf16 v[16:31], v[160:163], v[156:159], v[16:31]
 ds_read_b64_tr_b16 v[136:137], v230 offset:16384
 ds_read_b64_tr_b16 v[138:139], v230 offset:17408
 v_mfma_f32_32x32x16_bf16 v[48:63], v[164:167], v[156:159], v[48:63]
 ds_read_b64_tr_b16 v[140:141], v231 offset:16384
 ds_read_b64_tr_b16 v[142:143], v231 offset:17408
 v_mfma_f32_32x32x16_bf16 v[32:47], v[164:167], v[152:155], v[32:47]
 ds_read_b64_tr_b16 v[144:145], v229 offset:0
 ds_read_b64_tr_b16 v[146:147], v229 offset:1024
 v_mfma_f32_32x32x16_bf16 v[64:79], v[168:171], v[152:155], v[64:79]
 ds_read_b64_tr_b16 v[148:149], v199 offset:0
 ds_read_b64_tr_b16 v[150:151], v199 offset:1024
 s_add_u32 m0, s64, 12288
 s_add_u32 s67, s65, 0
 s_nop 0
 buffer_load_dwordx4 v232, s[48:51], s67 offen lds
 v_mfma_f32_32x32x16_bf16 v[80:95], v[168:171], v[156:159], v[80:95]
 s_add_u32 m0, s64, 13312
 s_add_u32 s67, s65, 8192
 buffer_load_dwordx4 v232, s[48:51], s67 offen lds
 v_mfma_f32_32x32x16_bf16 v[112:127], v[172:175], v[156:159], v[112:127]
 s_add_u32 m0, s64, 14336
 s_add_u32 s67, s65, 128
 buffer_load_dwordx4 v232, s[48:51], s67 offen lds
 v_mfma_f32_32x32x16_bf16 v[96:111], v[172:175], v[152:155], v[96:111]
 s_add_u32 m0, s64, 15360
 s_add_u32 s67, s65, 8320
 buffer_load_dwordx4 v232, s[48:51], s67 offen lds
 s_add_u32 s65, s65, 16384
 s_waitcnt lgkmcnt(0)
 s_waitcnt vmcnt(4)
 v_mfma_f32_32x32x16_bf16 v[0:15], v[136:139], v[128:131], v[0:15]
 ds_read_b128 v[152:155], v228 offset:24576
 ds_read_b128 v[156:159], v228 offset:25600
 v_mfma_f32_32x32x16_bf16 v[16:31], v[136:139], v[132:135], v[16:31]
 ds_read_b64_tr_b16 v[160:161], v230 offset:8192
 ds_read_b64_tr_b16 v[162:163], v230 offset:9216
 v_mfma_f32_32x32x16_bf16 v[48:63], v[140:143], v[132:135], v[48:63]
 ds_read_b64_tr_b16 v[164:165], v231 offset:8192
 ds_read_b64_tr_b16 v[166:167], v231 offset:9216
 v_mfma_f32_32x32x16_bf16 v[32:47], v[140:143], v[128:131], v[32:47]
 ds_read_b64_tr_b16 v[168:169], v230 offset:10240
 ds_read_b64_tr_b16 v[170:171], v230 offset:11264
 v_mfma_f32_32x32x16_bf16 v[64:79], v[144:147], v[128:131], v[64:79]
 ds_read_b64_tr_b16 v[172:173], v231 offset:10240
 ds_read_b64_tr_b16 v[174:175], v231 offset:11264
 s_add_u32 m0, s64, 16384
 s_add_u32 s67, s65, 0
 s_nop 0
 buffer_load_dwordx4 v232, s[48:51], s67 offen lds
 v_mfma_f32_32x32x16_bf16 v[80:95], v[144:147], v[132:135], v[80:95]
 s_add_u32 m0, s64, 17408
 s_add_u32 s67, s65, 8192
 buffer_load_dwordx4 v232, s[48:51], s67 offen lds
 v_mfma_f32_32x32x16_bf16 v[112:127], v[148:151], v[132:135], v[112:127]
 s_add_u32 m0, s75, 0
 s_nop 0
 s_add_u32 s67, s65, 128
 buffer_load_dwordx4 v232, s[48:51], s67 offen lds
 v_mfma_f32_32x32x16_bf16 v[96:111], v[148:151], v[128:131], v[96:111]
 s_add_u32 m0, s75, 1024
 s_add_u32 s67, s65, 8320
 buffer_load_dwordx4 v232, s[48:51], s67 offen lds
 s_add_u32 s65, s65, 16384
 s_waitcnt lgkmcnt(0)
 s_waitcnt vmcnt(4)
 v_mfma_f32_32x32x16_bf16 v[0:15], v[160:163], v[152:155], v[0:15]
 ds_read_b128 v[128:131], v228 offset:36864
 ds_read_b128 v[132:135], v228 offset:37888
 v_mfma_f32_32x32x16_bf16 v[16:31], v[160:163], v[156:159], v[16:31]
 ds_read_b64_tr_b16 v[136:137], v230 offset:12288
 ds_read_b64_tr_b16 v[138:139], v230 offset:13312
 v_mfma_f32_32x32x16_bf16 v[48:63], v[164:167], v[156:159], v[48:63]
 ds_read_b64_tr_b16 v[140:141], v231 offset:12288
 ds_read_b64_tr_b16 v[142:143], v231 offset:13312
 v_mfma_f32_32x32x16_bf16 v[32:47], v[164:167], v[152:155], v[32:47]
 ds_read_b64_tr_b16 v[144:145], v230 offset:14336
 ds_read_b64_tr_b16 v[146:147], v230 offset:15360
 v_mfma_f32_32x32x16_bf16 v[64:79], v[168:171], v[152:155], v[64:79]
 ds_read_b64_tr_b16 v[148:149], v231 offset:14336
 ds_read_b64_tr_b16 v[150:151], v231 offset:15360
 s_add_u32 m0, s64, 8192
 s_add_u32 s67, s65, 0
 s_nop 0
 buffer_load_dwordx4 v232, s[48:51], s67 offen lds
 v_mfma_f32_32x32x16_bf16 v[80:95], v[168:171], v[156:159], v[80:95]
 s_add_u32 m0, s64, 9216
 s_add_u32 s67, s65, 8192
 buffer_load_dwordx4 v232, s[48:51], s67 offen lds
 v_mfma_f32_32x32x16_bf16 v[112:127], v[172:175], v[156:159], v[112:127]
 s_add_u32 m0, s64, 10240
 s_add_u32 s67, s65, 128
 buffer_load_dwordx4 v232, s[48:51], s67 offen lds
 v_mfma_f32_32x32x16_bf16 v[96:111], v[172:175], v[152:155], v[96:111]
 s_add_u32 m0, s64, 11264
 s_add_u32 s67, s65, 8320
 buffer_load_dwordx4 v232, s[48:51], s67 offen lds
 s_add_u32 s65, s65, 16384
 s_waitcnt lgkmcnt(0)
 s_waitcnt vmcnt(4)
 v_mfma_f32_32x32x16_bf16 v[0:15], v[136:139], v[128:131], v[0:15]
 ds_read_b128 v[152:155], v228 offset:38912
 ds_read_b128 v[156:159], v228 offset:39936
 v_mfma_f32_32x32x16_bf16 v[16:31], v[136:139], v[132:135], v[16:31]
 ds_read_b64_tr_b16 v[160:161], v230 offset:16384
 ds_read_b64_tr_b16 v[162:163], v230 offset:17408
 v_mfma_f32_32x32x16_bf16 v[48:63], v[140:143], v[132:135], v[48:63]
 ds_read_b64_tr_b16 v[164:165], v231 offset:16384
 ds_read_b64_tr_b16 v[166:167], v231 offset:17408
 v_mfma_f32_32x32x16_bf16 v[32:47], v[140:143], v[128:131], v[32:47]
 ds_read_b64_tr_b16 v[168:169], v229 offset:0
 ds_read_b64_tr_b16 v[170:171], v229 offset:1024
 v_mfma_f32_32x32x16_bf16 v[64:79], v[144:147], v[128:131], v[64:79]
 ds_read_b64_tr_b16 v[172:173], v199 offset:0
 ds_read_b64_tr_b16 v[174:175], v199 offset:1024
 s_add_u32 m0, s64, 12288
 s_add_u32 s67, s65, 0
 s_nop 0
 buffer_load_dwordx4 v232, s[48:51], s67 offen lds
 v_mfma_f32_32x32x16_bf16 v[80:95], v[144:147], v[132:135], v[80:95]
 s_add_u32 m0, s64, 13312
 s_add_u32 s67, s65, 8192
 buffer_load_dwordx4 v232, s[48:51], s67 offen lds
 v_mfma_f32_32x32x16_bf16 v[112:127], v[148:151], v[132:135], v[112:127]
 s_add_u32 m0, s64, 14336
 s_add_u32 s67, s65, 128
 buffer_load_dwordx4 v232, s[48:51], s67 offen lds
 v_mfma_f32_32x32x16_bf16 v[96:111], v[148:151], v[128:131], v[96:111]
 s_add_u32 m0, s64, 15360
 s_add_u32 s67, s65, 8320
 buffer_load_dwordx4 v232, s[48:51], s67 offen lds
 s_add_u32 s65, s65, 16384
 s_waitcnt lgkmcnt(0)
 s_waitcnt vmcnt(4)
 v_mfma_f32_32x32x16_bf16 v[0:15], v[160:163], v[152:155], v[0:15]
 ds_read_b128 v[128:131], v228 offset:40960
 ds_read_b128 v[132:135], v228 offset:41984
 v_mfma_f32_32x32x16_bf16 v[16:31], v[160:163], v[156:159], v[16:31]
 ds_read_b64_tr_b16 v[136:137], v230 offset:8192
 ds_read_b64_tr_b16 v[138:139], v230 offset:9216
 v_mfma_f32_32x32x16_bf16 v[48:63], v[164:167], v[156:159], v[48:63]
 ds_read_b64_tr_b16 v[140:141], v231 offset:8192
 ds_read_b64_tr_b16 v[142:143], v231 offset:9216
 v_mfma_f32_32x32x16_bf16 v[32:47], v[164:167], v[152:155], v[32:47]
 ds_read_b64_tr_b16 v[144:145], v230 offset:10240
 ds_read_b64_tr_b16 v[146:147], v230 offset:11264
 v_mfma_f32_32x32x16_bf16 v[64:79], v[168:171], v[152:155], v[64:79]
 ds_read_b64_tr_b16 v[148:149], v231 offset:10240
 ds_read_b64_tr_b16 v[150:151], v231 offset:11264
 s_add_u32 m0, s64, 16384
 s_add_u32 s67, s65, 0
 s_nop 0
 buffer_load_dwordx4 v232, s[48:51], s67 offen lds
 v_mfma_f32_32x32x16_bf16 v[80:95], v[168:171], v[156:159], v[80:95]
 s_add_u32 m0, s64, 17408
 s_add_u32 s67, s65, 8192
 buffer_load_dwordx4 v232, s[48:51], s67 offen lds
 v_mfma_f32_32x32x16_bf16 v[112:127], v[172:175], v[156:159], v[112:127]
 s_add_u32 m0, s75, 0
 s_nop 0
 s_add_u32 s67, s65, 128
 buffer_load_dwordx4 v232, s[48:51], s67 offen lds
 v_mfma_f32_32x32x16_bf16 v[96:111], v[172:175], v[152:155], v[96:111]
 s_add_u32 m0, s75, 1024
 s_add_u32 s67, s65, 8320
 buffer_load_dwordx4 v232, s[48:51], s67 offen lds
 s_add_u32 s65, s65, 16384
 s_waitcnt lgkmcnt(0)
 s_waitcnt vmcnt(4)
 v_mfma_f32_32x32x16_bf16 v[0:15], v[136:139], v[128:131], v[0:15]
 ds_read_b128 v[152:155], v228 offset:43008
 ds_read_b128 v[156:159], v228 offset:44032
 v_mfma_f32_32x32x16_bf16 v[16:31], v[136:139], v[132:135], v[16:31]
 ds_read_b64_tr_b16 v[160:161], v230 offset:12288
 ds_read_b64_tr_b16 v[162:163], v230 offset:13312
 v_mfma_f32_32x32x16_bf16 v[48:63], v[140:143], v[132:135], v[48:63]
 ds_read_b64_tr_b16 v[164:165], v231 offset:12288
 ds_read_b64_tr_b16 v[166:167], v231 offset:13312
 v_mfma_f32_32x32x16_bf16 v[32:47], v[140:143], v[128:131], v[32:47]
 ds_read_b64_tr_b16 v[168:169], v230 offset:14336
 ds_read_b64_tr_b16 v[170:171], v230 offset:15360
 v_mfma_f32_32x32x16_bf16 v[64:79], v[144:147], v[128:131], v[64:79]
 ds_read_b64_tr_b16 v[172:173], v231 offset:14336
 ds_read_b64_tr_b16 v[174:175], v231 offset:15360
 s_add_u32 m0, s64, 8192
 s_add_u32 s67, s65, 0
 s_nop 0
 buffer_load_dwordx4 v232, s[48:51], s67 offen lds
 v_mfma_f32_32x32x16_bf16 v[80:95], v[144:147], v[132:135], v[80:95]
 s_add_u32 m0, s64, 9216
 s_add_u32 s67, s65, 8192
 buffer_load_dwordx4 v232, s[48:51], s67 offen lds
 v_mfma_f32_32x32x16_bf16 v[112:127], v[148:151], v[132:135], v[112:127]
 s_add_u32 m0, s64, 10240
 s_add_u32 s67, s65, 128
 buffer_load_dwordx4 v232, s[48:51], s67 offen lds
 v_mfma_f32_32x32x16_bf16 v[96:111], v[148:151], v[128:131], v[96:111]
 s_add_u32 m0, s64, 11264
 s_add_u32 s67, s65, 8320
 buffer_load_dwordx4 v232, s[48:51], s67 offen lds
 s_add_u32 s65, s65, 16384
 s_waitcnt lgkmcnt(0)
 s_waitcnt vmcnt(4)
 v_mfma_f32_32x32x16_bf16 v[0:15], v[160:163], v[152:155], v[0:15]
 ds_read_b128 v[128:131], v228 offset:55296
 ds_read_b128 v[132:135], v228 offset:56320
 v_mfma_f32_32x32x16_bf16 v[16:31], v[160:163], v[156:159], v[16:31]
 ds_read_b64_tr_b16 v[136:137], v230 offset:16384
 ds_read_b64_tr_b16 v[138:139], v230 offset:17408
 v_mfma_f32_32x32x16_bf16 v[48:63], v[164:167], v[156:159], v[48:63]
 ds_read_b64_tr_b16 v[140:141], v231 offset:16384
 ds_read_b64_tr_b16 v[142:143], v231 offset:17408
 v_mfma_f32_32x32x16_bf16 v[32:47], v[164:167], v[152:155], v[32:47]
 ds_read_b64_tr_b16 v[144:145], v229 offset:0
 ds_read_b64_tr_b16 v[146:147], v229 offset:1024
 v_mfma_f32_32x32x16_bf16 v[64:79], v[168:171], v[152:155], v[64:79]
 ds_read_b64_tr_b16 v[148:149], v199 offset:0
 ds_read_b64_tr_b16 v[150:151], v199 offset:1024
 s_add_u32 m0, s64, 12288
 s_add_u32 s67, s65, 0
 s_nop 0
 buffer_load_dwordx4 v232, s[48:51], s67 offen lds
 v_mfma_f32_32x32x16_bf16 v[80:95], v[168:171], v[156:159], v[80:95]
 s_add_u32 m0, s64, 13312
 s_add_u32 s67, s65, 8192
 buffer_load_dwordx4 v232, s[48:51], s67 offen lds
 v_mfma_f32_32x32x16_bf16 v[112:127], v[172:175], v[156:159], v[112:127]
 s_add_u32 m0, s64, 14336
 s_add_u32 s67, s65, 128
 buffer_load_dwordx4 v232, s[48:51], s67 offen lds
 v_mfma_f32_32x32x16_bf16 v[96:111], v[172:175], v[152:155], v[96:111]
 s_add_u32 m0, s64, 15360
 s_add_u32 s67, s65, 8320
 buffer_load_dwordx4 v232, s[48:51], s67 offen lds
 s_add_u32 s65, s65, 16384
 s_waitcnt lgkmcnt(0)
 s_waitcnt vmcnt(4)
 v_mfma_f32_32x32x16_bf16 v[0:15], v[136:139], v[128:131], v[0:15]
 ds_read_b128 v[152:155], v228 offset:57344
 ds_read_b128 v[156:159], v228 offset:58368
 v_mfma_f32_32x32x16_bf16 v[16:31], v[136:139], v[132:135], v[16:31]
 ds_read_b64_tr_b16 v[160:161], v230 offset:8192
 ds_read_b64_tr_b16 v[162:163], v230 offset:9216
 v_mfma_f32_32x32x16_bf16 v[48:63], v[140:143], v[132:135], v[48:63]
 ds_read_b64_tr_b16 v[164:165], v231 offset:8192
 ds_read_b64_tr_b16 v[166:167], v231 offset:9216
 v_mfma_f32_32x32x16_bf16 v[32:47], v[140:143], v[128:131], v[32:47]
 ds_read_b64_tr_b16 v[168:169], v230 offset:10240
 ds_read_b64_tr_b16 v[170:171], v230 offset:11264
 v_mfma_f32_32x32x16_bf16 v[64:79], v[144:147], v[128:131], v[64:79]
 ds_read_b64_tr_b16 v[172:173], v231 offset:10240
 ds_read_b64_tr_b16 v[174:175], v231 offset:11264
 s_add_u32 m0, s64, 16384
 s_add_u32 s67, s65, 0
 s_nop 0
 buffer_load_dwordx4 v232, s[48:51], s67 offen lds
 v_mfma_f32_32x32x16_bf16 v[80:95], v[144:147], v[132:135], v[80:95]
 s_add_u32 m0, s64, 17408
 s_add_u32 s67, s65, 8192
 buffer_load_dwordx4 v232, s[48:51], s67 offen lds
 v_mfma_f32_32x32x16_bf16 v[112:127], v[148:151], v[132:135], v[112:127]
 s_add_u32 m0, s75, 0
 s_nop 0
 s_add_u32 s67, s65, 128
 buffer_load_dwordx4 v232, s[48:51], s67 offen lds
 v_mfma_f32_32x32x16_bf16 v[96:111], v[148:151], v[128:131], v[96:111]
 s_add_u32 m0, s75, 1024
 s_add_u32 s67, s65, 8320
 buffer_load_dwordx4 v232, s[48:51], s67 offen lds
 s_lshl_b32 s65, s73, 10
 s_lshl_b32 s67, s60, 8
 s_add_u32 s65, s65, s67
 s_waitcnt lgkmcnt(0)
 s_waitcnt vmcnt(4)
 s_nop 0
 v_mfma_f32_32x32x16_bf16 v[0:15], v[160:163], v[152:155], v[0:15]
 ds_read_b128 v[128:131], v228 offset:59392
 ds_read_b128 v[132:135], v228 offset:60416
 v_mfma_f32_32x32x16_bf16 v[16:31], v[160:163], v[156:159], v[16:31]
 ds_read_b64_tr_b16 v[136:137], v230 offset:12288
 ds_read_b64_tr_b16 v[138:139], v230 offset:13312
 v_mfma_f32_32x32x16_bf16 v[48:63], v[164:167], v[156:159], v[48:63]
 ds_read_b64_tr_b16 v[140:141], v231 offset:12288
 ds_read_b64_tr_b16 v[142:143], v231 offset:13312
 v_mfma_f32_32x32x16_bf16 v[32:47], v[164:167], v[152:155], v[32:47]
 ds_read_b64_tr_b16 v[144:145], v230 offset:14336
 ds_read_b64_tr_b16 v[146:147], v230 offset:15360
 v_mfma_f32_32x32x16_bf16 v[64:79], v[168:171], v[152:155], v[64:79]
 ds_read_b64_tr_b16 v[148:149], v231 offset:14336
 ds_read_b64_tr_b16 v[150:151], v231 offset:15360
 s_add_u32 m0, s64, 8192
 s_add_u32 s67, s65, 0
 s_nop 0
 buffer_load_dwordx4 v232, s[48:51], s67 offen lds
 v_mfma_f32_32x32x16_bf16 v[80:95], v[168:171], v[156:159], v[80:95]
 s_add_u32 m0, s64, 9216
 s_add_u32 s67, s65, 8192
 buffer_load_dwordx4 v232, s[48:51], s67 offen lds
 v_mfma_f32_32x32x16_bf16 v[112:127], v[172:175], v[156:159], v[112:127]
 s_add_u32 m0, s64, 10240
 s_add_u32 s67, s65, 128
 buffer_load_dwordx4 v232, s[48:51], s67 offen lds
 v_mfma_f32_32x32x16_bf16 v[96:111], v[172:175], v[152:155], v[96:111]
 s_add_u32 m0, s64, 11264
 s_add_u32 s67, s65, 8320
 buffer_load_dwordx4 v232, s[48:51], s67 offen lds
 s_add_u32 s65, s65, 16384
 s_waitcnt lgkmcnt(0)
 s_waitcnt vmcnt(4)
 v_mfma_f32_32x32x16_bf16 v[0:15], v[136:139], v[128:131], v[0:15]
 ds_read_b128 v[152:155], v228 offset:61440
 ds_read_b128 v[156:159], v228 offset:62464
 v_mfma_f32_32x32x16_bf16 v[16:31], v[136:139], v[132:135], v[16:31]
 ds_read_b64_tr_b16 v[160:161], v230 offset:16384
 ds_read_b64_tr_b16 v[162:163], v230 offset:17408
 v_mfma_f32_32x32x16_bf16 v[48:63], v[140:143], v[132:135], v[48:63]
 ds_read_b64_tr_b16 v[164:165], v231 offset:16384
 ds_read_b64_tr_b16 v[166:167], v231 offset:17408
 v_mfma_f32_32x32x16_bf16 v[32:47], v[140:143], v[128:131], v[32:47]
 ds_read_b64_tr_b16 v[168:169], v229 offset:0
 ds_read_b64_tr_b16 v[170:171], v229 offset:1024
 v_mfma_f32_32x32x16_bf16 v[64:79], v[144:147], v[128:131], v[64:79]
 ds_read_b64_tr_b16 v[172:173], v199 offset:0
 ds_read_b64_tr_b16 v[174:175], v199 offset:1024
 s_add_u32 m0, s64, 12288
 s_add_u32 s67, s65, 0
 s_nop 0
 buffer_load_dwordx4 v232, s[48:51], s67 offen lds
 v_mfma_f32_32x32x16_bf16 v[80:95], v[144:147], v[132:135], v[80:95]
 s_add_u32 m0, s64, 13312
 s_add_u32 s67, s65, 8192
 buffer_load_dwordx4 v232, s[48:51], s67 offen lds
 v_mfma_f32_32x32x16_bf16 v[112:127], v[148:151], v[132:135], v[112:127]
 s_add_u32 m0, s64, 14336
 s_add_u32 s67, s65, 128
 buffer_load_dwordx4 v232, s[48:51], s67 offen lds
 v_mfma_f32_32x32x16_bf16 v[96:111], v[148:151], v[128:131], v[96:111]
 s_add_u32 m0, s64, 15360
 s_add_u32 s67, s65, 8320
 buffer_load_dwordx4 v232, s[48:51], s67 offen lds
 s_add_u32 s65, s65, 16384
 s_waitcnt lgkmcnt(0)
 s_setprio 2
 s_cmp_eq_u32 s60, 0
 s_cbranch_scc1 Lnq_36
 s_mov_b32 s70, 0
Llp_37:
 ds_read_b32 v205, v202 offset:8
 s_add_u32 s70, s70, 1
 s_waitcnt lgkmcnt(0)
 v_cmp_gt_u32 vcc, 1, v205
 s_cmp_gt_u32 s70, 1600000
 s_cbranch_scc1 Llpd_38
 s_cbranch_vccz Llpd_38
 s_sleep 4
 s_branch Llp_37
Llpd_38:
 s_lshl_b32 s67, s60, 11
 s_add_u32 s67, s67, 144640
 v_add_u32 v204, s67, v236
 ds_read_b128 v[208:211], v204
 ds_read_b128 v[212:215], v204 offset:1024
 s_waitcnt lgkmcnt(0)
 s_setprio 2
 v_mul_f32 v180, v208, v208
 v_mul_f32 v181, v209, v209
 v_mul_f32 v182, v210, v210
 v_mul_f32 v183, v211, v211
 v_mul_f32 v184, v212, v212
 v_mul_f32 v185, v213, v213
 v_mul_f32 v186, v214, v214
 v_mul_f32 v187, v215, v215
 v_fma_f32 v180, v180, v190, v188
 v_fma_f32 v181, v181, v190, v188
 v_fma_f32 v182, v182, v190, v188
 v_fma_f32 v183, v183, v190, v188
 v_fma_f32 v184, v184, v190, v188
 v_fma_f32 v185, v185, v190, v188
 v_fma_f32 v186, v186, v190, v188
 v_fma_f32 v187, v187, v190, v188
 v_mul_f32 v180, v180, v208
 v_mul_f32 v181, v181, v209
 v_mul_f32 v182, v182, v210
 v_mul_f32 v183, v183, v211
 v_mul_f32 v184, v184, v212
 v_mul_f32 v185, v185, v213
 v_mul_f32 v186, v186, v214
 v_mul_f32 v187, v187, v215
 v_exp_f32 v180, v180
 v_exp_f32 v181, v181
 v_exp_f32 v182, v182
 v_exp_f32 v183, v183
 v_exp_f32 v184, v184
 v_exp_f32 v185, v185
 v_exp_f32 v186, v186
 v_exp_f32 v187, v187
 v_add_f32 v180, 1.0, v180
 v_add_f32 v181, 1.0, v181
 v_add_f32 v182, 1.0, v182
 v_add_f32 v183, 1.0, v183
 v_add_f32 v184, 1.0, v184
 v_add_f32 v185, 1.0, v185
 v_add_f32 v186, 1.0, v186
 v_add_f32 v187, 1.0, v187
 v_rcp_f32 v180, v180
 v_rcp_f32 v181, v181
 v_rcp_f32 v182, v182
 v_rcp_f32 v183, v183
 v_rcp_f32 v184, v184
 v_rcp_f32 v185, v185
 v_rcp_f32 v186, v186
 v_rcp_f32 v187, v187
 v_mul_f32 v208, v208, v180
 v_mul_f32 v209, v209, v181
 v_mul_f32 v210, v210, v182
 v_mul_f32 v211, v211, v183
 v_mul_f32 v212, v212, v184
 v_mul_f32 v213, v213, v185
 v_mul_f32 v214, v214, v186
 v_mul_f32 v215, v215, v187
 v_cvt_pk_bf16_f32 v216, v208, v209
 v_cvt_pk_bf16_f32 v217, v210, v211
 v_cvt_pk_bf16_f32 v218, v212, v213
 v_cvt_pk_bf16_f32 v219, v214, v215
 s_lshl_b32 s67, s60, 10
 v_add_u32 v204, s67, v233
 ds_write_b128 v204, v[216:219]
 s_waitcnt lgkmcnt(0)
 s_mov_b64 exec, 1
 ds_add_u32 v202, v203 offset:4
 s_mov_b64 exec, -1
 s_setprio 0
Lnq_36:
 s_setprio 2
 s_mov_b32 s70, 0
Llp_39:
 ds_read_b32 v205, v202 offset:4
 s_add_u32 s70, s70, 1
 s_waitcnt lgkmcnt(0)
 v_cmp_gt_u32 vcc, 4, v205
 s_cmp_gt_u32 s70, 1600000
 s_cbranch_scc1 Llpd_40
 s_cbranch_vccz Llpd_40
 s_sleep 2
 s_branch Llp_39
Llpd_40:
 s_setprio 0
 s_waitcnt vmcnt(4)
 s_lshl_b32 s65, s60, 17
 s_lshl_b32 s67, s3, 7
 s_add_u32 s65, s65, s67
 s_lshl_b32 s69, s60, 14
 s_nop 0
 v_mfma_f32_32x32x16_bf16 v[0:15], v[160:163], v[152:155], v[0:15]
 ds_read_b128 v[128:131], v233 offset:0
 ds_read_b128 v[132:135], v233 offset:2048
 v_mfma_f32_32x32x16_bf16 v[16:31], v[160:163], v[156:159], v[16:31]
 ds_read_b64_tr_b16 v[136:137], v230 offset:8192
 ds_read_b64_tr_b16 v[138:139], v230 offset:9216
 v_mfma_f32_32x32x16_bf16 v[48:63], v[164:167], v[156:159], v[48:63]
 ds_read_b64_tr_b16 v[140:141], v231 offset:8192
 ds_read_b64_tr_b16 v[142:143], v231 offset:9216
 v_mfma_f32_32x32x16_bf16 v[32:47], v[164:167], v[152:155], v[32:47]
 ds_read_b64_tr_b16 v[144:145], v230 offset:10240
 ds_read_b64_tr_b16 v[146:147], v230 offset:11264
 v_mfma_f32_32x32x16_bf16 v[64:79], v[168:171], v[152:155], v[64:79]
 ds_read_b64_tr_b16 v[148:149], v231 offset:10240
 ds_read_b64_tr_b16 v[150:151], v231 offset:11264
 s_add_u32 m0, s69, 0
 s_nop 0
 buffer_load_dwordx4 v232, s[36:39], s65 offen lds
 s_add_u32 s65, s65, 8192
 v_mfma_f32_32x32x16_bf16 v[80:95], v[168:171], v[156:159], v[80:95]
 s_add_u32 m0, s69, 1024
 s_nop 0
 s_nop 0
 buffer_load_dwordx4 v232, s[36:39], s65 offen lds
 s_add_u32 s65, s65, 8192
 v_mfma_f32_32x32x16_bf16 v[112:127], v[172:175], v[156:159], v[112:127]
 s_add_u32 m0, s69, 2048
 s_nop 0
 s_nop 0
 buffer_load_dwordx4 v232, s[36:39], s65 offen lds
 s_add_u32 s65, s65, 8192
 v_mfma_f32_32x32x16_bf16 v[96:111], v[172:175], v[152:155], v[96:111]
 s_add_u32 m0, s69, 3072
 s_nop 0
 buffer_load_dwordx4 v232, s[36:39], s65 offen lds
 s_add_u32 s65, s65, 8192
 s_waitcnt lgkmcnt(0)
 s_waitcnt vmcnt(4)
 s_nop 0
 v_mfma_f32_32x32x16_bf16 v[0:15], v[136:139], v[128:131], v[0:15]
 ds_read_b128 v[152:155], v233 offset:1024
 ds_read_b128 v[156:159], v233 offset:3072
 v_mfma_f32_32x32x16_bf16 v[16:31], v[136:139], v[132:135], v[16:31]
 ds_read_b64_tr_b16 v[160:161], v230 offset:12288
 ds_read_b64_tr_b16 v[162:163], v230 offset:13312
 v_mfma_f32_32x32x16_bf16 v[48:63], v[140:143], v[132:135], v[48:63]
 ds_read_b64_tr_b16 v[164:165], v231 offset:12288
 ds_read_b64_tr_b16 v[166:167], v231 offset:13312
 v_mfma_f32_32x32x16_bf16 v[32:47], v[140:143], v[128:131], v[32:47]
 ds_read_b64_tr_b16 v[168:169], v230 offset:14336
 ds_read_b64_tr_b16 v[170:171], v230 offset:15360
 v_mfma_f32_32x32x16_bf16 v[64:79], v[144:147], v[128:131], v[64:79]
 ds_read_b64_tr_b16 v[172:173], v231 offset:14336
 ds_read_b64_tr_b16 v[174:175], v231 offset:15360
 s_add_u32 m0, s69, 4096
 s_nop 0
 s_nop 0
 buffer_load_dwordx4 v232, s[36:39], s65 offen lds
 s_add_u32 s65, s65, 8192
 v_mfma_f32_32x32x16_bf16 v[80:95], v[144:147], v[132:135], v[80:95]
 s_add_u32 m0, s69, 5120
 s_nop 0
 s_nop 0
 buffer_load_dwordx4 v232, s[36:39], s65 offen lds
 s_add_u32 s65, s65, 8192
 v_mfma_f32_32x32x16_bf16 v[112:127], v[148:151], v[132:135], v[112:127]
 s_add_u32 m0, s69, 6144
 s_nop 0
 s_nop 0
 buffer_load_dwordx4 v232, s[36:39], s65 offen lds
 s_add_u32 s65, s65, 8192
 v_mfma_f32_32x32x16_bf16 v[96:111], v[148:151], v[128:131], v[96:111]
 s_add_u32 m0, s69, 7168
 s_nop 0
 buffer_load_dwordx4 v232, s[36:39], s65 offen lds
 s_add_u32 s65, s65, 8192
 s_waitcnt lgkmcnt(0)
 v_mfma_f32_32x32x16_bf16 v[0:15], v[160:163], v[152:155], v[0:15]
 v_mfma_f32_32x32x16_bf16 v[16:31], v[160:163], v[156:159], v[16:31]
 v_mfma_f32_32x32x16_bf16 v[48:63], v[164:167], v[156:159], v[48:63]
 v_mfma_f32_32x32x16_bf16 v[32:47], v[164:167], v[152:155], v[32:47]
 v_mfma_f32_32x32x16_bf16 v[64:79], v[168:171], v[152:155], v[64:79]
 s_add_u32 m0, s69, 8192
 s_nop 0
 s_nop 0
 buffer_load_dwordx4 v232, s[36:39], s65 offen lds
 s_add_u32 s65, s65, 8192
 v_mfma_f32_32x32x16_bf16 v[80:95], v[168:171], v[156:159], v[80:95]
 s_add_u32 m0, s69, 9216
 s_nop 0
 s_nop 0
 buffer_load_dwordx4 v232, s[36:39], s65 offen lds
 s_add_u32 s65, s65, 8192
 v_mfma_f32_32x32x16_bf16 v[112:127], v[172:175], v[156:159], v[112:127]
 s_add_u32 m0, s69, 10240
 s_nop 0
 s_nop 0
 buffer_load_dwordx4 v232, s[36:39], s65 offen lds
 s_add_u32 s65, s65, 8192
 v_mfma_f32_32x32x16_bf16 v[96:111], v[172:175], v[152:155], v[96:111]
 s_add_u32 m0, s69, 11264
 s_nop 0
 buffer_load_dwordx4 v232, s[36:39], s65 offen lds
 s_add_u32 s65, s65, 8192
 s_mov_b64 exec, 1
 ds_add_u32 v202, v203 offset:16
 s_mov_b64 exec, -1
 s_setprio 2
 s_waitcnt vmcnt(4)
 s_add_u32 m0, s69, 12288
 s_nop 0
 buffer_load_dwordx4 v232, s[36:39], s65 offen lds
 s_add_u32 s65, s65, 8192
 s_add_u32 m0, s69, 13312
 s_nop 0
 s_nop 0
 buffer_load_dwordx4 v232, s[36:39], s65 offen lds
 s_add_u32 s65, s65, 8192
 s_add_u32 m0, s69, 14336
 s_nop 0
 s_nop 0
 buffer_load_dwordx4 v232, s[36:39], s65 offen lds
 s_add_u32 s65, s65, 8192
 s_add_u32 m0, s69, 15360
 s_nop 0
 buffer_load_dwordx4 v232, s[36:39], s65 offen lds
 s_add_u32 s65, s65, 8192
 s_lshl_b32 s67, s31, 3
 s_lshl_b32 s68, s60, 1
 s_add_u32 s67, s67, s68
 s_lshl_b32 s67, s67, 3
 s_add_u32 s67, s67, s3
 s_lshl_b32 s67, s67, 13
 s_nop 0
 s_add_u32 s67, s67, 4194304
 v_cvt_pk_bf16_f32 v128, v0, v1
 v_cvt_pk_bf16_f32 v129, v2, v3
 v_cvt_pk_bf16_f32 v130, v4, v5
 v_cvt_pk_bf16_f32 v131, v6, v7
 v_cvt_pk_bf16_f32 v132, v8, v9
 v_cvt_pk_bf16_f32 v133, v10, v11
 v_cvt_pk_bf16_f32 v134, v12, v13
 v_cvt_pk_bf16_f32 v135, v14, v15
 s_add_u32 s68, s67, 0
 s_waitcnt vmcnt(4)
 buffer_store_dwordx4 v[128:131], v236, s[40:43], s68 offen offset:0 sc1
 buffer_store_dwordx4 v[132:135], v236, s[40:43], s68 offen offset:1024 sc1
 v_cvt_pk_bf16_f32 v136, v16, v17
 v_cvt_pk_bf16_f32 v137, v18, v19
 v_cvt_pk_bf16_f32 v138, v20, v21
 v_cvt_pk_bf16_f32 v139, v22, v23
 v_cvt_pk_bf16_f32 v140, v24, v25
 v_cvt_pk_bf16_f32 v141, v26, v27
 v_cvt_pk_bf16_f32 v142, v28, v29
 v_cvt_pk_bf16_f32 v143, v30, v31
 s_waitcnt vmcnt(4)
 s_nop 0
 buffer_store_dwordx4 v[136:139], v236, s[40:43], s68 offen offset:2048 sc1
 buffer_store_dwordx4 v[140:143], v236, s[40:43], s68 offen offset:3072 sc1
 v_cvt_pk_bf16_f32 v144, v32, v33
 v_cvt_pk_bf16_f32 v145, v34, v35
 v_cvt_pk_bf16_f32 v146, v36, v37
 v_cvt_pk_bf16_f32 v147, v38, v39
 v_cvt_pk_bf16_f32 v148, v40, v41
 v_cvt_pk_bf16_f32 v149, v42, v43
 v_cvt_pk_bf16_f32 v150, v44, v45
 v_cvt_pk_bf16_f32 v151, v46, v47
 s_add_u32 s68, s67, 4096
 s_waitcnt vmcnt(4)
 s_nop 0
 buffer_store_dwordx4 v[144:147], v236, s[40:43], s68 offen offset:0 sc1
 buffer_store_dwordx4 v[148:151], v236, s[40:43], s68 offen offset:1024 sc1
 v_cvt_pk_bf16_f32 v152, v48, v49
 v_cvt_pk_bf16_f32 v153, v50, v51
 v_cvt_pk_bf16_f32 v154, v52, v53
 v_cvt_pk_bf16_f32 v155, v54, v55
 v_cvt_pk_bf16_f32 v156, v56, v57
 v_cvt_pk_bf16_f32 v157, v58, v59
 v_cvt_pk_bf16_f32 v158, v60, v61
 v_cvt_pk_bf16_f32 v159, v62, v63
 s_waitcnt vmcnt(4)
 s_nop 0
 buffer_store_dwordx4 v[152:155], v236, s[40:43], s68 offen offset:2048 sc1
 buffer_store_dwordx4 v[156:159], v236, s[40:43], s68 offen offset:3072 sc1
 v_cvt_pk_bf16_f32 v128, v64, v65
 v_cvt_pk_bf16_f32 v129, v66, v67
 v_cvt_pk_bf16_f32 v130, v68, v69
 v_cvt_pk_bf16_f32 v131, v70, v71
 v_cvt_pk_bf16_f32 v132, v72, v73
 v_cvt_pk_bf16_f32 v133, v74, v75
 v_cvt_pk_bf16_f32 v134, v76, v77
 v_cvt_pk_bf16_f32 v135, v78, v79
 s_add_u32 s68, s67, 65536
 s_waitcnt vmcnt(4)
 s_nop 0
 buffer_store_dwordx4 v[128:131], v236, s[40:43], s68 offen offset:0 sc1
 buffer_store_dwordx4 v[132:135], v236, s[40:43], s68 offen offset:1024 sc1
 v_cvt_pk_bf16_f32 v136, v80, v81
 v_cvt_pk_bf16_f32 v137, v82, v83
 v_cvt_pk_bf16_f32 v138, v84, v85
 v_cvt_pk_bf16_f32 v139, v86, v87
 v_cvt_pk_bf16_f32 v140, v88, v89
 v_cvt_pk_bf16_f32 v141, v90, v91
 v_cvt_pk_bf16_f32 v142, v92, v93
 v_cvt_pk_bf16_f32 v143, v94, v95
 s_waitcnt vmcnt(4)
 s_nop 0
 buffer_store_dwordx4 v[136:139], v236, s[40:43], s68 offen offset:2048 sc1
 buffer_store_dwordx4 v[140:143], v236, s[40:43], s68 offen offset:3072 sc1
 v_cvt_pk_bf16_f32 v144, v96, v97
 v_cvt_pk_bf16_f32 v145, v98, v99
 v_cvt_pk_bf16_f32 v146, v100, v101
 v_cvt_pk_bf16_f32 v147, v102, v103
 v_cvt_pk_bf16_f32 v148, v104, v105
 v_cvt_pk_bf16_f32 v149, v106, v107
 v_cvt_pk_bf16_f32 v150, v108, v109
 v_cvt_pk_bf16_f32 v151, v110, v111
 s_add_u32 s68, s67, 69632
 s_waitcnt vmcnt(4)
 s_nop 0
 buffer_store_dwordx4 v[144:147], v236, s[40:43], s68 offen offset:0 sc1
 buffer_store_dwordx4 v[148:151], v236, s[40:43], s68 offen offset:1024 sc1
 v_cvt_pk_bf16_f32 v152, v112, v113
 v_cvt_pk_bf16_f32 v153, v114, v115
 v_cvt_pk_bf16_f32 v154, v116, v117
 v_cvt_pk_bf16_f32 v155, v118, v119
 v_cvt_pk_bf16_f32 v156, v120, v121
 v_cvt_pk_bf16_f32 v157, v122, v123
 v_cvt_pk_bf16_f32 v158, v124, v125
 v_cvt_pk_bf16_f32 v159, v126, v127
 s_waitcnt vmcnt(4)
 buffer_store_dwordx4 v[152:155], v236, s[40:43], s68 offen offset:2048 sc1
 buffer_store_dwordx4 v[156:159], v236, s[40:43], s68 offen offset:3072 sc1
 v_mov_b32 v4, 0
 s_mov_b32 s70, 0
Ltag_41:
 buffer_load_dwordx2 v[2:3], v4, s[44:47], 0 offen sc1
 s_add_u32 s70, s70, 1
 s_waitcnt vmcnt(0)
 v_readfirstlane_b32 s0, v2
 v_readfirstlane_b32 s1, v3
 s_cmp_gt_u32 s70, 200000
 s_cbranch_scc1 Ltagd_42
 s_cmp_lg_u32 s0, 0
 s_cbranch_scc1 Ltagd_42
 s_sleep 2
 s_branch Ltag_41
Ltagd_42:
 s_mov_b64 exec, 1
 ds_add_u32 v202, v203 offset:20
 s_mov_b64 exec, -1
 s_lshl_b32 s67, s31, 3
 s_add_u32 s67, s67, s3
 s_lshl_b32 s67, s67, 7
 s_lshl_b32 s68, s60, 3
 s_add_u32 s67, s67, s68
 s_add_u32 s67, s67, 524288
 s_mov_b64 exec, 1
 buffer_store_dwordx2 v[2:3], v4, s[40:43], s67 offen sc1
 s_mov_b64 exec, -1
 s_and_b32 s66, s60, 1
 s_lshr_b32 s71, s60, 1
 s_mov_b32 s56, s22
 s_mov_b32 s57, s23
 s_mov_b32 s58, 1024
 s_mov_b32 s59, 0x20000
 s_lshl_b32 s68, s3, 1
 s_add_u32 s68, s68, s71
 s_lshl_b32 s68, s68, 6
 buffer_load_ushort v40, v246, s[56:59], s68 offen
 s_lshl_b32 s67, s31, 16
 s_lshl_b32 s69, s66, 15
 s_add_u32 s67, s67, s69
 s_add_u32 s72, s67, s68
 buffer_load_dwordx2 v[48:49], v247, s[32:35], s72 offen offset:0
 buffer_load_dwordx2 v[50:51], v247, s[32:35], s72 offen offset:16
 buffer_load_dwordx2 v[52:53], v247, s[32:35], s72 offen offset:32
 buffer_load_dwordx2 v[54:55], v247, s[32:35], s72 offen offset:48
 s_lshl_b32 s67, s31, 10
 s_add_u32 s67, s67, 524288
 s_mov_b32 s70, 0
Llp_43:
 ds_read_b32 v74, v202 offset:20
 s_add_u32 s70, s70, 1
 s_waitcnt lgkmcnt(0)
 v_cmp_gt_u32 vcc, 4, v74
 s_cmp_gt_u32 s70, 1600000
 s_cbranch_scc1 Llpd_44
 s_cbranch_vccz Llpd_44
 s_sleep 4
 s_branch Llp_43
Llpd_44:
 s_mov_b32 s70, 0
 s_mov_b32 exec_hi, 0
Lf2_45:
 buffer_load_dwordx2 v[74:75], v248, s[40:43], s67 offen sc1
 s_add_u32 s70, s70, 1
 s_waitcnt vmcnt(0)
 v_cmp_ne_u64 vcc, s[0:1], v[74:75]
 s_cmp_gt_u32 s70, 200000
 s_cbranch_scc1 Lf2d_46
 s_cbranch_vccz Lf2d_46
 s_sleep 8
 s_branch Lf2_45
Lf2d_46:
 s_mov_b64 exec, -1
 s_lshl_b32 s67, s31, 3
 s_add_u32 s67, s67, s3
 s_lshl_b32 s67, s67, 16
 s_lshl_b32 s68, s71, 12
 s_add_u32 s67, s67, s68
 s_lshl_b32 s68, s66, 11
 s_add_u32 s67, s67, s68
 s_add_u32 s67, s67, 4194304
 s_add_u32 s68, s67, 0
 s_nop 0
 buffer_load_dwordx4 v[112:115], v236, s[40:43], s68 offen offset:0 sc1
 buffer_load_dwordx4 v[116:119], v236, s[40:43], s68 offen offset:1024 sc1
 s_add_u32 s68, s67, 8192
 buffer_load_dwordx4 v[120:123], v236, s[40:43], s68 offen offset:0 sc1
 buffer_load_dwordx4 v[124:127], v236, s[40:43], s68 offen offset:1024 sc1
 s_add_u32 s68, s67, 16384
 buffer_load_dwordx4 v[128:131], v236, s[40:43], s68 offen offset:0 sc1
 buffer_load_dwordx4 v[132:135], v236, s[40:43], s68 offen offset:1024 sc1
 s_add_u32 s68, s67, 24576
 buffer_load_dwordx4 v[136:139], v236, s[40:43], s68 offen offset:0 sc1
 buffer_load_dwordx4 v[140:143], v236, s[40:43], s68 offen offset:1024 sc1
 s_waitcnt vmcnt(4)
 s_nop 0
 s_add_u32 s68, s67, 32768
 buffer_load_dwordx4 v[144:147], v236, s[40:43], s68 offen offset:0 sc1
 buffer_load_dwordx4 v[148:151], v236, s[40:43], s68 offen offset:1024 sc1
 s_add_u32 s68, s67, 40960
 buffer_load_dwordx4 v[152:155], v236, s[40:43], s68 offen offset:0 sc1
 buffer_load_dwordx4 v[156:159], v236, s[40:43], s68 offen offset:1024 sc1
 s_waitcnt vmcnt(4)
 s_nop 0
 s_add_u32 s68, s67, 49152
 buffer_load_dwordx4 v[160:163], v236, s[40:43], s68 offen offset:0 sc1
 buffer_load_dwordx4 v[164:167], v236, s[40:43], s68 offen offset:1024 sc1
 s_add_u32 s68, s67, 57344
 buffer_load_dwordx4 v[168:171], v236, s[40:43], s68 offen offset:0 sc1
 buffer_load_dwordx4 v[172:175], v236, s[40:43], s68 offen offset:1024 sc1
 s_waitcnt vmcnt(4)
 s_mov_b32 s48, s24
 s_mov_b32 s49, s25
 s_nop 0
 s_mov_b32 s50, 2097152
 s_mov_b32 s51, 0x20000
 ds_read_b64_tr_b16 v[72:73], v244 offset:10240
 ds_read_b64_tr_b16 v[74:75], v244 offset:11264
 ds_read_b64_tr_b16 v[76:77], v245 offset:10240
 ds_read_b64_tr_b16 v[78:79], v245 offset:11264
 ds_read_b64_tr_b16 v[80:81], v244 offset:12288
 ds_read_b64_tr_b16 v[82:83], v244 offset:13312
 ds_read_b64_tr_b16 v[84:85], v245 offset:12288
 ds_read_b64_tr_b16 v[86:87], v245 offset:13312
 ds_read_b64_tr_b16 v[88:89], v244 offset:14336
 ds_read_b64_tr_b16 v[90:91], v244 offset:15360
 ds_read_b64_tr_b16 v[92:93], v245 offset:14336
 ds_read_b64_tr_b16 v[94:95], v245 offset:15360
 ds_read_b64_tr_b16 v[96:97], v244 offset:16384
 ds_read_b64_tr_b16 v[98:99], v244 offset:17408
 ds_read_b64_tr_b16 v[100:101], v245 offset:16384
 ds_read_b64_tr_b16 v[102:103], v245 offset:17408
 ds_read_b64_tr_b16 v[104:105], v244 offset:18432
 ds_read_b64_tr_b16 v[106:107], v244 offset:19456
 ds_read_b64_tr_b16 v[108:109], v245 offset:18432
 ds_read_b64_tr_b16 v[110:111], v245 offset:19456
 s_lshl_b32 s67, s31, 1
 s_add_u32 s67, s67, s71
 s_lshl_b32 s67, s67, 15
 s_lshl_b32 s68, s66, 10
 s_add_u32 s67, s67, s68
 s_add_u32 s67, s67, 1048576
 s_mov_b32 s69, 0
 s_mov_b32 s70, 0
 s_mov_b64 s[76:77], -1
 s_waitcnt vmcnt(0) lgkmcnt(0)
 s_barrier
 v_mov_b32 v41, 0
 v_mov_b32 v42, 0
 v_mov_b32 v43, 0
 v_mov_b32 v45, 0
 v_mov_b32 v46, 0
 v_mov_b32 v47, 0
 v_mov_b32 v44, 0x3f80
 v_mov_b64 v[16:17], 0
 v_mov_b64 v[18:19], 0
 v_mov_b64 v[20:21], 0
 v_mov_b64 v[22:23], 0
 v_mov_b64 v[24:25], 0
 v_mov_b64 v[26:27], 0
 v_mov_b64_e64 v[28:29], 0
 v_mov_b64 v[30:31], 0
 s_barrier
 v_mfma_f32_32x32x16_bf16 v[0:15], v[40:43], v[44:47], 0
 v_mfma_f32_32x32x16_bf16 v[0:15], v[220:223], v[48:51], v[0:15]
 v_mfma_f32_32x32x16_bf16 v[0:15], v[224:227], v[52:55], v[0:15]
 v_mfma_f32_32x32x16_bf16 v[0:15], v[220:223], v[112:115], v[0:15]
 v_mfma_f32_32x32x16_bf16 v[0:15], v[224:227], v[116:119], v[0:15]
 v_mfma_f32_32x32x16_bf16 v[0:15], v[220:223], v[120:123], v[0:15]
 v_mfma_f32_32x32x16_bf16 v[0:15], v[224:227], v[124:127], v[0:15]
 v_mfma_f32_32x32x16_bf16 v[0:15], v[220:223], v[128:131], v[0:15]
 v_mfma_f32_32x32x16_bf16 v[0:15], v[224:227], v[132:135], v[0:15]
 v_mfma_f32_32x32x16_bf16 v[0:15], v[220:223], v[136:139], v[0:15]
 v_mfma_f32_32x32x16_bf16 v[0:15], v[224:227], v[140:143], v[0:15]
 v_mfma_f32_32x32x16_bf16 v[0:15], v[220:223], v[144:147], v[0:15]
 v_mfma_f32_32x32x16_bf16 v[0:15], v[224:227], v[148:151], v[0:15]
 v_mfma_f32_32x32x16_bf16 v[0:15], v[220:223], v[152:155], v[0:15]
 v_mfma_f32_32x32x16_bf16 v[0:15], v[224:227], v[156:159], v[0:15]
 v_mfma_f32_32x32x16_bf16 v[0:15], v[220:223], v[160:163], v[0:15]
 v_mfma_f32_32x32x16_bf16 v[0:15], v[224:227], v[164:167], v[0:15]
 v_mfma_f32_32x32x16_bf16 v[0:15], v[220:223], v[168:171], v[0:15]
 v_mfma_f32_32x32x16_bf16 v[0:15], v[224:227], v[172:175], v[0:15]
 ds_read_b64_tr_b16 v[32:33], v244 offset:0
 ds_read_b64_tr_b16 v[34:35], v244 offset:1024
 ds_read_b64_tr_b16 v[36:37], v245 offset:0
 ds_read_b64_tr_b16 v[38:39], v245 offset:1024
 ds_read_b64_tr_b16 v[40:41], v244 offset:2048
 ds_read_b64_tr_b16 v[42:43], v244 offset:3072
 ds_read_b64_tr_b16 v[44:45], v245 offset:2048
 ds_read_b64_tr_b16 v[46:47], v245 offset:3072
 ds_read_b64_tr_b16 v[48:49], v244 offset:4096
 ds_read_b64_tr_b16 v[50:51], v244 offset:5120
 ds_read_b64_tr_b16 v[52:53], v245 offset:4096
 ds_read_b64_tr_b16 v[54:55], v245 offset:5120
 ds_read_b64_tr_b16 v[56:57], v244 offset:6144
 ds_read_b64_tr_b16 v[58:59], v244 offset:7168
 ds_read_b64_tr_b16 v[60:61], v245 offset:6144
 ds_read_b64_tr_b16 v[62:63], v245 offset:7168
 ds_read_b64_tr_b16 v[64:65], v244 offset:8192
 ds_read_b64_tr_b16 v[66:67], v244 offset:9216
 ds_read_b64_tr_b16 v[68:69], v245 offset:8192
 ds_read_b64_tr_b16 v[70:71], v245 offset:9216
 ds_read_b64_tr_b16 v[112:113], v244 offset:20480
 ds_read_b64_tr_b16 v[114:115], v244 offset:21504
 ds_read_b64_tr_b16 v[116:117], v245 offset:20480
 ds_read_b64_tr_b16 v[118:119], v245 offset:21504
 ds_read_b64_tr_b16 v[120:121], v244 offset:22528
 ds_read_b64_tr_b16 v[122:123], v244 offset:23552
 ds_read_b64_tr_b16 v[124:125], v245 offset:22528
 ds_read_b64_tr_b16 v[126:127], v245 offset:23552
 ds_read_b64_tr_b16 v[128:129], v244 offset:24576
 ds_read_b64_tr_b16 v[130:131], v244 offset:25600
 ds_read_b64_tr_b16 v[132:133], v245 offset:24576
 ds_read_b64_tr_b16 v[134:135], v245 offset:25600
 ds_read_b64_tr_b16 v[136:137], v244 offset:26624
 ds_read_b64_tr_b16 v[138:139], v244 offset:27648
 ds_read_b64_tr_b16 v[140:141], v245 offset:26624
 ds_read_b64_tr_b16 v[142:143], v245 offset:27648
 ds_read_b64_tr_b16 v[144:145], v244 offset:28672
 ds_read_b64_tr_b16 v[146:147], v244 offset:29696
 ds_read_b64_tr_b16 v[148:149], v245 offset:28672
 ds_read_b64_tr_b16 v[150:151], v245 offset:29696
 ds_read_b64_tr_b16 v[152:153], v244 offset:30720
 ds_read_b64_tr_b16 v[154:155], v244 offset:31744
 ds_read_b64_tr_b16 v[156:157], v245 offset:30720
 ds_read_b64_tr_b16 v[158:159], v245 offset:31744
LOP0:
 s_add_u32 s68, s67, 0
 s_nop 0
 buffer_load_dwordx4 v[176:179], v240, s[40:43], s68 offen offset:0 sc1
 buffer_load_dwordx4 v[180:183], v240, s[40:43], s68 offen offset:2048 sc1
 s_add_u32 s68, s67, 4096
 buffer_load_dwordx4 v[184:187], v240, s[40:43], s68 offen offset:0 sc1
 buffer_load_dwordx4 v[188:191], v240, s[40:43], s68 offen offset:2048 sc1
 s_add_u32 s68, s67, 8192
 buffer_load_dwordx4 v[192:195], v240, s[40:43], s68 offen offset:0 sc1
 buffer_load_dwordx4 v[196:199], v240, s[40:43], s68 offen offset:2048 sc1
 s_add_u32 s68, s67, 12288
 buffer_load_dwordx4 v[200:203], v240, s[40:43], s68 offen offset:0 sc1
 buffer_load_dwordx4 v[204:207], v240, s[40:43], s68 offen offset:2048 sc1
 s_add_u32 s68, s67, 16384
 buffer_load_dwordx4 v[208:211], v240, s[40:43], s68 offen offset:0 sc1
 buffer_load_dwordx4 v[212:215], v240, s[40:43], s68 offen offset:2048 sc1
 s_add_u32 s68, s67, 20480
 buffer_load_dwordx4 v[216:219], v240, s[40:43], s68 offen offset:0 sc1
 buffer_load_dwordx4 v[220:223], v240, s[40:43], s68 offen offset:2048 sc1
 s_add_u32 s68, s67, 24576
 buffer_load_dwordx4 v[224:227], v240, s[40:43], s68 offen offset:0 sc1
 buffer_load_dwordx4 v[228:231], v240, s[40:43], s68 offen offset:2048 sc1
 s_add_u32 s68, s67, 28672
 buffer_load_dwordx4 v[232:235], v240, s[40:43], s68 offen offset:0 sc1
 buffer_load_dwordx4 v[236:239], v240, s[40:43], s68 offen offset:2048 sc1
LOP1:
 s_add_u32 s70, s70, 1
 s_cmp_gt_u32 s70, 200000
 s_cselect_b64 s[76:77], 0, -1
 s_waitcnt lgkmcnt(0)
 s_waitcnt vmcnt(12)
 v_max3_u32 v250, v176, v177, v178
 v_max3_u32 v251, v180, v181, v182
 v_max3_u32 v252, v184, v185, v186
 v_max3_u32 v253, v188, v189, v190
 v_max3_u32 v250, v250, v179, v183
 v_max3_u32 v251, v251, v187, v191
 v_max3_u32 v250, v250, v251, v252
 v_max_u32 v250, v250, v253
 v_cmp_eq_u32 vcc, -1, v250
 s_and_b64 vcc, vcc, s[76:77]
 s_cbranch_vccnz Loc_47
 v_mfma_f32_32x32x16_bf16 v[16:31], v[36:39], v[176:179], v[16:31]
 v_mfma_f32_32x32x16_bf16 v[16:31], v[44:47], v[180:183], v[16:31]
 v_mfma_f32_32x32x16_bf16 v[16:31], v[52:55], v[184:187], v[16:31]
 v_mfma_f32_32x32x16_bf16 v[16:31], v[60:63], v[188:191], v[16:31]
 v_mfma_f32_32x32x16_bf16 v[0:15], v[32:35], v[176:179], v[0:15]
 v_mfma_f32_32x32x16_bf16 v[0:15], v[40:43], v[180:183], v[0:15]
 v_mfma_f32_32x32x16_bf16 v[0:15], v[48:51], v[184:187], v[0:15]
 v_mfma_f32_32x32x16_bf16 v[0:15], v[56:59], v[188:191], v[0:15]
 s_bitset1_b32 s69, 0
Loc_47:
 s_waitcnt vmcnt(8)
 v_max3_u32 v250, v192, v193, v194
 v_max3_u32 v251, v196, v197, v198
 v_max3_u32 v252, v200, v201, v202
 v_max3_u32 v253, v204, v205, v206
 v_max3_u32 v250, v250, v195, v199
 v_max3_u32 v251, v251, v203, v207
 v_max3_u32 v250, v250, v251, v252
 v_max_u32 v250, v250, v253
 v_cmp_eq_u32 vcc, -1, v250
 s_and_b64 vcc, vcc, s[76:77]
 s_cbranch_vccnz Loc_48
 v_mfma_f32_32x32x16_bf16 v[16:31], v[68:71], v[192:195], v[16:31]
 v_mfma_f32_32x32x16_bf16 v[16:31], v[76:79], v[196:199], v[16:31]
 v_mfma_f32_32x32x16_bf16 v[16:31], v[84:87], v[200:203], v[16:31]
 v_mfma_f32_32x32x16_bf16 v[16:31], v[92:95], v[204:207], v[16:31]
 v_mfma_f32_32x32x16_bf16 v[0:15], v[64:67], v[192:195], v[0:15]
 v_mfma_f32_32x32x16_bf16 v[0:15], v[72:75], v[196:199], v[0:15]
 v_mfma_f32_32x32x16_bf16 v[0:15], v[80:83], v[200:203], v[0:15]
 v_mfma_f32_32x32x16_bf16 v[0:15], v[88:91], v[204:207], v[0:15]
 s_bitset1_b32 s69, 1
Loc_48:
 s_waitcnt vmcnt(4)
 v_max3_u32 v250, v208, v209, v210
 v_max3_u32 v251, v212, v213, v214
 v_max3_u32 v252, v216, v217, v218
 v_max3_u32 v253, v220, v221, v222
 v_max3_u32 v250, v250, v211, v215
 v_max3_u32 v251, v251, v219, v223
 v_max3_u32 v250, v250, v251, v252
 v_max_u32 v250, v250, v253
 v_cmp_eq_u32 vcc, -1, v250
 s_and_b64 vcc, vcc, s[76:77]
 s_cbranch_vccnz Loc_49
 v_mfma_f32_32x32x16_bf16 v[16:31], v[100:103], v[208:211], v[16:31]
 v_mfma_f32_32x32x16_bf16 v[16:31], v[108:111], v[212:215], v[16:31]
 v_mfma_f32_32x32x16_bf16 v[16:31], v[116:119], v[216:219], v[16:31]
 v_mfma_f32_32x32x16_bf16 v[16:31], v[124:127], v[220:223], v[16:31]
 v_mfma_f32_32x32x16_bf16 v[0:15], v[96:99], v[208:211], v[0:15]
 v_mfma_f32_32x32x16_bf16 v[0:15], v[104:107], v[212:215], v[0:15]
 v_mfma_f32_32x32x16_bf16 v[0:15], v[112:115], v[216:219], v[0:15]
 v_mfma_f32_32x32x16_bf16 v[0:15], v[120:123], v[220:223], v[0:15]
 s_bitset1_b32 s69, 2
Loc_49:
 s_waitcnt vmcnt(0)
 v_max3_u32 v250, v224, v225, v226
 v_max3_u32 v251, v228, v229, v230
 v_max3_u32 v252, v232, v233, v234
 v_max3_u32 v253, v236, v237, v238
 v_max3_u32 v250, v250, v227, v231
 v_max3_u32 v251, v251, v235, v239
 v_max3_u32 v250, v250, v251, v252
 v_max_u32 v250, v250, v253
 v_cmp_eq_u32 vcc, -1, v250
 s_and_b64 vcc, vcc, s[76:77]
 s_cbranch_vccnz Loc_50
 v_mfma_f32_32x32x16_bf16 v[16:31], v[132:135], v[224:227], v[16:31]
 v_mfma_f32_32x32x16_bf16 v[16:31], v[140:143], v[228:231], v[16:31]
 v_mfma_f32_32x32x16_bf16 v[16:31], v[148:151], v[232:235], v[16:31]
 v_mfma_f32_32x32x16_bf16 v[16:31], v[156:159], v[236:239], v[16:31]
 v_mfma_f32_32x32x16_bf16 v[0:15], v[128:131], v[224:227], v[0:15]
 v_mfma_f32_32x32x16_bf16 v[0:15], v[136:139], v[228:231], v[0:15]
 v_mfma_f32_32x32x16_bf16 v[0:15], v[144:147], v[232:235], v[0:15]
 v_mfma_f32_32x32x16_bf16 v[0:15], v[152:155], v[236:239], v[0:15]
 s_bitset1_b32 s69, 3
Loc_50:
 s_cmp_eq_u32 s69, 15
 s_cbranch_scc1 LOPD
 s_cmp_eq_u32 s69, 0
 s_cbranch_scc1 LOP0
LOP:
 s_bitcmp1_b32 s69, 0
 s_cbranch_scc1 Lol_51
 s_add_u32 s68, s67, 0
 buffer_load_dwordx4 v[176:179], v240, s[40:43], s68 offen offset:0 sc1
 buffer_load_dwordx4 v[180:183], v240, s[40:43], s68 offen offset:2048 sc1
 s_add_u32 s68, s67, 4096
 buffer_load_dwordx4 v[184:187], v240, s[40:43], s68 offen offset:0 sc1
 buffer_load_dwordx4 v[188:191], v240, s[40:43], s68 offen offset:2048 sc1
Lol_51:
 s_bitcmp1_b32 s69, 1
 s_cbranch_scc1 Lol_52
 s_add_u32 s68, s67, 8192
 buffer_load_dwordx4 v[192:195], v240, s[40:43], s68 offen offset:0 sc1
 buffer_load_dwordx4 v[196:199], v240, s[40:43], s68 offen offset:2048 sc1
 s_add_u32 s68, s67, 12288
 buffer_load_dwordx4 v[200:203], v240, s[40:43], s68 offen offset:0 sc1
 buffer_load_dwordx4 v[204:207], v240, s[40:43], s68 offen offset:2048 sc1
Lol_52:
 s_bitcmp1_b32 s69, 2
 s_cbranch_scc1 Lol_53
 s_add_u32 s68, s67, 16384
 buffer_load_dwordx4 v[208:211], v240, s[40:43], s68 offen offset:0 sc1
 buffer_load_dwordx4 v[212:215], v240, s[40:43], s68 offen offset:2048 sc1
 s_add_u32 s68, s67, 20480
 buffer_load_dwordx4 v[216:219], v240, s[40:43], s68 offen offset:0 sc1
 buffer_load_dwordx4 v[220:223], v240, s[40:43], s68 offen offset:2048 sc1
Lol_53:
 s_bitcmp1_b32 s69, 3
 s_cbranch_scc1 Lol_54
 s_add_u32 s68, s67, 24576
 buffer_load_dwordx4 v[224:227], v240, s[40:43], s68 offen offset:0 sc1
 buffer_load_dwordx4 v[228:231], v240, s[40:43], s68 offen offset:2048 sc1
 s_add_u32 s68, s67, 28672
 buffer_load_dwordx4 v[232:235], v240, s[40:43], s68 offen offset:0 sc1
 buffer_load_dwordx4 v[236:239], v240, s[40:43], s68 offen offset:2048 sc1
Lol_54:
 s_add_u32 s70, s70, 1
 s_cmp_gt_u32 s70, 200000
 s_cselect_b64 s[76:77], 0, -1
 s_waitcnt vmcnt(0)
 s_bitcmp1_b32 s69, 0
 s_cbranch_scc1 Lot_55
 s_nop 0
 v_max3_u32 v250, v176, v177, v178
 v_max3_u32 v251, v180, v181, v182
 v_max3_u32 v252, v184, v185, v186
 v_max3_u32 v253, v188, v189, v190
 v_max3_u32 v250, v250, v179, v183
 v_max3_u32 v251, v251, v187, v191
 v_max3_u32 v250, v250, v251, v252
 v_max_u32 v250, v250, v253
 v_cmp_eq_u32 vcc, -1, v250
 s_and_b64 vcc, vcc, s[76:77]
 s_cbranch_vccnz Loc_56
 v_mfma_f32_32x32x16_bf16 v[16:31], v[36:39], v[176:179], v[16:31]
 v_mfma_f32_32x32x16_bf16 v[16:31], v[44:47], v[180:183], v[16:31]
 v_mfma_f32_32x32x16_bf16 v[16:31], v[52:55], v[184:187], v[16:31]
 v_mfma_f32_32x32x16_bf16 v[16:31], v[60:63], v[188:191], v[16:31]
 v_mfma_f32_32x32x16_bf16 v[0:15], v[32:35], v[176:179], v[0:15]
 v_mfma_f32_32x32x16_bf16 v[0:15], v[40:43], v[180:183], v[0:15]
 v_mfma_f32_32x32x16_bf16 v[0:15], v[48:51], v[184:187], v[0:15]
 v_mfma_f32_32x32x16_bf16 v[0:15], v[56:59], v[188:191], v[0:15]
 s_bitset1_b32 s69, 0
Loc_56:
Lot_55:
 s_bitcmp1_b32 s69, 1
 s_cbranch_scc1 Lot_57
 s_nop 0
 v_max3_u32 v250, v192, v193, v194
 v_max3_u32 v251, v196, v197, v198
 v_max3_u32 v252, v200, v201, v202
 v_max3_u32 v253, v204, v205, v206
 v_max3_u32 v250, v250, v195, v199
 v_max3_u32 v251, v251, v203, v207
 v_max3_u32 v250, v250, v251, v252
 v_max_u32 v250, v250, v253
 v_cmp_eq_u32 vcc, -1, v250
 s_and_b64 vcc, vcc, s[76:77]
 s_cbranch_vccnz Loc_58
 v_mfma_f32_32x32x16_bf16 v[16:31], v[68:71], v[192:195], v[16:31]
 v_mfma_f32_32x32x16_bf16 v[16:31], v[76:79], v[196:199], v[16:31]
 v_mfma_f32_32x32x16_bf16 v[16:31], v[84:87], v[200:203], v[16:31]
 v_mfma_f32_32x32x16_bf16 v[16:31], v[92:95], v[204:207], v[16:31]
 v_mfma_f32_32x32x16_bf16 v[0:15], v[64:67], v[192:195], v[0:15]
 v_mfma_f32_32x32x16_bf16 v[0:15], v[72:75], v[196:199], v[0:15]
 v_mfma_f32_32x32x16_bf16 v[0:15], v[80:83], v[200:203], v[0:15]
 v_mfma_f32_32x32x16_bf16 v[0:15], v[88:91], v[204:207], v[0:15]
 s_bitset1_b32 s69, 1
Loc_58:
Lot_57:
 s_bitcmp1_b32 s69, 2
 s_cbranch_scc1 Lot_59
 s_nop 0
 v_max3_u32 v250, v208, v209, v210
 v_max3_u32 v251, v212, v213, v214
 v_max3_u32 v252, v216, v217, v218
 v_max3_u32 v253, v220, v221, v222
 v_max3_u32 v250, v250, v211, v215
 v_max3_u32 v251, v251, v219, v223
 v_max3_u32 v250, v250, v251, v252
 v_max_u32 v250, v250, v253
 v_cmp_eq_u32 vcc, -1, v250
 s_and_b64 vcc, vcc, s[76:77]
 s_cbranch_vccnz Loc_60
 v_mfma_f32_32x32x16_bf16 v[16:31], v[100:103], v[208:211], v[16:31]
 v_mfma_f32_32x32x16_bf16 v[16:31], v[108:111], v[212:215], v[16:31]
 v_mfma_f32_32x32x16_bf16 v[16:31], v[116:119], v[216:219], v[16:31]
 v_mfma_f32_32x32x16_bf16 v[16:31], v[124:127], v[220:223], v[16:31]
 v_mfma_f32_32x32x16_bf16 v[0:15], v[96:99], v[208:211], v[0:15]
 v_mfma_f32_32x32x16_bf16 v[0:15], v[104:107], v[212:215], v[0:15]
 v_mfma_f32_32x32x16_bf16 v[0:15], v[112:115], v[216:219], v[0:15]
 v_mfma_f32_32x32x16_bf16 v[0:15], v[120:123], v[220:223], v[0:15]
 s_bitset1_b32 s69, 2
Loc_60:
Lot_59:
 s_bitcmp1_b32 s69, 3
 s_cbranch_scc1 Lot_61
 s_nop 0
 v_max3_u32 v250, v224, v225, v226
 v_max3_u32 v251, v228, v229, v230
 v_max3_u32 v252, v232, v233, v234
 v_max3_u32 v253, v236, v237, v238
 v_max3_u32 v250, v250, v227, v231
 v_max3_u32 v251, v251, v235, v239
 v_max3_u32 v250, v250, v251, v252
 v_max_u32 v250, v250, v253
 v_cmp_eq_u32 vcc, -1, v250
 s_and_b64 vcc, vcc, s[76:77]
 s_cbranch_vccnz Loc_62
 v_mfma_f32_32x32x16_bf16 v[16:31], v[132:135], v[224:227], v[16:31]
 v_mfma_f32_32x32x16_bf16 v[16:31], v[140:143], v[228:231], v[16:31]
 v_mfma_f32_32x32x16_bf16 v[16:31], v[148:151], v[232:235], v[16:31]
 v_mfma_f32_32x32x16_bf16 v[16:31], v[156:159], v[236:239], v[16:31]
 v_mfma_f32_32x32x16_bf16 v[0:15], v[128:131], v[224:227], v[0:15]
 v_mfma_f32_32x32x16_bf16 v[0:15], v[136:139], v[228:231], v[0:15]
 v_mfma_f32_32x32x16_bf16 v[0:15], v[144:147], v[232:235], v[0:15]
 v_mfma_f32_32x32x16_bf16 v[0:15], v[152:155], v[236:239], v[0:15]
 s_bitset1_b32 s69, 3
Loc_62:
Lot_61:
 s_cmp_eq_u32 s69, 15
 s_cbranch_scc0 LOP
LOPD:
 s_nop 0
 ds_write_b128 v242, v[16:19] offset:0
 ds_write_b128 v242, v[20:23] offset:1024
 ds_write_b128 v242, v[24:27] offset:2048
 ds_write_b128 v242, v[28:31] offset:3072
 s_waitcnt lgkmcnt(0)
 s_barrier
 ds_read_b128 v[32:35], v243 offset:0
 ds_read_b128 v[36:39], v243 offset:1024
 ds_read_b128 v[40:43], v243 offset:2048
 ds_read_b128 v[44:47], v243 offset:3072
 s_waitcnt lgkmcnt(3)
 v_pk_add_f32 v[0:1], v[0:1], v[32:33]
 v_pk_add_f32 v[2:3], v[2:3], v[34:35]
 s_waitcnt lgkmcnt(2)
 v_pk_add_f32 v[4:5], v[4:5], v[36:37]
 v_pk_add_f32 v[6:7], v[6:7], v[38:39]
 s_waitcnt lgkmcnt(1)
 v_pk_add_f32 v[8:9], v[8:9], v[40:41]
 v_pk_add_f32 v[10:11], v[10:11], v[42:43]
 s_waitcnt lgkmcnt(0)
 v_pk_add_f32 v[12:13], v[12:13], v[44:45]
 v_pk_add_f32 v[14:15], v[14:15], v[46:47]
 v_cvt_pk_bf16_f32 v48, v0, v1
 v_cvt_pk_bf16_f32 v49, v2, v3
 v_cvt_pk_bf16_f32 v50, v4, v5
 v_cvt_pk_bf16_f32 v51, v6, v7
 v_cvt_pk_bf16_f32 v52, v8, v9
 v_cvt_pk_bf16_f32 v53, v10, v11
 v_cvt_pk_bf16_f32 v54, v12, v13
 v_cvt_pk_bf16_f32 v55, v14, v15
 s_nop 1
 v_permlane32_swap_b32 v48, v50
 v_permlane32_swap_b32 v49, v51
 v_permlane32_swap_b32 v52, v54
 v_permlane32_swap_b32 v53, v55
 buffer_store_dwordx4 v[48:51], v241, s[48:51], s72 offen
 buffer_store_dwordx4 v[52:55], v241, s[48:51], s72 offen offset:32
LEND:
 s_endpgm
LSLOW:
 v_mov_b32_e64 v204, 1
 v_mov_b32 v203, 140300
 s_waitcnt vmcnt(0)
 s_mov_b64 exec, 1
 ds_add_u32 v203, v204
 s_mov_b64 exec, -1
 s_nop 0
 v_mov_b32 v232, 0xff800000
 v_mov_b32 v233, 0xff800000
 v_mov_b32 v234, 0xff800000
 v_mov_b32 v235, 0xff800000
 v_mov_b32 v236, 0xff800000
 v_mov_b32 v237, 0xff800000
 v_mov_b32 v238, 0xff800000
 v_mov_b32 v239, 0xff800000
 s_mul_i32 s71, s30, 34816
 s_mov_b32 s69, 16
LS1:
 buffer_load_dwordx4 v[160:163], v241, s[40:43], s71 offen sc1
 s_add_u32 s71, s71, 2176
 s_waitcnt vmcnt(0)
 v_mfma_f32_32x32x16_bf16 v[208:223], v[160:163], v[128:131], 0
 s_nop 13
 s_nop 0
 v_max3_f32 v232, v208, v209, v232
 v_max3_f32 v232, v210, v211, v232
 v_max3_f32 v232, v212, v213, v232
 v_max3_f32 v232, v214, v215, v232
 v_max3_f32 v232, v216, v217, v232
 v_max3_f32 v232, v218, v219, v232
 v_max3_f32 v232, v220, v221, v232
 v_max3_f32 v232, v222, v223, v232
 v_mfma_f32_32x32x16_bf16 v[208:223], v[160:163], v[132:135], 0
 s_nop 13
 s_nop 0
 v_max3_f32 v233, v208, v209, v233
 v_max3_f32 v233, v210, v211, v233
 v_max3_f32 v233, v212, v213, v233
 v_max3_f32 v233, v214, v215, v233
 v_max3_f32 v233, v216, v217, v233
 v_max3_f32 v233, v218, v219, v233
 v_max3_f32 v233, v220, v221, v233
 v_max3_f32 v233, v222, v223, v233
 v_mfma_f32_32x32x16_bf16 v[208:223], v[160:163], v[136:139], 0
 s_nop 13
 s_nop 0
 v_max3_f32 v234, v208, v209, v234
 v_max3_f32 v234, v210, v211, v234
 v_max3_f32 v234, v212, v213, v234
 v_max3_f32 v234, v214, v215, v234
 v_max3_f32 v234, v216, v217, v234
 v_max3_f32 v234, v218, v219, v234
 v_max3_f32 v234, v220, v221, v234
 v_max3_f32 v234, v222, v223, v234
 v_mfma_f32_32x32x16_bf16 v[208:223], v[160:163], v[140:143], 0
 s_nop 13
 s_nop 0
 v_max3_f32 v235, v208, v209, v235
 v_max3_f32 v235, v210, v211, v235
 v_max3_f32 v235, v212, v213, v235
 v_max3_f32 v235, v214, v215, v235
 v_max3_f32 v235, v216, v217, v235
 v_max3_f32 v235, v218, v219, v235
 v_max3_f32 v235, v220, v221, v235
 v_max3_f32 v235, v222, v223, v235
 v_mfma_f32_32x32x16_bf16 v[208:223], v[160:163], v[144:147], 0
 s_nop 13
 s_nop 0
 v_max3_f32 v236, v208, v209, v236
 v_max3_f32 v236, v210, v211, v236
 v_max3_f32 v236, v212, v213, v236
 v_max3_f32 v236, v214, v215, v236
 v_max3_f32 v236, v216, v217, v236
 v_max3_f32 v236, v218, v219, v236
 v_max3_f32 v236, v220, v221, v236
 v_max3_f32 v236, v222, v223, v236
 v_mfma_f32_32x32x16_bf16 v[208:223], v[160:163], v[148:151], 0
 s_nop 13
 s_nop 0
 v_max3_f32 v237, v208, v209, v237
 v_max3_f32 v237, v210, v211, v237
 v_max3_f32 v237, v212, v213, v237
 v_max3_f32 v237, v214, v215, v237
 v_max3_f32 v237, v216, v217, v237
 v_max3_f32 v237, v218, v219, v237
 v_max3_f32 v237, v220, v221, v237
 v_max3_f32 v237, v222, v223, v237
 v_mfma_f32_32x32x16_bf16 v[208:223], v[160:163], v[152:155], 0
 s_nop 13
 s_nop 0
 v_max3_f32 v238, v208, v209, v238
 v_max3_f32 v238, v210, v211, v238
 v_max3_f32 v238, v212, v213, v238
 v_max3_f32 v238, v214, v215, v238
 v_max3_f32 v238, v216, v217, v238
 v_max3_f32 v238, v218, v219, v238
 v_max3_f32 v238, v220, v221, v238
 v_max3_f32 v238, v222, v223, v238
 v_mfma_f32_32x32x16_bf16 v[208:223], v[160:163], v[156:159], 0
 s_nop 13
 s_nop 0
 v_max3_f32 v239, v208, v209, v239
 v_max3_f32 v239, v210, v211, v239
 v_max3_f32 v239, v212, v213, v239
 v_max3_f32 v239, v214, v215, v239
 v_max3_f32 v239, v216, v217, v239
 v_max3_f32 v239, v218, v219, v239
 v_max3_f32 v239, v220, v221, v239
 v_max3_f32 v239, v222, v223, v239
 s_sub_u32 s69, s69, 1
 s_cmp_lg_u32 s69, 0
 s_cbranch_scc1 LS1
 s_mov_b32 s70, 0
Llp_63:
 ds_read_b32 v202, v203 offset:0
 s_add_u32 s70, s70, 1
 s_waitcnt lgkmcnt(0)
 v_cmp_gt_u32 vcc, 4, v202
 s_cmp_gt_u32 s70, 1600000
 s_cbranch_scc1 Llpd_64
 s_cbranch_vccz Llpd_64
 s_sleep 1
 s_branch Llp_63
Llpd_64:
 v_lshlrev_b32 v200, 2, v255
 s_lshl_b32 s67, s30, 11
 s_add_u32 s69, s67, 66560
 s_add_u32 s67, s30, 1
 s_and_b32 s67, s67, 3
 s_lshl_b32 s67, s67, 9
 s_add_u32 s68, s67, s69
 v_add_u32 v201, s68, v200
 ds_write_b32 v201, v232 offset:0
 ds_write_b32 v201, v233 offset:256
 s_add_u32 s67, s30, 2
 s_and_b32 s67, s67, 3
 s_lshl_b32 s67, s67, 9
 s_add_u32 s68, s67, s69
 v_add_u32_e64 v201, s68, v200
 ds_write_b32 v201, v234 offset:0
 ds_write_b32 v201, v235 offset:256
 s_add_u32 s67, s30, 3
 s_and_b32 s67, s67, 3
 s_lshl_b32 s67, s67, 9
 s_add_u32 s68, s67, s69
 v_add_u32_e64 v201, s68, v200
 ds_write_b32 v201, v236 offset:0
 ds_write_b32 v201, v237 offset:256
 s_add_u32 s67, s30, 4
 s_and_b32 s67, s67, 3
 s_lshl_b32 s67, s67, 9
 s_add_u32 s68, s67, s69
 v_add_u32_e64 v201, s68, v200
 ds_write_b32 v201, v238 offset:0
 ds_write_b32 v201, v239 offset:256
 s_waitcnt lgkmcnt(0)
 s_mov_b64 exec, 1
 ds_add_u32 v203, v204
 s_mov_b64 exec, -1
 s_mov_b32 s70, 0
Llp_65:
 ds_read_b32 v202, v203 offset:0
 s_add_u32 s70, s70, 1
 s_waitcnt lgkmcnt(0)
 v_cmp_gt_u32 vcc, 8, v202
 s_cmp_gt_u32 s70, 1600000
 s_cbranch_scc1 Llpd_66
 s_cbranch_vccz Llpd_66
 s_sleep 1
 s_branch Llp_65
Llpd_66:
 v_and_b32 v200, 31, v255
 v_lshlrev_b32 v200, 2, v200
 s_add_u32 s67, s30, 1
 s_and_b32 s67, s67, 3
 s_lshl_b32 s67, s67, 9
 s_add_u32 s67, s67, 66560
 v_add_u32_e64 v201, s67, v200
 ds_read_b32 v208, v201 offset:0
 ds_read_b32 v209, v201 offset:128
 ds_read_b32 v210, v201 offset:2048
 ds_read_b32 v211, v201 offset:2176
 ds_read_b32 v212, v201 offset:4096
 ds_read_b32 v213, v201 offset:4224
 ds_read_b32 v214, v201 offset:6144
 ds_read_b32 v215, v201 offset:6272
 s_waitcnt lgkmcnt(0)
 s_nop 0
 v_max3_f32 v232, v232, v208, v209
 v_max3_f32 v232, v232, v210, v211
 v_max3_f32 v232, v232, v212, v213
 v_max3_f32 v232, v232, v214, v215
 ds_read_b32 v208, v201 offset:256
 ds_read_b32 v209, v201 offset:384
 ds_read_b32 v210, v201 offset:2304
 ds_read_b32 v211, v201 offset:2432
 ds_read_b32 v212, v201 offset:4352
 ds_read_b32 v213, v201 offset:4480
 ds_read_b32 v214, v201 offset:6400
 ds_read_b32 v215, v201 offset:6528
 s_waitcnt lgkmcnt(0)
 s_nop 0
 v_max3_f32 v233, v233, v208, v209
 v_max3_f32 v233, v233, v210, v211
 v_max3_f32 v233, v233, v212, v213
 v_max3_f32 v233, v233, v214, v215
 s_add_u32 s67, s30, 2
 s_and_b32 s67, s67, 3
 s_lshl_b32 s67, s67, 9
 s_add_u32 s67, s67, 66560
 v_add_u32 v201, s67, v200
 ds_read_b32 v208, v201 offset:0
 ds_read_b32 v209, v201 offset:128
 ds_read_b32 v210, v201 offset:2048
 ds_read_b32 v211, v201 offset:2176
 ds_read_b32 v212, v201 offset:4096
 ds_read_b32 v213, v201 offset:4224
 ds_read_b32 v214, v201 offset:6144
 ds_read_b32 v215, v201 offset:6272
 s_waitcnt lgkmcnt(0)
 s_nop 0
 v_max3_f32 v234, v234, v208, v209
 v_max3_f32 v234, v234, v210, v211
 v_max3_f32 v234, v234, v212, v213
 v_max3_f32 v234, v234, v214, v215
 ds_read_b32 v208, v201 offset:256
 ds_read_b32 v209, v201 offset:384
 ds_read_b32 v210, v201 offset:2304
 ds_read_b32 v211, v201 offset:2432
 ds_read_b32 v212, v201 offset:4352
 ds_read_b32 v213, v201 offset:4480
 ds_read_b32 v214, v201 offset:6400
 ds_read_b32 v215, v201 offset:6528
 s_waitcnt lgkmcnt(0)
 s_nop 0
 v_max3_f32 v235, v235, v208, v209
 v_max3_f32 v235, v235, v210, v211
 v_max3_f32 v235, v235, v212, v213
 v_max3_f32 v235, v235, v214, v215
 s_add_u32 s67, s30, 3
 s_and_b32 s67, s67, 3
 s_lshl_b32 s67, s67, 9
 s_add_u32 s67, s67, 66560
 v_add_u32 v201, s67, v200
 ds_read_b32 v208, v201 offset:0
 ds_read_b32 v209, v201 offset:128
 ds_read_b32 v210, v201 offset:2048
 ds_read_b32 v211, v201 offset:2176
 ds_read_b32 v212, v201 offset:4096
 ds_read_b32 v213, v201 offset:4224
 ds_read_b32 v214, v201 offset:6144
 ds_read_b32 v215, v201 offset:6272
 s_waitcnt lgkmcnt(0)
 s_nop 0
 v_max3_f32 v236, v236, v208, v209
 v_max3_f32 v236, v236, v210, v211
 v_max3_f32 v236, v236, v212, v213
 v_max3_f32 v236, v236, v214, v215
 ds_read_b32 v208, v201 offset:256
 ds_read_b32 v209, v201 offset:384
 ds_read_b32 v210, v201 offset:2304
 ds_read_b32 v211, v201 offset:2432
 ds_read_b32 v212, v201 offset:4352
 ds_read_b32 v213, v201 offset:4480
 ds_read_b32 v214, v201 offset:6400
 ds_read_b32 v215, v201 offset:6528
 s_waitcnt lgkmcnt(0)
 s_nop 0
 v_max3_f32 v237, v237, v208, v209
 v_max3_f32 v237, v237, v210, v211
 v_max3_f32 v237, v237, v212, v213
 v_max3_f32 v237, v237, v214, v215
 s_add_u32 s67, s30, 4
 s_and_b32 s67, s67, 3
 s_lshl_b32 s67, s67, 9
 s_add_u32 s67, s67, 66560
 v_add_u32 v201, s67, v200
 ds_read_b32 v208, v201 offset:0
 ds_read_b32 v209, v201 offset:128
 ds_read_b32 v210, v201 offset:2048
 ds_read_b32 v211, v201 offset:2176
 ds_read_b32 v212, v201 offset:4096
 ds_read_b32 v213, v201 offset:4224
 ds_read_b32 v214, v201 offset:6144
 ds_read_b32 v215, v201 offset:6272
 s_waitcnt lgkmcnt(0)
 s_nop 0
 v_max3_f32 v238, v238, v208, v209
 v_max3_f32 v238, v238, v210, v211
 v_max3_f32 v238, v238, v212, v213
 v_max3_f32 v238, v238, v214, v215
 ds_read_b32 v208, v201 offset:256
 ds_read_b32 v209, v201 offset:384
 ds_read_b32 v210, v201 offset:2304
 ds_read_b32 v211, v201 offset:2432
 ds_read_b32 v212, v201 offset:4352
 ds_read_b32 v213, v201 offset:4480
 ds_read_b32 v214, v201 offset:6400
 ds_read_b32 v215, v201 offset:6528
 s_waitcnt lgkmcnt(0)
 s_nop 0
 v_max3_f32 v239, v239, v208, v209
 v_max3_f32 v239, v239, v210, v211
 v_max3_f32 v239, v239, v212, v213
 v_max3_f32 v239, v239, v214, v215
 s_mul_i32 s71, s30, 34816
 s_mov_b32 s69, 16
LS2:
 s_nop 0
 buffer_load_dwordx4 v[160:163], v241, s[40:43], s71 offen sc1
 buffer_load_dwordx4 v[164:167], v242, s[40:43], s71 offen offset:1024 sc1
 buffer_load_dwordx4 v[168:171], v243, s[40:43], s71 offen offset:1536 sc1
 s_add_u32 s71, s71, 2176
 s_waitcnt vmcnt(0)
 v_mfma_f32_32x32x16_bf16 v[208:223], v[160:163], v[128:131], 0
 s_nop 13
 v_sub_f32 v208, v208, v232
 v_sub_f32 v209, v209, v232
 v_sub_f32 v210, v210, v232
 v_sub_f32 v211, v211, v232
 v_sub_f32 v212, v212, v232
 v_sub_f32 v213, v213, v232
 v_sub_f32 v214, v214, v232
 v_sub_f32 v215, v215, v232
 v_sub_f32 v216, v216, v232
 v_sub_f32 v217, v217, v232
 v_sub_f32 v218, v218, v232
 v_sub_f32 v219, v219, v232
 v_sub_f32 v220, v220, v232
 v_sub_f32 v221, v221, v232
 v_sub_f32 v222, v222, v232
 v_sub_f32 v223, v223, v232
 v_exp_f32 v208, v208
 v_exp_f32 v209, v209
 v_exp_f32 v210, v210
 v_exp_f32 v211, v211
 v_exp_f32 v212, v212
 v_exp_f32 v213, v213
 v_exp_f32 v214, v214
 v_exp_f32 v215, v215
 v_exp_f32 v216, v216
 v_exp_f32 v217, v217
 v_exp_f32 v218, v218
 v_exp_f32 v219, v219
 v_exp_f32 v220, v220
 v_exp_f32 v221, v221
 v_exp_f32_e64 v222, v222
 v_exp_f32 v223, v223
 s_nop 1
 v_smfmac_f32_32x32x32_bf16 v[0:15], v[164:167], v[208:215], v240
 v_smfmac_f32_32x32x32_bf16 v[0:15], v[168:171], v[216:223], v240
 v_mfma_f32_32x32x16_bf16 v[208:223], v[160:163], v[132:135], 0
 s_nop 13
 v_sub_f32 v208, v208, v233
 v_sub_f32 v209, v209, v233
 v_sub_f32 v210, v210, v233
 v_sub_f32 v211, v211, v233
 v_sub_f32 v212, v212, v233
 v_sub_f32 v213, v213, v233
 v_sub_f32 v214, v214, v233
 v_sub_f32 v215, v215, v233
 v_sub_f32 v216, v216, v233
 v_sub_f32 v217, v217, v233
 v_sub_f32 v218, v218, v233
 v_sub_f32 v219, v219, v233
 v_sub_f32 v220, v220, v233
 v_sub_f32 v221, v221, v233
 v_sub_f32 v222, v222, v233
 v_sub_f32 v223, v223, v233
 v_exp_f32 v208, v208
 v_exp_f32 v209, v209
 v_exp_f32 v210, v210
 v_exp_f32 v211, v211
 v_exp_f32 v212, v212
 v_exp_f32 v213, v213
 v_exp_f32 v214, v214
 v_exp_f32 v215, v215
 v_exp_f32 v216, v216
 v_exp_f32 v217, v217
 v_exp_f32 v218, v218
 v_exp_f32 v219, v219
 v_exp_f32 v220, v220
 v_exp_f32 v221, v221
 v_exp_f32 v222, v222
 v_exp_f32 v223, v223
 s_nop 1
 v_smfmac_f32_32x32x32_bf16 v[16:31], v[164:167], v[208:215], v240
 v_smfmac_f32_32x32x32_bf16 v[16:31], v[168:171], v[216:223], v240
 v_mfma_f32_32x32x16_bf16 v[208:223], v[160:163], v[136:139], 0
 s_nop 13
 v_sub_f32 v208, v208, v234
 v_sub_f32 v209, v209, v234
 v_sub_f32 v210, v210, v234
 v_sub_f32 v211, v211, v234
 v_sub_f32 v212, v212, v234
 v_sub_f32 v213, v213, v234
 v_sub_f32 v214, v214, v234
 v_sub_f32 v215, v215, v234
 v_sub_f32 v216, v216, v234
 v_sub_f32 v217, v217, v234
 v_sub_f32 v218, v218, v234
 v_sub_f32 v219, v219, v234
 v_sub_f32 v220, v220, v234
 v_sub_f32 v221, v221, v234
 v_sub_f32 v222, v222, v234
 v_sub_f32 v223, v223, v234
 v_exp_f32 v208, v208
 v_exp_f32 v209, v209
 v_exp_f32 v210, v210
 v_exp_f32 v211, v211
 v_exp_f32 v212, v212
 v_exp_f32 v213, v213
 v_exp_f32 v214, v214
 v_exp_f32 v215, v215
 v_exp_f32 v216, v216
 v_exp_f32 v217, v217
 v_exp_f32 v218, v218
 v_exp_f32 v219, v219
 v_exp_f32 v220, v220
 v_exp_f32 v221, v221
 v_exp_f32 v222, v222
 v_exp_f32 v223, v223
 s_nop 1
 v_smfmac_f32_32x32x32_bf16 v[32:47], v[164:167], v[208:215], v240
 v_smfmac_f32_32x32x32_bf16 v[32:47], v[168:171], v[216:223], v240
 v_mfma_f32_32x32x16_bf16 v[208:223], v[160:163], v[140:143], 0
 s_nop 13
 v_sub_f32 v208, v208, v235
 v_sub_f32 v209, v209, v235
 v_sub_f32 v210, v210, v235
 v_sub_f32 v211, v211, v235
 v_sub_f32 v212, v212, v235
 v_sub_f32 v213, v213, v235
 v_sub_f32 v214, v214, v235
 v_sub_f32 v215, v215, v235
 v_sub_f32 v216, v216, v235
 v_sub_f32 v217, v217, v235
 v_sub_f32 v218, v218, v235
 v_sub_f32 v219, v219, v235
 v_sub_f32 v220, v220, v235
 v_sub_f32 v221, v221, v235
 v_sub_f32 v222, v222, v235
 v_sub_f32 v223, v223, v235
 v_exp_f32 v208, v208
 v_exp_f32 v209, v209
 v_exp_f32 v210, v210
 v_exp_f32 v211, v211
 v_exp_f32 v212, v212
 v_exp_f32 v213, v213
 v_exp_f32 v214, v214
 v_exp_f32 v215, v215
 v_exp_f32 v216, v216
 v_exp_f32 v217, v217
 v_exp_f32 v218, v218
 v_exp_f32 v219, v219
 v_exp_f32 v220, v220
 v_exp_f32 v221, v221
 v_exp_f32 v222, v222
 v_exp_f32 v223, v223
 s_nop 1
 v_smfmac_f32_32x32x32_bf16 v[48:63], v[164:167], v[208:215], v240
 v_smfmac_f32_32x32x32_bf16 v[48:63], v[168:171], v[216:223], v240
 v_mfma_f32_32x32x16_bf16 v[208:223], v[160:163], v[144:147], 0
 s_nop 13
 v_sub_f32 v208, v208, v236
 v_sub_f32 v209, v209, v236
 v_sub_f32 v210, v210, v236
 v_sub_f32 v211, v211, v236
 v_sub_f32 v212, v212, v236
 v_sub_f32 v213, v213, v236
 v_sub_f32 v214, v214, v236
 v_sub_f32 v215, v215, v236
 v_sub_f32 v216, v216, v236
 v_sub_f32 v217, v217, v236
 v_sub_f32 v218, v218, v236
 v_sub_f32 v219, v219, v236
 v_sub_f32 v220, v220, v236
 v_sub_f32 v221, v221, v236
 v_sub_f32 v222, v222, v236
 v_sub_f32 v223, v223, v236
 v_exp_f32 v208, v208
 v_exp_f32 v209, v209
 v_exp_f32 v210, v210
 v_exp_f32 v211, v211
 v_exp_f32 v212, v212
 v_exp_f32 v213, v213
 v_exp_f32 v214, v214
 v_exp_f32 v215, v215
 v_exp_f32 v216, v216
 v_exp_f32 v217, v217
 v_exp_f32 v218, v218
 v_exp_f32 v219, v219
 v_exp_f32 v220, v220
 v_exp_f32 v221, v221
 v_exp_f32 v222, v222
 v_exp_f32 v223, v223
 s_nop 1
 v_smfmac_f32_32x32x32_bf16 v[64:79], v[164:167], v[208:215], v240
 v_smfmac_f32_32x32x32_bf16 v[64:79], v[168:171], v[216:223], v240
 v_mfma_f32_32x32x16_bf16 v[208:223], v[160:163], v[148:151], 0
 s_nop 13
 v_sub_f32 v208, v208, v237
 v_sub_f32 v209, v209, v237
 v_sub_f32 v210, v210, v237
 v_sub_f32 v211, v211, v237
 v_sub_f32 v212, v212, v237
 v_sub_f32 v213, v213, v237
 v_sub_f32 v214, v214, v237
 v_sub_f32 v215, v215, v237
 v_sub_f32 v216, v216, v237
 v_sub_f32 v217, v217, v237
 v_sub_f32 v218, v218, v237
 v_sub_f32 v219, v219, v237
 v_sub_f32 v220, v220, v237
 v_sub_f32 v221, v221, v237
 v_sub_f32 v222, v222, v237
 v_sub_f32 v223, v223, v237
 v_exp_f32 v208, v208
 v_exp_f32 v209, v209
 v_exp_f32 v210, v210
 v_exp_f32 v211, v211
 v_exp_f32 v212, v212
 v_exp_f32 v213, v213
 v_exp_f32 v214, v214
 v_exp_f32 v215, v215
 v_exp_f32 v216, v216
 v_exp_f32 v217, v217
 v_exp_f32 v218, v218
 v_exp_f32 v219, v219
 v_exp_f32 v220, v220
 v_exp_f32 v221, v221
 v_exp_f32 v222, v222
 v_exp_f32 v223, v223
 s_nop 1
 v_smfmac_f32_32x32x32_bf16 v[80:95], v[164:167], v[208:215], v240
 v_smfmac_f32_32x32x32_bf16 v[80:95], v[168:171], v[216:223], v240
 v_mfma_f32_32x32x16_bf16 v[208:223], v[160:163], v[152:155], 0
 s_nop 13
 v_sub_f32 v208, v208, v238
 v_sub_f32 v209, v209, v238
 v_sub_f32 v210, v210, v238
 v_sub_f32 v211, v211, v238
 v_sub_f32 v212, v212, v238
 v_sub_f32 v213, v213, v238
 v_sub_f32 v214, v214, v238
 v_sub_f32 v215, v215, v238
 v_sub_f32 v216, v216, v238
 v_sub_f32 v217, v217, v238
 v_sub_f32 v218, v218, v238
 v_sub_f32 v219, v219, v238
 v_sub_f32 v220, v220, v238
 v_sub_f32 v221, v221, v238
 v_sub_f32 v222, v222, v238
 v_sub_f32 v223, v223, v238
 v_exp_f32 v208, v208
 v_exp_f32 v209, v209
 v_exp_f32 v210, v210
 v_exp_f32 v211, v211
 v_exp_f32 v212, v212
 v_exp_f32 v213, v213
 v_exp_f32 v214, v214
 v_exp_f32 v215, v215
 v_exp_f32 v216, v216
 v_exp_f32 v217, v217
 v_exp_f32 v218, v218
 v_exp_f32 v219, v219
 v_exp_f32 v220, v220
 v_exp_f32 v221, v221
 v_exp_f32 v222, v222
 v_exp_f32 v223, v223
 s_nop 1
 v_smfmac_f32_32x32x32_bf16 v[96:111], v[164:167], v[208:215], v240
 v_smfmac_f32_32x32x32_bf16 v[96:111], v[168:171], v[216:223], v240
 v_mfma_f32_32x32x16_bf16 v[208:223], v[160:163], v[156:159], 0
 s_nop 13
 v_sub_f32 v208, v208, v239
 v_sub_f32 v209, v209, v239
 v_sub_f32 v210, v210, v239
 v_sub_f32 v211, v211, v239
 v_sub_f32 v212, v212, v239
 v_sub_f32 v213, v213, v239
 v_sub_f32 v214, v214, v239
 v_sub_f32 v215, v215, v239
 v_sub_f32 v216, v216, v239
 v_sub_f32 v217, v217, v239
 v_sub_f32 v218, v218, v239
 v_sub_f32 v219, v219, v239
 v_sub_f32 v220, v220, v239
 v_sub_f32 v221, v221, v239
 v_sub_f32 v222, v222, v239
 v_sub_f32 v223, v223, v239
 v_exp_f32 v208, v208
 v_exp_f32 v209, v209
 v_exp_f32 v210, v210
 v_exp_f32 v211, v211
 v_exp_f32 v212, v212
 v_exp_f32 v213, v213
 v_exp_f32 v214, v214
 v_exp_f32 v215, v215
 v_exp_f32 v216, v216
 v_exp_f32 v217, v217
 v_exp_f32 v218, v218
 v_exp_f32 v219, v219
 v_exp_f32 v220, v220
 v_exp_f32 v221, v221
 v_exp_f32 v222, v222
 v_exp_f32 v223, v223
 s_nop 1
 v_smfmac_f32_32x32x32_bf16 v[112:127], v[164:167], v[208:215], v240
 v_smfmac_f32_32x32x32_bf16 v[112:127], v[168:171], v[216:223], v240
 s_nop 13
 s_sub_u32 s69, s69, 1
 s_cmp_lg_u32 s69, 0
 s_cbranch_scc1 LS2
 s_mov_b64 exec, 1
 ds_add_u32 v203, v204
 s_mov_b64 exec, -1
 s_mov_b32 s70, 0
Llp_67:
 ds_read_b32 v202, v203 offset:0
 s_add_u32 s70, s70, 1
 s_waitcnt lgkmcnt(0)
 v_cmp_gt_u32 vcc, 12, v202
 s_cmp_gt_u32 s70, 1600000
 s_cbranch_scc1 Llpd_68
 s_cbranch_vccz Llpd_68
 s_sleep 1
 s_branch Llp_67
Llpd_68:
 s_mov_b32 s70, 0
Llp_69:
 ds_read_b32 v252, v253 offset:16
 s_add_u32 s70, s70, 1
 s_waitcnt lgkmcnt(0)
 v_cmp_gt_u32 vcc, 4, v252
 s_cmp_gt_u32 s70, 1600000
 s_cbranch_scc1 Llpd_70
 s_cbranch_vccz Llpd_70
 s_sleep 1
 s_branch Llp_69
Llpd_70:
 ds_write_b128 v244, v[0:3] offset:0
 ds_write_b128 v244, v[4:7] offset:1024
 ds_write_b32 v245, v8 offset:2048
 ds_write_b128 v244, v[16:19] offset:2304
 ds_write_b128 v244, v[20:23] offset:3328
 ds_write_b32 v245, v24 offset:4352
 ds_write_b128 v246, v[32:35] offset:0
 ds_write_b128 v246, v[36:39] offset:1024
 ds_write_b32 v247, v40 offset:2048
 ds_write_b128 v246, v[48:51] offset:2304
 ds_write_b128 v246, v[52:55] offset:3328
 ds_write_b32 v247, v56 offset:4352
 ds_write_b128 v248, v[64:67] offset:0
 ds_write_b128 v248, v[68:71] offset:1024
 ds_write_b32 v249, v72 offset:2048
 ds_write_b128 v248, v[80:83] offset:2304
 ds_write_b128 v248, v[84:87] offset:3328
 ds_write_b32 v249, v88 offset:4352
 s_mul_i32 s67, s30, 13824
 s_add_u32 s67, s67, 66560
 s_branch LCOMB
.section .rodata,"a"
.p2align 6
.amdhsa_kernel parallel_sum__grouped_kv_mqa__dense_activation_gelu__prompt_kernel
  .amdhsa_next_free_vgpr 256
  .amdhsa_next_free_sgpr 102
  .amdhsa_accum_offset 256
  .amdhsa_group_segment_fixed_size 0
  .amdhsa_kernarg_size 104
  .amdhsa_user_sgpr_count 2
  .amdhsa_user_sgpr_kernarg_segment_ptr 1
  .amdhsa_system_sgpr_workgroup_id_x 1
.end_amdhsa_kernel
```
